```python
import torch

def _softmax(x, axis=-1):
    return torch.softmax(x, dim=axis)
def _gelu(x):
    return torch.nn.functional.gelu(x, approximate="tanh")
def _silu(x):
    return torch.nn.functional.silu(x)
def _sigmoid(x):
    return torch.sigmoid(x)
def _layernorm(x, axis=-1, eps=1e-5):
    m = x.mean(dim=axis, keepdim=True)
    v = x.var(dim=axis, keepdim=True, unbiased=False)
    return (x - m) / torch.sqrt(v + eps)
def _scatter_add(tgt, idx, src, axis=0):
    return tgt.clone().index_add_(axis, idx, src)
def _segment_sum(src, seg, n):
    out = torch.zeros((n,) + src.shape[1:], dtype=src.dtype)
    return out.index_add_(0, seg, src)
def _pad(x, pw):
    flat = tuple(v for pair in reversed(pw) for v in pair)
    return torch.nn.functional.pad(x, flat)

kernel_name = 'sequential_preLN__grouped_kv_mqa__geglu_ffn__prompt'

def setup_inputs():

    _w = (lambda a: (lambda t: t.to(torch.bfloat16) if t.is_floating_point() else t)(torch.as_tensor(a)))
    def _A_setup():
        B, S, D, H = 1, 2048, 640, 32
        Dh = D // H
        return {
            "x": _w((lambda *s: torch.randn(*s, dtype=torch.bfloat16) * 0.05)(B, S, D)),
            "wq": _w((lambda *s: torch.randn(*s, dtype=torch.bfloat16) * 0.05)(D, H * Dh)),
            "wk": _w((lambda *s: torch.randn(*s, dtype=torch.bfloat16) * 0.05)(D, Dh)),
            "wv": _w((lambda *s: torch.randn(*s, dtype=torch.bfloat16) * 0.05)(D, Dh)),
            "wo": _w((lambda *s: torch.randn(*s, dtype=torch.bfloat16) * 0.05)(H * Dh, D)),
        }
    _A_in = _A_setup()

    def _B_setup():
        B, S, D, F = 1, 2048, 640, 1536
        return {
            "x": _w((lambda *s: torch.randn(*s, dtype=torch.bfloat16) * 0.05)(B, S, D)),
            "w_gate": _w((lambda *s: torch.randn(*s, dtype=torch.bfloat16) * 0.05)(D, F)),
            "w_up": _w((lambda *s: torch.randn(*s, dtype=torch.bfloat16) * 0.05)(D, F)),
            "w_down": _w((lambda *s: torch.randn(*s, dtype=torch.bfloat16) * 0.05)(F, D)),
        }
    _B_in = _B_setup()

    return {
        "A_x": _A_in["x"],
        "A_wq": _A_in["wq"],
        "A_wk": _A_in["wk"],
        "A_wv": _A_in["wv"],
        "A_wo": _A_in["wo"],
        "B_x": _B_in["x"],
        "B_w_gate": _B_in["w_gate"],
        "B_w_up": _B_in["w_up"],
        "B_w_down": _B_in["w_down"],
    }

def reference(A_x, A_wq, A_wk, A_wv, A_wo, B_x, B_w_gate, B_w_up, B_w_down):
    def _A_ref(x, wq, wk, wv, wo):
        B, S, D = x.shape
        H = 32
        Dh = D // H
        q = (lambda x, *d: x.permute(*d))((x @ wq).reshape(B, S, H, Dh), 0, 2, 1, 3)
        k = x @ wk
        v = x @ wv
        scores = torch.einsum("bhqd,bkd->bhqk", q, k) * (Dh ** -0.5)
        p = _softmax(scores, axis=-1)
        o = torch.einsum("bhqk,bkd->bhqd", p, v)
        return (lambda x, *d: x.permute(*d))(o, 0, 2, 1, 3).reshape(B, S, H * Dh) @ wo

    def _B_ref(x, w_gate, w_up, w_down):
        return (_gelu(x @ w_gate) * (x @ w_up)) @ w_down

    x = A_x
    h = x + _A_ref(_layernorm(x, axis=-1), A_wq, A_wk, A_wv, A_wo)
    h2 = h + _B_ref(_layernorm(h, axis=-1), B_w_gate, B_w_up, B_w_down)
    return h2
```

```asm
; @launch kernel=k1_qkv_kernel grid=(242,1,1) block=(320,1,1) lds=107520
; @launch kernel=k2_tail_kernel grid=(256,1,1) block=(512,1,1) lds=158976
.amdgcn_target "amdgcn-amd-amdhsa--gfx950"
.text
.globl k1_qkv_kernel
.p2align 8
.type k1_qkv_kernel,@function
k1_qkv_kernel:
    s_load_dwordx16 s[64:79], s[0:1], 0
    s_load_dwordx8 s[80:87], s[0:1], 64
    s_cmp_ge_u32 s2, 242
    s_cbranch_scc1 K1_end
    v_lshrrev_b32 v1, 6, v0
    s_nop 0
    v_readfirstlane_b32 s40, v1
    v_and_b32 v1, 63, v0
    s_mov_b32 s41, s40
    s_mov_b32 s42, 0
    s_and_b32 s3, s2, 7
    s_lshr_b32 s44, s2, 3
    s_mul_i32 s50, s44, 205
    s_lshr_b32 s50, s50, 11
    s_mul_i32 s51, s50, 10
    s_lshl_b32 s43, s50, 3
    s_add_u32 s43, s43, s3
    s_lshl_b32 s61, s44, 1
    s_add_u32 s61, s61, s3
    s_sub_u32 s61, s61, 46
    s_sub_u32 s52, s2, 220
    s_cmp_ge_u32 s2, 240
    s_cselect_b32 s61, s52, s61
    s_sub_u32 s44, s44, s51
    s_cmp_ge_u32 s43, 22
    s_cbranch_scc1 K1_kv
    s_lshl_b32 s55, s44, 7
    s_mul_i32 s56, s43, 3
    s_add_u32 s56, s56, s40
    v_lshrrev_b32 v2, 5, v1
    v_lshlrev_b32 v3, 4, v1
    s_mul_i32 s57, s43, 122880
    s_cmp_lt_u32 s40, 3
    s_cbranch_scc1 L_compute_1
    s_cmp_eq_u32 s40, 3
    s_cbranch_scc1 L_wloader_2
    v_lshrrev_b32 v106, 3, v1
    v_bfe_u32 v107, v106, 1, 3
    v_and_b32 v108, 7, v1
    v_xor_b32 v107, v107, v108
    v_mul_u32_u24 v106, 1280, v106
    v_lshl_add_u32 v106, v107, 4, v106
    v_add_u32 v84, s57, v106
    v_lshrrev_b32 v106, 3, v1
    v_add_u32 v106, 8, v106
    v_bfe_u32 v107, v106, 1, 3
    v_and_b32 v108, 7, v1
    v_xor_b32 v107, v107, v108
    v_mul_u32_u24 v106, 1280, v106
    v_lshl_add_u32 v106, v107, 4, v106
    v_add_u32 v85, s57, v106
    v_add_u32 v86, 20480, v84
    v_add_u32 v87, 20480, v85
    v_add_u32 v88, 20480, v86
    v_add_u32 v89, 20480, v87
    v_add_u32 v90, 20480, v88
    v_add_u32 v91, 20480, v89
    v_add_u32 v92, 20480, v90
    v_add_u32 v93, 20480, v91
    v_add_u32 v94, 20480, v92
    v_add_u32 v95, 20480, v93
    s_waitcnt lgkmcnt(0)
    s_mov_b32 s20, s64
    s_and_b32 s21, s65, 0xffff
    s_mov_b32 s22, 2621440
    s_mov_b32 s23, 0x00020000
    s_mov_b32 s53, 40960
    s_mov_b32 s45, 0
    s_mov_b32 s47, s53
    s_add_u32 s51, s53, 20480
    s_mov_b32 s49, 4
L_ldn_3:
    s_mov_b32 m0, s47
    s_nop 0
    buffer_load_dwordx4 v84, s[20:23], s45 offen lds
    s_add_u32 m0, s47, 1024
    s_nop 0
    buffer_load_dwordx4 v85, s[20:23], s45 offen lds
    s_add_u32 m0, s47, 2048
    s_nop 0
    buffer_load_dwordx4 v86, s[20:23], s45 offen lds
    s_add_u32 m0, s47, 3072
    s_nop 0
    buffer_load_dwordx4 v87, s[20:23], s45 offen lds
    s_add_u32 m0, s47, 20480
    s_nop 0
    buffer_load_dwordx4 v88, s[20:23], s45 offen lds
    s_add_u32 m0, s47, 21504
    s_nop 0
    buffer_load_dwordx4 v89, s[20:23], s45 offen lds
    s_add_u32 m0, s47, 22528
    s_nop 0
    buffer_load_dwordx4 v90, s[20:23], s45 offen lds
    s_add_u32 m0, s47, 23552
    s_nop 0
    buffer_load_dwordx4 v91, s[20:23], s45 offen lds
    s_add_u32 m0, s47, 40960
    s_nop 0
    buffer_load_dwordx4 v92, s[20:23], s45 offen lds
    s_add_u32 m0, s47, 41984
    s_nop 0
    buffer_load_dwordx4 v93, s[20:23], s45 offen lds
    s_add_u32 m0, s47, 43008
    s_nop 0
    buffer_load_dwordx4 v94, s[20:23], s45 offen lds
    s_add_u32 m0, s47, 44032
    s_nop 0
    buffer_load_dwordx4 v95, s[20:23], s45 offen lds
    s_add_u32 s45, s45, 128
    s_add_u32 s47, s47, 4096
    s_cmp_ge_u32 s47, s51
    s_cselect_b32 s47, s53, s47
    s_sub_u32 s49, s49, 1
    s_cmp_lg_u32 s49, 0
    s_cbranch_scc1 L_ldn_3
    s_waitcnt vmcnt(36)
    s_barrier
    s_mov_b32 s46, 6
L_ldloop_4:
    s_waitcnt vmcnt(24)
    s_barrier
    s_mov_b32 m0, s47
    s_nop 0
    buffer_load_dwordx4 v84, s[20:23], s45 offen lds
    s_add_u32 m0, s47, 1024
    s_nop 0
    buffer_load_dwordx4 v85, s[20:23], s45 offen lds
    s_add_u32 m0, s47, 2048
    s_nop 0
    buffer_load_dwordx4 v86, s[20:23], s45 offen lds
    s_add_u32 m0, s47, 3072
    s_nop 0
    buffer_load_dwordx4 v87, s[20:23], s45 offen lds
    s_add_u32 m0, s47, 20480
    s_nop 0
    buffer_load_dwordx4 v88, s[20:23], s45 offen lds
    s_add_u32 m0, s47, 21504
    s_nop 0
    buffer_load_dwordx4 v89, s[20:23], s45 offen lds
    s_add_u32 m0, s47, 22528
    s_nop 0
    buffer_load_dwordx4 v90, s[20:23], s45 offen lds
    s_add_u32 m0, s47, 23552
    s_nop 0
    buffer_load_dwordx4 v91, s[20:23], s45 offen lds
    s_add_u32 m0, s47, 40960
    s_nop 0
    buffer_load_dwordx4 v92, s[20:23], s45 offen lds
    s_add_u32 m0, s47, 41984
    s_nop 0
    buffer_load_dwordx4 v93, s[20:23], s45 offen lds
    s_add_u32 m0, s47, 43008
    s_nop 0
    buffer_load_dwordx4 v94, s[20:23], s45 offen lds
    s_add_u32 m0, s47, 44032
    s_nop 0
    buffer_load_dwordx4 v95, s[20:23], s45 offen lds
    s_add_u32 s45, s45, 128
    s_add_u32 s47, s47, 4096
    s_cmp_ge_u32 s47, s51
    s_cselect_b32 s47, s53, s47
    s_sub_u32 s46, s46, 1
    s_cmp_lg_u32 s46, 0
    s_cbranch_scc1 L_ldloop_4
    s_waitcnt vmcnt(24)
    s_barrier
    s_waitcnt vmcnt(12)
    s_barrier
    s_waitcnt vmcnt(0)
    s_barrier
    s_endpgm
L_wloader_2:
    s_mov_b32 s53, 0
    v_mov_b32 v106, v1
    v_lshrrev_b32 v107, 3, v106
    v_and_b32 v108, 7, v106
    v_bfe_u32 v109, v107, 1, 1
    v_lshlrev_b32 v109, 2, v109
    v_xor_b32 v108, v108, v109
    v_mul_u32_u24 v107, 1280, v107
    v_lshl_add_u32 v107, v108, 4, v107
    v_add_u32 v84, s55, v107
    v_add_u32 v85, 10240, v84
    v_add_u32 v86, 10240, v85
    v_add_u32 v87, 10240, v86
    v_add_u32 v88, 10240, v87
    v_add_u32 v89, 10240, v88
    v_add_u32 v90, 10240, v89
    v_add_u32 v91, 10240, v90
    s_mov_b32 s45, 0
    s_add_u32 s47, s53, 0
    s_add_u32 s51, s53, 40960
    s_waitcnt lgkmcnt(0)
    s_mov_b32 s16, s66
    s_and_b32 s17, s67, 0xffff
    s_mov_b32 s18, 819200
    s_mov_b32 s19, 0x00020000
    s_mov_b32 s49, 4
L_ldn_5:
    s_mov_b32 m0, s47
    s_nop 0
    buffer_load_dwordx4 v84, s[16:19], s45 offen lds
    s_add_u32 m0, s47, 1024
    s_nop 0
    buffer_load_dwordx4 v85, s[16:19], s45 offen lds
    s_add_u32 m0, s47, 2048
    s_nop 0
    buffer_load_dwordx4 v86, s[16:19], s45 offen lds
    s_add_u32 m0, s47, 3072
    s_nop 0
    buffer_load_dwordx4 v87, s[16:19], s45 offen lds
    s_add_u32 m0, s47, 4096
    s_nop 0
    buffer_load_dwordx4 v88, s[16:19], s45 offen lds
    s_add_u32 m0, s47, 5120
    s_nop 0
    buffer_load_dwordx4 v89, s[16:19], s45 offen lds
    s_add_u32 m0, s47, 6144
    s_nop 0
    buffer_load_dwordx4 v90, s[16:19], s45 offen lds
    s_add_u32 m0, s47, 7168
    s_nop 0
    buffer_load_dwordx4 v91, s[16:19], s45 offen lds
    s_add_u32 s45, s45, 81920
    s_add_u32 s47, s47, 8192
    s_cmp_ge_u32 s47, s51
    s_cselect_b32 s47, s53, s47
    s_sub_u32 s49, s49, 1
    s_cmp_lg_u32 s49, 0
    s_cbranch_scc1 L_ldn_5
    v_lshrrev_b32 v106, 5, v1
    v_mul_u32_u24 v100, 1024, v106
    v_bfe_u32 v106, v1, 4, 1
    v_mul_u32_u24 v106, 32, v106
    v_add_u32 v100, v100, v106
    v_bfe_u32 v106, v1, 2, 2
    v_mul_u32_u24 v107, 128, v106
    v_add_u32 v100, v100, v107
    v_and_b32 v107, 3, v1
    v_lshl_add_u32 v100, v107, 3, v100
    v_lshrrev_b32 v106, 1, v106
    v_lshl_add_u32 v100, v106, 6, v100
    v_xor_b32 v101, 64, v100
    v_lshrrev_b32 v106, 2, v1
    v_xor_b32 v106, v106, v1
    v_bfe_u32 v106, v106, 2, 1
    v_cmp_eq_u32 vcc, 0, v106
    v_mov_b32 v107, 0x3f803f80
    s_nop 0
    v_cndmask_b32 v76, 0, v107, vcc
    v_cndmask_b32 v77, 0, v107, vcc
    v_cndmask_b32 v78, 0, v107, vcc
    v_cndmask_b32 v79, 0, v107, vcc
    v_mov_b32 v68, 0
    v_mov_b32 v69, 0
    v_mov_b32 v70, 0
    v_mov_b32 v71, 0
    v_mov_b32 v72, 0
    v_mov_b32 v73, 0
    v_mov_b32 v74, 0
    v_mov_b32 v75, 0
    s_mov_b32 s48, 0
    s_waitcnt vmcnt(24)
    s_barrier
    v_add_u32 v102, s48, v100
    v_add_u32 v103, s48, v101
    ds_read_b64_tr_b16 v[36:37], v102 offset:0
    ds_read_b64_tr_b16 v[38:39], v102 offset:512
    ds_read_b64_tr_b16 v[52:53], v103 offset:0
    ds_read_b64_tr_b16 v[54:55], v103 offset:512
    ds_read_b64_tr_b16 v[40:41], v102 offset:2048
    ds_read_b64_tr_b16 v[42:43], v102 offset:2560
    ds_read_b64_tr_b16 v[56:57], v103 offset:2048
    ds_read_b64_tr_b16 v[58:59], v103 offset:2560
    ds_read_b64_tr_b16 v[44:45], v102 offset:4096
    ds_read_b64_tr_b16 v[46:47], v102 offset:4608
    ds_read_b64_tr_b16 v[60:61], v103 offset:4096
    ds_read_b64_tr_b16 v[62:63], v103 offset:4608
    ds_read_b64_tr_b16 v[48:49], v102 offset:6144
    ds_read_b64_tr_b16 v[50:51], v102 offset:6656
    ds_read_b64_tr_b16 v[64:65], v103 offset:6144
    ds_read_b64_tr_b16 v[66:67], v103 offset:6656
    s_waitcnt lgkmcnt(12)
    v_mfma_f32_16x16x32_bf16 v[68:71], v[76:79], v[36:39], v[68:71]
    v_mfma_f32_16x16x32_bf16 v[72:75], v[76:79], v[52:55], v[72:75]
    s_waitcnt lgkmcnt(8)
    v_mfma_f32_16x16x32_bf16 v[68:71], v[76:79], v[40:43], v[68:71]
    v_mfma_f32_16x16x32_bf16 v[72:75], v[76:79], v[56:59], v[72:75]
    s_waitcnt lgkmcnt(4)
    v_mfma_f32_16x16x32_bf16 v[68:71], v[76:79], v[44:47], v[68:71]
    v_mfma_f32_16x16x32_bf16 v[72:75], v[76:79], v[60:63], v[72:75]
    s_waitcnt lgkmcnt(0)
    v_mfma_f32_16x16x32_bf16 v[68:71], v[76:79], v[48:51], v[68:71]
    v_mfma_f32_16x16x32_bf16 v[72:75], v[76:79], v[64:67], v[72:75]
    s_add_u32 s48, s48, 8192
    s_cmp_ge_u32 s48, 40960
    s_cselect_b32 s48, 0, s48
    s_mov_b32 s46, 6
L_ldloop_6:
    s_waitcnt vmcnt(16)
    s_barrier
    s_mov_b32 m0, s47
    s_nop 0
    buffer_load_dwordx4 v84, s[16:19], s45 offen lds
    s_add_u32 m0, s47, 1024
    s_nop 0
    buffer_load_dwordx4 v85, s[16:19], s45 offen lds
    s_add_u32 m0, s47, 2048
    s_nop 0
    buffer_load_dwordx4 v86, s[16:19], s45 offen lds
    s_add_u32 m0, s47, 3072
    s_nop 0
    buffer_load_dwordx4 v87, s[16:19], s45 offen lds
    s_add_u32 m0, s47, 4096
    s_nop 0
    buffer_load_dwordx4 v88, s[16:19], s45 offen lds
    s_add_u32 m0, s47, 5120
    s_nop 0
    buffer_load_dwordx4 v89, s[16:19], s45 offen lds
    s_add_u32 m0, s47, 6144
    s_nop 0
    buffer_load_dwordx4 v90, s[16:19], s45 offen lds
    s_add_u32 m0, s47, 7168
    s_nop 0
    buffer_load_dwordx4 v91, s[16:19], s45 offen lds
    s_add_u32 s45, s45, 81920
    s_add_u32 s47, s47, 8192
    s_cmp_ge_u32 s47, s51
    s_cselect_b32 s47, s53, s47
    v_add_u32 v102, s48, v100
    v_add_u32 v103, s48, v101
    ds_read_b64_tr_b16 v[36:37], v102 offset:0
    ds_read_b64_tr_b16 v[38:39], v102 offset:512
    ds_read_b64_tr_b16 v[52:53], v103 offset:0
    ds_read_b64_tr_b16 v[54:55], v103 offset:512
    ds_read_b64_tr_b16 v[40:41], v102 offset:2048
    ds_read_b64_tr_b16 v[42:43], v102 offset:2560
    ds_read_b64_tr_b16 v[56:57], v103 offset:2048
    ds_read_b64_tr_b16 v[58:59], v103 offset:2560
    ds_read_b64_tr_b16 v[44:45], v102 offset:4096
    ds_read_b64_tr_b16 v[46:47], v102 offset:4608
    ds_read_b64_tr_b16 v[60:61], v103 offset:4096
    ds_read_b64_tr_b16 v[62:63], v103 offset:4608
    ds_read_b64_tr_b16 v[48:49], v102 offset:6144
    ds_read_b64_tr_b16 v[50:51], v102 offset:6656
    ds_read_b64_tr_b16 v[64:65], v103 offset:6144
    ds_read_b64_tr_b16 v[66:67], v103 offset:6656
    s_waitcnt lgkmcnt(12)
    v_mfma_f32_16x16x32_bf16 v[68:71], v[76:79], v[36:39], v[68:71]
    v_mfma_f32_16x16x32_bf16 v[72:75], v[76:79], v[52:55], v[72:75]
    s_waitcnt lgkmcnt(8)
    v_mfma_f32_16x16x32_bf16 v[68:71], v[76:79], v[40:43], v[68:71]
    v_mfma_f32_16x16x32_bf16 v[72:75], v[76:79], v[56:59], v[72:75]
    s_waitcnt lgkmcnt(4)
    v_mfma_f32_16x16x32_bf16 v[68:71], v[76:79], v[44:47], v[68:71]
    v_mfma_f32_16x16x32_bf16 v[72:75], v[76:79], v[60:63], v[72:75]
    s_waitcnt lgkmcnt(0)
    v_mfma_f32_16x16x32_bf16 v[68:71], v[76:79], v[48:51], v[68:71]
    v_mfma_f32_16x16x32_bf16 v[72:75], v[76:79], v[64:67], v[72:75]
    s_add_u32 s48, s48, 8192
    s_cmp_ge_u32 s48, 40960
    s_cselect_b32 s48, 0, s48
    s_sub_u32 s46, s46, 1
    s_cmp_lg_u32 s46, 0
    s_cbranch_scc1 L_ldloop_6
    s_waitcnt vmcnt(16)
    s_barrier
    v_add_u32 v102, s48, v100
    v_add_u32 v103, s48, v101
    ds_read_b64_tr_b16 v[36:37], v102 offset:0
    ds_read_b64_tr_b16 v[38:39], v102 offset:512
    ds_read_b64_tr_b16 v[52:53], v103 offset:0
    ds_read_b64_tr_b16 v[54:55], v103 offset:512
    ds_read_b64_tr_b16 v[40:41], v102 offset:2048
    ds_read_b64_tr_b16 v[42:43], v102 offset:2560
    ds_read_b64_tr_b16 v[56:57], v103 offset:2048
    ds_read_b64_tr_b16 v[58:59], v103 offset:2560
    ds_read_b64_tr_b16 v[44:45], v102 offset:4096
    ds_read_b64_tr_b16 v[46:47], v102 offset:4608
    ds_read_b64_tr_b16 v[60:61], v103 offset:4096
    ds_read_b64_tr_b16 v[62:63], v103 offset:4608
    ds_read_b64_tr_b16 v[48:49], v102 offset:6144
    ds_read_b64_tr_b16 v[50:51], v102 offset:6656
    ds_read_b64_tr_b16 v[64:65], v103 offset:6144
    ds_read_b64_tr_b16 v[66:67], v103 offset:6656
    s_waitcnt lgkmcnt(12)
    v_mfma_f32_16x16x32_bf16 v[68:71], v[76:79], v[36:39], v[68:71]
    v_mfma_f32_16x16x32_bf16 v[72:75], v[76:79], v[52:55], v[72:75]
    s_waitcnt lgkmcnt(8)
    v_mfma_f32_16x16x32_bf16 v[68:71], v[76:79], v[40:43], v[68:71]
    v_mfma_f32_16x16x32_bf16 v[72:75], v[76:79], v[56:59], v[72:75]
    s_waitcnt lgkmcnt(4)
    v_mfma_f32_16x16x32_bf16 v[68:71], v[76:79], v[44:47], v[68:71]
    v_mfma_f32_16x16x32_bf16 v[72:75], v[76:79], v[60:63], v[72:75]
    s_waitcnt lgkmcnt(0)
    v_mfma_f32_16x16x32_bf16 v[68:71], v[76:79], v[48:51], v[68:71]
    v_mfma_f32_16x16x32_bf16 v[72:75], v[76:79], v[64:67], v[72:75]
    s_add_u32 s48, s48, 8192
    s_cmp_ge_u32 s48, 40960
    s_cselect_b32 s48, 0, s48
    s_waitcnt vmcnt(8)
    s_barrier
    v_add_u32 v102, s48, v100
    v_add_u32 v103, s48, v101
    ds_read_b64_tr_b16 v[36:37], v102 offset:0
    ds_read_b64_tr_b16 v[38:39], v102 offset:512
    ds_read_b64_tr_b16 v[52:53], v103 offset:0
    ds_read_b64_tr_b16 v[54:55], v103 offset:512
    ds_read_b64_tr_b16 v[40:41], v102 offset:2048
    ds_read_b64_tr_b16 v[42:43], v102 offset:2560
    ds_read_b64_tr_b16 v[56:57], v103 offset:2048
    ds_read_b64_tr_b16 v[58:59], v103 offset:2560
    ds_read_b64_tr_b16 v[44:45], v102 offset:4096
    ds_read_b64_tr_b16 v[46:47], v102 offset:4608
    ds_read_b64_tr_b16 v[60:61], v103 offset:4096
    ds_read_b64_tr_b16 v[62:63], v103 offset:4608
    ds_read_b64_tr_b16 v[48:49], v102 offset:6144
    ds_read_b64_tr_b16 v[50:51], v102 offset:6656
    ds_read_b64_tr_b16 v[64:65], v103 offset:6144
    ds_read_b64_tr_b16 v[66:67], v103 offset:6656
    s_waitcnt lgkmcnt(12)
    v_mfma_f32_16x16x32_bf16 v[68:71], v[76:79], v[36:39], v[68:71]
    v_mfma_f32_16x16x32_bf16 v[72:75], v[76:79], v[52:55], v[72:75]
    s_waitcnt lgkmcnt(8)
    v_mfma_f32_16x16x32_bf16 v[68:71], v[76:79], v[40:43], v[68:71]
    v_mfma_f32_16x16x32_bf16 v[72:75], v[76:79], v[56:59], v[72:75]
    s_waitcnt lgkmcnt(4)
    v_mfma_f32_16x16x32_bf16 v[68:71], v[76:79], v[44:47], v[68:71]
    v_mfma_f32_16x16x32_bf16 v[72:75], v[76:79], v[60:63], v[72:75]
    s_waitcnt lgkmcnt(0)
    v_mfma_f32_16x16x32_bf16 v[68:71], v[76:79], v[48:51], v[68:71]
    v_mfma_f32_16x16x32_bf16 v[72:75], v[76:79], v[64:67], v[72:75]
    s_add_u32 s48, s48, 8192
    s_cmp_ge_u32 s48, 40960
    s_cselect_b32 s48, 0, s48
    s_waitcnt vmcnt(0)
    s_barrier
    v_add_u32 v102, s48, v100
    v_add_u32 v103, s48, v101
    ds_read_b64_tr_b16 v[36:37], v102 offset:0
    ds_read_b64_tr_b16 v[38:39], v102 offset:512
    ds_read_b64_tr_b16 v[52:53], v103 offset:0
    ds_read_b64_tr_b16 v[54:55], v103 offset:512
    ds_read_b64_tr_b16 v[40:41], v102 offset:2048
    ds_read_b64_tr_b16 v[42:43], v102 offset:2560
    ds_read_b64_tr_b16 v[56:57], v103 offset:2048
    ds_read_b64_tr_b16 v[58:59], v103 offset:2560
    ds_read_b64_tr_b16 v[44:45], v102 offset:4096
    ds_read_b64_tr_b16 v[46:47], v102 offset:4608
    ds_read_b64_tr_b16 v[60:61], v103 offset:4096
    ds_read_b64_tr_b16 v[62:63], v103 offset:4608
    ds_read_b64_tr_b16 v[48:49], v102 offset:6144
    ds_read_b64_tr_b16 v[50:51], v102 offset:6656
    ds_read_b64_tr_b16 v[64:65], v103 offset:6144
    ds_read_b64_tr_b16 v[66:67], v103 offset:6656
    s_waitcnt lgkmcnt(12)
    v_mfma_f32_16x16x32_bf16 v[68:71], v[76:79], v[36:39], v[68:71]
    v_mfma_f32_16x16x32_bf16 v[72:75], v[76:79], v[52:55], v[72:75]
    s_waitcnt lgkmcnt(8)
    v_mfma_f32_16x16x32_bf16 v[68:71], v[76:79], v[40:43], v[68:71]
    v_mfma_f32_16x16x32_bf16 v[72:75], v[76:79], v[56:59], v[72:75]
    s_waitcnt lgkmcnt(4)
    v_mfma_f32_16x16x32_bf16 v[68:71], v[76:79], v[44:47], v[68:71]
    v_mfma_f32_16x16x32_bf16 v[72:75], v[76:79], v[60:63], v[72:75]
    s_waitcnt lgkmcnt(0)
    v_mfma_f32_16x16x32_bf16 v[68:71], v[76:79], v[48:51], v[68:71]
    v_mfma_f32_16x16x32_bf16 v[72:75], v[76:79], v[64:67], v[72:75]
    s_add_u32 s48, s48, 8192
    s_cmp_ge_u32 s48, 40960
    s_cselect_b32 s48, 0, s48
    s_nop 7
    v_and_b32 v106, 31, v1
    v_lshlrev_b32 v106, 2, v106
    v_add_u32 v106, 102400, v106
    ds_write_b32 v106, v68 offset:0
    ds_write_b32 v106, v72 offset:128
    s_waitcnt lgkmcnt(0)
    s_barrier
    s_endpgm
L_compute_1:
    s_mul_i32 s60, s40, 20480
    s_add_u32 s60, s60, 40960
    v_lshrrev_b32 v106, 5, v1
    v_mul_u32_u24 v100, 1024, v106
    v_bfe_u32 v106, v1, 4, 1
    v_mul_u32_u24 v106, 32, v106
    v_add_u32 v100, v100, v106
    v_bfe_u32 v106, v1, 2, 2
    v_mul_u32_u24 v107, 128, v106
    v_add_u32 v100, v100, v107
    v_and_b32 v107, 3, v1
    v_lshl_add_u32 v100, v107, 3, v100
    v_lshrrev_b32 v106, 1, v106
    v_lshl_add_u32 v100, v106, 6, v100
    v_xor_b32 v101, 64, v100
    v_lshrrev_b32 v106, 5, v1
    v_bfe_u32 v107, v1, 1, 3
    v_xor_b32 v106, v106, v107
    v_and_b32 v107, 31, v1
    v_lshlrev_b32 v107, 7, v107
    v_lshl_add_u32 v106, v106, 4, v107
    v_add_u32 v76, s60, v106
    v_lshrrev_b32 v106, 5, v1
    v_bfe_u32 v107, v1, 1, 3
    v_xor_b32 v106, v106, v107
    v_xor_b32 v106, 2, v106
    v_and_b32 v107, 31, v1
    v_lshlrev_b32 v107, 7, v107
    v_lshl_add_u32 v106, v106, 4, v107
    v_add_u32 v77, s60, v106
    v_lshrrev_b32 v106, 5, v1
    v_bfe_u32 v107, v1, 1, 3
    v_xor_b32 v106, v106, v107
    v_xor_b32 v106, 4, v106
    v_and_b32 v107, 31, v1
    v_lshlrev_b32 v107, 7, v107
    v_lshl_add_u32 v106, v106, 4, v107
    v_add_u32 v78, s60, v106
    v_lshrrev_b32 v106, 5, v1
    v_bfe_u32 v107, v1, 1, 3
    v_xor_b32 v106, v106, v107
    v_xor_b32 v106, 6, v106
    v_and_b32 v107, 31, v1
    v_lshlrev_b32 v107, 7, v107
    v_lshl_add_u32 v106, v106, 4, v107
    v_add_u32 v79, s60, v106
    v_mov_b32 v36, 0
    v_mov_b32 v37, 0
    v_mov_b32 v38, 0
    v_mov_b32 v39, 0
    v_mov_b32 v40, 0
    v_mov_b32 v41, 0
    v_mov_b32 v42, 0
    v_mov_b32 v43, 0
    v_mov_b32 v44, 0
    v_mov_b32 v45, 0
    v_mov_b32 v46, 0
    v_mov_b32 v47, 0
    v_mov_b32 v48, 0
    v_mov_b32 v49, 0
    v_mov_b32 v50, 0
    v_mov_b32 v51, 0
    v_mov_b32 v52, 0
    v_mov_b32 v53, 0
    v_mov_b32 v54, 0
    v_mov_b32 v55, 0
    v_mov_b32 v56, 0
    v_mov_b32 v57, 0
    v_mov_b32 v58, 0
    v_mov_b32 v59, 0
    v_mov_b32 v60, 0
    v_mov_b32 v61, 0
    v_mov_b32 v62, 0
    v_mov_b32 v63, 0
    v_mov_b32 v64, 0
    v_mov_b32 v65, 0
    v_mov_b32 v66, 0
    v_mov_b32 v67, 0
    s_waitcnt lgkmcnt(0)
    s_lshl_b32 s51, s44, 12
    s_mul_i32 s50, s56, 40960
    s_add_u32 s50, s50, s51
    s_add_u32 s50, s50, 14598144
    s_add_u32 s28, s86, s50
    s_addc_u32 s29, s87, 0
    s_and_b32 s29, s29, 0xffff
    s_mov_b32 s30, 4096
    s_mov_b32 s31, 0x00020000
    s_cmp_ge_u32 s56, 64
    s_cselect_b32 s30, 0, s30
    s_mul_i32 s50, s56, 40960
    s_add_u32 s50, s50, s51
    s_add_u32 s50, s50, 0
    s_add_u32 s24, s86, s50
    s_addc_u32 s25, s87, 0
    s_and_b32 s25, s25, 0xffff
    s_mov_b32 s26, 4096
    s_mov_b32 s27, 0x00020000
    s_cmp_ge_u32 s56, 64
    s_cselect_b32 s26, 0, s26
    s_cmp_lg_u32 s40, 0
    s_cbranch_scc1 L_nozero_7
    s_add_u32 s4, s86, 17219584
    s_addc_u32 s5, s87, 0
    s_and_b32 s5, s5, 0xffff
    s_mov_b32 s6, 65536
    s_mov_b32 s7, 0x00020000
    v_lshlrev_b32 v8, 2, v1
    v_mov_b32 v9, 0
    s_lshl_b32 s50, s2, 8
    buffer_store_dword v9, v8, s[4:7], s50 offen
    s_nop 1
L_nozero_7:
    v_lshrrev_b32 v8, 2, v1
    v_xor_b32 v8, v8, v1
    v_bfe_u32 v8, v8, 2, 1
    v_cmp_eq_u32 vcc, 0, v8
    v_mov_b32 v9, 0x3f803f80
    s_nop 0
    v_cndmask_b32 v4, 0, v9, vcc
    v_cndmask_b32 v5, 0, v9, vcc
    v_cndmask_b32 v6, 0, v9, vcc
    v_cndmask_b32 v7, 0, v9, vcc
    v_mov_b32 v8, 0
    v_mov_b32 v9, 0
    v_mov_b32 v10, 0
    v_mov_b32 v11, 0
    v_mov_b32 v12, 0
    v_mov_b32 v13, 0
    v_mov_b32 v14, 0
    v_mov_b32 v15, 0
    v_mov_b32 v16, 0
    v_mov_b32 v17, 0
    v_mov_b32 v18, 0
    v_mov_b32 v19, 0
    v_mov_b32 v20, 0
    v_mov_b32 v21, 0
    v_mov_b32 v22, 0
    v_mov_b32 v23, 0
    v_mov_b32 v24, 0
    v_mov_b32 v25, 0
    v_mov_b32 v26, 0
    v_mov_b32 v27, 0
    v_add_u32 v102, 0, v100
    v_add_u32 v103, 0, v101
    s_mov_b32 s48, 0
    s_barrier
    ds_read_b128 v[68:71], v76 offset:0
    ds_read_b64_tr_b16 v[84:85], v102 offset:0
    ds_read_b64_tr_b16 v[86:87], v102 offset:512
    ds_read_b64_tr_b16 v[88:89], v103 offset:0
    ds_read_b64_tr_b16 v[90:91], v103 offset:512
    s_waitcnt lgkmcnt(2)
    v_mfma_f32_32x32x16_bf16 v[36:51], v[84:87], v[68:71], v[36:51]
    ds_read_b128 v[72:75], v77 offset:0
    ds_read_b64_tr_b16 v[92:93], v102 offset:2048
    ds_read_b64_tr_b16 v[94:95], v102 offset:2560
    s_waitcnt lgkmcnt(3)
    v_mfma_f32_32x32x16_bf16 v[52:67], v[88:91], v[68:71], v[52:67]
    ds_read_b64_tr_b16 v[96:97], v103 offset:2048
    ds_read_b64_tr_b16 v[98:99], v103 offset:2560
    v_mfma_f32_16x16x32_bf16 v[8:11], v[4:7], v[68:71], v[8:11]
    v_mfma_f32_32x32x16_bf16 v[12:27], v[68:71], v[68:71], v[12:27]
    s_cmp_lg_u32 s44, 0
    s_cbranch_scc1 L_xs_8
    buffer_store_dwordx4 v[68:71], v3, s[28:31], 0 offen offset:0 sc1
L_xs_8:
    s_waitcnt lgkmcnt(2)
    v_mfma_f32_32x32x16_bf16 v[36:51], v[92:95], v[72:75], v[36:51]
    ds_read_b128 v[68:71], v78 offset:0
    ds_read_b64_tr_b16 v[84:85], v102 offset:4096
    ds_read_b64_tr_b16 v[86:87], v102 offset:4608
    s_waitcnt lgkmcnt(3)
    v_mfma_f32_32x32x16_bf16 v[52:67], v[96:99], v[72:75], v[52:67]
    ds_read_b64_tr_b16 v[88:89], v103 offset:4096
    ds_read_b64_tr_b16 v[90:91], v103 offset:4608
    v_mfma_f32_16x16x32_bf16 v[8:11], v[4:7], v[72:75], v[8:11]
    v_mfma_f32_32x32x16_bf16 v[12:27], v[72:75], v[72:75], v[12:27]
    s_cmp_lg_u32 s44, 0
    s_cbranch_scc1 L_xs_9
    buffer_store_dwordx4 v[72:75], v3, s[28:31], 0 offen offset:1024 sc1
L_xs_9:
    s_waitcnt lgkmcnt(2)
    v_mfma_f32_32x32x16_bf16 v[36:51], v[84:87], v[68:71], v[36:51]
    ds_read_b128 v[72:75], v79 offset:0
    ds_read_b64_tr_b16 v[92:93], v102 offset:6144
    ds_read_b64_tr_b16 v[94:95], v102 offset:6656
    s_waitcnt lgkmcnt(3)
    v_mfma_f32_32x32x16_bf16 v[52:67], v[88:91], v[68:71], v[52:67]
    ds_read_b64_tr_b16 v[96:97], v103 offset:6144
    ds_read_b64_tr_b16 v[98:99], v103 offset:6656
    v_mfma_f32_16x16x32_bf16 v[8:11], v[4:7], v[68:71], v[8:11]
    v_mfma_f32_32x32x16_bf16 v[12:27], v[68:71], v[68:71], v[12:27]
    s_cmp_lg_u32 s44, 0
    s_cbranch_scc1 L_xs_10
    buffer_store_dwordx4 v[68:71], v3, s[28:31], 0 offen offset:2048 sc1
L_xs_10:
    s_waitcnt lgkmcnt(2)
    v_mfma_f32_32x32x16_bf16 v[36:51], v[92:95], v[72:75], v[36:51]
    s_add_u32 s48, s48, 8192
    s_cmp_ge_u32 s48, 40960
    s_cselect_b32 s48, 0, s48
    v_add_u32 v104, s48, v100
    v_add_u32 v105, s48, v101
    s_barrier
    ds_read_b128 v[68:71], v76 offset:4096
    ds_read_b64_tr_b16 v[84:85], v104 offset:0
    ds_read_b64_tr_b16 v[86:87], v104 offset:512
    s_waitcnt lgkmcnt(3)
    v_mfma_f32_32x32x16_bf16 v[52:67], v[96:99], v[72:75], v[52:67]
    ds_read_b64_tr_b16 v[88:89], v105 offset:0
    ds_read_b64_tr_b16 v[90:91], v105 offset:512
    v_mfma_f32_16x16x32_bf16 v[8:11], v[4:7], v[72:75], v[8:11]
    v_mfma_f32_32x32x16_bf16 v[12:27], v[72:75], v[72:75], v[12:27]
    s_cmp_lg_u32 s44, 0
    s_cbranch_scc1 L_xs_11
    buffer_store_dwordx4 v[72:75], v3, s[28:31], 0 offen offset:3072 sc1
L_xs_11:
    s_waitcnt lgkmcnt(2)
    v_mfma_f32_32x32x16_bf16 v[36:51], v[84:87], v[68:71], v[36:51]
    ds_read_b128 v[72:75], v77 offset:4096
    ds_read_b64_tr_b16 v[92:93], v104 offset:2048
    ds_read_b64_tr_b16 v[94:95], v104 offset:2560
    s_waitcnt lgkmcnt(3)
    v_mfma_f32_32x32x16_bf16 v[52:67], v[88:91], v[68:71], v[52:67]
    ds_read_b64_tr_b16 v[96:97], v105 offset:2048
    ds_read_b64_tr_b16 v[98:99], v105 offset:2560
    v_mfma_f32_16x16x32_bf16 v[8:11], v[4:7], v[68:71], v[8:11]
    v_mfma_f32_32x32x16_bf16 v[12:27], v[68:71], v[68:71], v[12:27]
    s_cmp_lg_u32 s44, 1
    s_cbranch_scc1 L_xs_12
    buffer_store_dwordx4 v[68:71], v3, s[28:31], 0 offen offset:0 sc1
L_xs_12:
    s_waitcnt lgkmcnt(2)
    v_mfma_f32_32x32x16_bf16 v[36:51], v[92:95], v[72:75], v[36:51]
    ds_read_b128 v[68:71], v78 offset:4096
    ds_read_b64_tr_b16 v[84:85], v104 offset:4096
    ds_read_b64_tr_b16 v[86:87], v104 offset:4608
    s_waitcnt lgkmcnt(3)
    v_mfma_f32_32x32x16_bf16 v[52:67], v[96:99], v[72:75], v[52:67]
    ds_read_b64_tr_b16 v[88:89], v105 offset:4096
    ds_read_b64_tr_b16 v[90:91], v105 offset:4608
    v_mfma_f32_16x16x32_bf16 v[8:11], v[4:7], v[72:75], v[8:11]
    v_mfma_f32_32x32x16_bf16 v[12:27], v[72:75], v[72:75], v[12:27]
    s_cmp_lg_u32 s44, 1
    s_cbranch_scc1 L_xs_13
    buffer_store_dwordx4 v[72:75], v3, s[28:31], 0 offen offset:1024 sc1
L_xs_13:
    s_waitcnt lgkmcnt(2)
    v_mfma_f32_32x32x16_bf16 v[36:51], v[84:87], v[68:71], v[36:51]
    ds_read_b128 v[72:75], v79 offset:4096
    ds_read_b64_tr_b16 v[92:93], v104 offset:6144
    ds_read_b64_tr_b16 v[94:95], v104 offset:6656
    s_waitcnt lgkmcnt(3)
    v_mfma_f32_32x32x16_bf16 v[52:67], v[88:91], v[68:71], v[52:67]
    ds_read_b64_tr_b16 v[96:97], v105 offset:6144
    ds_read_b64_tr_b16 v[98:99], v105 offset:6656
    v_mfma_f32_16x16x32_bf16 v[8:11], v[4:7], v[68:71], v[8:11]
    v_mfma_f32_32x32x16_bf16 v[12:27], v[68:71], v[68:71], v[12:27]
    s_cmp_lg_u32 s44, 1
    s_cbranch_scc1 L_xs_14
    buffer_store_dwordx4 v[68:71], v3, s[28:31], 0 offen offset:2048 sc1
L_xs_14:
    s_waitcnt lgkmcnt(2)
    v_mfma_f32_32x32x16_bf16 v[36:51], v[92:95], v[72:75], v[36:51]
    s_add_u32 s48, s48, 8192
    s_cmp_ge_u32 s48, 40960
    s_cselect_b32 s48, 0, s48
    v_add_u32 v102, s48, v100
    v_add_u32 v103, s48, v101
    s_barrier
    ds_read_b128 v[68:71], v76 offset:8192
    ds_read_b64_tr_b16 v[84:85], v102 offset:0
    ds_read_b64_tr_b16 v[86:87], v102 offset:512
    s_waitcnt lgkmcnt(3)
    v_mfma_f32_32x32x16_bf16 v[52:67], v[96:99], v[72:75], v[52:67]
    ds_read_b64_tr_b16 v[88:89], v103 offset:0
    ds_read_b64_tr_b16 v[90:91], v103 offset:512
    v_mfma_f32_16x16x32_bf16 v[8:11], v[4:7], v[72:75], v[8:11]
    v_mfma_f32_32x32x16_bf16 v[12:27], v[72:75], v[72:75], v[12:27]
    s_cmp_lg_u32 s44, 1
    s_cbranch_scc1 L_xs_15
    buffer_store_dwordx4 v[72:75], v3, s[28:31], 0 offen offset:3072 sc1
L_xs_15:
    s_waitcnt lgkmcnt(2)
    v_mfma_f32_32x32x16_bf16 v[36:51], v[84:87], v[68:71], v[36:51]
    ds_read_b128 v[72:75], v77 offset:8192
    ds_read_b64_tr_b16 v[92:93], v102 offset:2048
    ds_read_b64_tr_b16 v[94:95], v102 offset:2560
    s_waitcnt lgkmcnt(3)
    v_mfma_f32_32x32x16_bf16 v[52:67], v[88:91], v[68:71], v[52:67]
    ds_read_b64_tr_b16 v[96:97], v103 offset:2048
    ds_read_b64_tr_b16 v[98:99], v103 offset:2560
    v_mfma_f32_16x16x32_bf16 v[8:11], v[4:7], v[68:71], v[8:11]
    v_mfma_f32_32x32x16_bf16 v[12:27], v[68:71], v[68:71], v[12:27]
    s_cmp_lg_u32 s44, 2
    s_cbranch_scc1 L_xs_16
    buffer_store_dwordx4 v[68:71], v3, s[28:31], 0 offen offset:0 sc1
L_xs_16:
    s_waitcnt lgkmcnt(2)
    v_mfma_f32_32x32x16_bf16 v[36:51], v[92:95], v[72:75], v[36:51]
    ds_read_b128 v[68:71], v78 offset:8192
    ds_read_b64_tr_b16 v[84:85], v102 offset:4096
    ds_read_b64_tr_b16 v[86:87], v102 offset:4608
    s_waitcnt lgkmcnt(3)
    v_mfma_f32_32x32x16_bf16 v[52:67], v[96:99], v[72:75], v[52:67]
    ds_read_b64_tr_b16 v[88:89], v103 offset:4096
    ds_read_b64_tr_b16 v[90:91], v103 offset:4608
    v_mfma_f32_16x16x32_bf16 v[8:11], v[4:7], v[72:75], v[8:11]
    v_mfma_f32_32x32x16_bf16 v[12:27], v[72:75], v[72:75], v[12:27]
    s_cmp_lg_u32 s44, 2
    s_cbranch_scc1 L_xs_17
    buffer_store_dwordx4 v[72:75], v3, s[28:31], 0 offen offset:1024 sc1
L_xs_17:
    s_waitcnt lgkmcnt(2)
    v_mfma_f32_32x32x16_bf16 v[36:51], v[84:87], v[68:71], v[36:51]
    ds_read_b128 v[72:75], v79 offset:8192
    ds_read_b64_tr_b16 v[92:93], v102 offset:6144
    ds_read_b64_tr_b16 v[94:95], v102 offset:6656
    s_waitcnt lgkmcnt(3)
    v_mfma_f32_32x32x16_bf16 v[52:67], v[88:91], v[68:71], v[52:67]
    ds_read_b64_tr_b16 v[96:97], v103 offset:6144
    ds_read_b64_tr_b16 v[98:99], v103 offset:6656
    v_mfma_f32_16x16x32_bf16 v[8:11], v[4:7], v[68:71], v[8:11]
    v_mfma_f32_32x32x16_bf16 v[12:27], v[68:71], v[68:71], v[12:27]
    s_cmp_lg_u32 s44, 2
    s_cbranch_scc1 L_xs_18
    buffer_store_dwordx4 v[68:71], v3, s[28:31], 0 offen offset:2048 sc1
L_xs_18:
    s_waitcnt lgkmcnt(2)
    v_mfma_f32_32x32x16_bf16 v[36:51], v[92:95], v[72:75], v[36:51]
    s_add_u32 s48, s48, 8192
    s_cmp_ge_u32 s48, 40960
    s_cselect_b32 s48, 0, s48
    v_add_u32 v104, s48, v100
    v_add_u32 v105, s48, v101
    s_barrier
    ds_read_b128 v[68:71], v76 offset:12288
    ds_read_b64_tr_b16 v[84:85], v104 offset:0
    ds_read_b64_tr_b16 v[86:87], v104 offset:512
    s_waitcnt lgkmcnt(3)
    v_mfma_f32_32x32x16_bf16 v[52:67], v[96:99], v[72:75], v[52:67]
    ds_read_b64_tr_b16 v[88:89], v105 offset:0
    ds_read_b64_tr_b16 v[90:91], v105 offset:512
    v_mfma_f32_16x16x32_bf16 v[8:11], v[4:7], v[72:75], v[8:11]
    v_mfma_f32_32x32x16_bf16 v[12:27], v[72:75], v[72:75], v[12:27]
    s_cmp_lg_u32 s44, 2
    s_cbranch_scc1 L_xs_19
    buffer_store_dwordx4 v[72:75], v3, s[28:31], 0 offen offset:3072 sc1
L_xs_19:
    s_waitcnt lgkmcnt(2)
    v_mfma_f32_32x32x16_bf16 v[36:51], v[84:87], v[68:71], v[36:51]
    ds_read_b128 v[72:75], v77 offset:12288
    ds_read_b64_tr_b16 v[92:93], v104 offset:2048
    ds_read_b64_tr_b16 v[94:95], v104 offset:2560
    s_waitcnt lgkmcnt(3)
    v_mfma_f32_32x32x16_bf16 v[52:67], v[88:91], v[68:71], v[52:67]
    ds_read_b64_tr_b16 v[96:97], v105 offset:2048
    ds_read_b64_tr_b16 v[98:99], v105 offset:2560
    v_mfma_f32_16x16x32_bf16 v[8:11], v[4:7], v[68:71], v[8:11]
    v_mfma_f32_32x32x16_bf16 v[12:27], v[68:71], v[68:71], v[12:27]
    s_cmp_lg_u32 s44, 3
    s_cbranch_scc1 L_xs_20
    buffer_store_dwordx4 v[68:71], v3, s[28:31], 0 offen offset:0 sc1
L_xs_20:
    s_waitcnt lgkmcnt(2)
    v_mfma_f32_32x32x16_bf16 v[36:51], v[92:95], v[72:75], v[36:51]
    ds_read_b128 v[68:71], v78 offset:12288
    ds_read_b64_tr_b16 v[84:85], v104 offset:4096
    ds_read_b64_tr_b16 v[86:87], v104 offset:4608
    s_waitcnt lgkmcnt(3)
    v_mfma_f32_32x32x16_bf16 v[52:67], v[96:99], v[72:75], v[52:67]
    ds_read_b64_tr_b16 v[88:89], v105 offset:4096
    ds_read_b64_tr_b16 v[90:91], v105 offset:4608
    v_mfma_f32_16x16x32_bf16 v[8:11], v[4:7], v[72:75], v[8:11]
    v_mfma_f32_32x32x16_bf16 v[12:27], v[72:75], v[72:75], v[12:27]
    s_cmp_lg_u32 s44, 3
    s_cbranch_scc1 L_xs_21
    buffer_store_dwordx4 v[72:75], v3, s[28:31], 0 offen offset:1024 sc1
L_xs_21:
    s_waitcnt lgkmcnt(2)
    v_mfma_f32_32x32x16_bf16 v[36:51], v[84:87], v[68:71], v[36:51]
    ds_read_b128 v[72:75], v79 offset:12288
    ds_read_b64_tr_b16 v[92:93], v104 offset:6144
    ds_read_b64_tr_b16 v[94:95], v104 offset:6656
    s_waitcnt lgkmcnt(3)
    v_mfma_f32_32x32x16_bf16 v[52:67], v[88:91], v[68:71], v[52:67]
    ds_read_b64_tr_b16 v[96:97], v105 offset:6144
    ds_read_b64_tr_b16 v[98:99], v105 offset:6656
    v_mfma_f32_16x16x32_bf16 v[8:11], v[4:7], v[68:71], v[8:11]
    v_mfma_f32_32x32x16_bf16 v[12:27], v[68:71], v[68:71], v[12:27]
    s_cmp_lg_u32 s44, 3
    s_cbranch_scc1 L_xs_22
    buffer_store_dwordx4 v[68:71], v3, s[28:31], 0 offen offset:2048 sc1
L_xs_22:
    s_waitcnt lgkmcnt(2)
    v_mfma_f32_32x32x16_bf16 v[36:51], v[92:95], v[72:75], v[36:51]
    s_add_u32 s48, s48, 8192
    s_cmp_ge_u32 s48, 40960
    s_cselect_b32 s48, 0, s48
    v_add_u32 v102, s48, v100
    v_add_u32 v103, s48, v101
    s_barrier
    ds_read_b128 v[68:71], v76 offset:16384
    ds_read_b64_tr_b16 v[84:85], v102 offset:0
    ds_read_b64_tr_b16 v[86:87], v102 offset:512
    s_waitcnt lgkmcnt(3)
    v_mfma_f32_32x32x16_bf16 v[52:67], v[96:99], v[72:75], v[52:67]
    ds_read_b64_tr_b16 v[88:89], v103 offset:0
    ds_read_b64_tr_b16 v[90:91], v103 offset:512
    v_mfma_f32_16x16x32_bf16 v[8:11], v[4:7], v[72:75], v[8:11]
    v_mfma_f32_32x32x16_bf16 v[12:27], v[72:75], v[72:75], v[12:27]
    s_cmp_lg_u32 s44, 3
    s_cbranch_scc1 L_xs_23
    buffer_store_dwordx4 v[72:75], v3, s[28:31], 0 offen offset:3072 sc1
L_xs_23:
    s_waitcnt lgkmcnt(2)
    v_mfma_f32_32x32x16_bf16 v[36:51], v[84:87], v[68:71], v[36:51]
    ds_read_b128 v[72:75], v77 offset:16384
    ds_read_b64_tr_b16 v[92:93], v102 offset:2048
    ds_read_b64_tr_b16 v[94:95], v102 offset:2560
    s_waitcnt lgkmcnt(3)
    v_mfma_f32_32x32x16_bf16 v[52:67], v[88:91], v[68:71], v[52:67]
    ds_read_b64_tr_b16 v[96:97], v103 offset:2048
    ds_read_b64_tr_b16 v[98:99], v103 offset:2560
    v_mfma_f32_16x16x32_bf16 v[8:11], v[4:7], v[68:71], v[8:11]
    v_mfma_f32_32x32x16_bf16 v[12:27], v[68:71], v[68:71], v[12:27]
    s_cmp_lg_u32 s44, 4
    s_cbranch_scc1 L_xs_24
    buffer_store_dwordx4 v[68:71], v3, s[28:31], 0 offen offset:0 sc1
L_xs_24:
    s_waitcnt lgkmcnt(2)
    v_mfma_f32_32x32x16_bf16 v[36:51], v[92:95], v[72:75], v[36:51]
    ds_read_b128 v[68:71], v78 offset:16384
    ds_read_b64_tr_b16 v[84:85], v102 offset:4096
    ds_read_b64_tr_b16 v[86:87], v102 offset:4608
    s_waitcnt lgkmcnt(3)
    v_mfma_f32_32x32x16_bf16 v[52:67], v[96:99], v[72:75], v[52:67]
    ds_read_b64_tr_b16 v[88:89], v103 offset:4096
    ds_read_b64_tr_b16 v[90:91], v103 offset:4608
    v_mfma_f32_16x16x32_bf16 v[8:11], v[4:7], v[72:75], v[8:11]
    v_mfma_f32_32x32x16_bf16 v[12:27], v[72:75], v[72:75], v[12:27]
    s_cmp_lg_u32 s44, 4
    s_cbranch_scc1 L_xs_25
    buffer_store_dwordx4 v[72:75], v3, s[28:31], 0 offen offset:1024 sc1
L_xs_25:
    s_waitcnt lgkmcnt(2)
    v_mfma_f32_32x32x16_bf16 v[36:51], v[84:87], v[68:71], v[36:51]
    ds_read_b128 v[72:75], v79 offset:16384
    ds_read_b64_tr_b16 v[92:93], v102 offset:6144
    ds_read_b64_tr_b16 v[94:95], v102 offset:6656
    s_waitcnt lgkmcnt(3)
    v_mfma_f32_32x32x16_bf16 v[52:67], v[88:91], v[68:71], v[52:67]
    ds_read_b64_tr_b16 v[96:97], v103 offset:6144
    ds_read_b64_tr_b16 v[98:99], v103 offset:6656
    v_mfma_f32_16x16x32_bf16 v[8:11], v[4:7], v[68:71], v[8:11]
    v_mfma_f32_32x32x16_bf16 v[12:27], v[68:71], v[68:71], v[12:27]
    s_cmp_lg_u32 s44, 4
    s_cbranch_scc1 L_xs_26
    buffer_store_dwordx4 v[68:71], v3, s[28:31], 0 offen offset:2048 sc1
L_xs_26:
    s_waitcnt lgkmcnt(2)
    v_mfma_f32_32x32x16_bf16 v[36:51], v[92:95], v[72:75], v[36:51]
    s_add_u32 s48, s48, 8192
    s_cmp_ge_u32 s48, 40960
    s_cselect_b32 s48, 0, s48
    v_add_u32 v104, s48, v100
    v_add_u32 v105, s48, v101
    s_barrier
    ds_read_b128 v[68:71], v76 offset:0
    ds_read_b64_tr_b16 v[84:85], v104 offset:0
    ds_read_b64_tr_b16 v[86:87], v104 offset:512
    s_waitcnt lgkmcnt(3)
    v_mfma_f32_32x32x16_bf16 v[52:67], v[96:99], v[72:75], v[52:67]
    ds_read_b64_tr_b16 v[88:89], v105 offset:0
    ds_read_b64_tr_b16 v[90:91], v105 offset:512
    v_mfma_f32_16x16x32_bf16 v[8:11], v[4:7], v[72:75], v[8:11]
    v_mfma_f32_32x32x16_bf16 v[12:27], v[72:75], v[72:75], v[12:27]
    s_cmp_lg_u32 s44, 4
    s_cbranch_scc1 L_xs_27
    buffer_store_dwordx4 v[72:75], v3, s[28:31], 0 offen offset:3072 sc1
L_xs_27:
    s_waitcnt lgkmcnt(2)
    v_mfma_f32_32x32x16_bf16 v[36:51], v[84:87], v[68:71], v[36:51]
    ds_read_b128 v[72:75], v77 offset:0
    ds_read_b64_tr_b16 v[92:93], v104 offset:2048
    ds_read_b64_tr_b16 v[94:95], v104 offset:2560
    s_waitcnt lgkmcnt(3)
    v_mfma_f32_32x32x16_bf16 v[52:67], v[88:91], v[68:71], v[52:67]
    ds_read_b64_tr_b16 v[96:97], v105 offset:2048
    ds_read_b64_tr_b16 v[98:99], v105 offset:2560
    v_mfma_f32_16x16x32_bf16 v[8:11], v[4:7], v[68:71], v[8:11]
    v_mfma_f32_32x32x16_bf16 v[12:27], v[68:71], v[68:71], v[12:27]
    s_cmp_lg_u32 s44, 5
    s_cbranch_scc1 L_xs_28
    buffer_store_dwordx4 v[68:71], v3, s[28:31], 0 offen offset:0 sc1
L_xs_28:
    s_waitcnt lgkmcnt(2)
    v_mfma_f32_32x32x16_bf16 v[36:51], v[92:95], v[72:75], v[36:51]
    ds_read_b128 v[68:71], v78 offset:0
    ds_read_b64_tr_b16 v[84:85], v104 offset:4096
    ds_read_b64_tr_b16 v[86:87], v104 offset:4608
    s_waitcnt lgkmcnt(3)
    v_mfma_f32_32x32x16_bf16 v[52:67], v[96:99], v[72:75], v[52:67]
    ds_read_b64_tr_b16 v[88:89], v105 offset:4096
    ds_read_b64_tr_b16 v[90:91], v105 offset:4608
    v_mfma_f32_16x16x32_bf16 v[8:11], v[4:7], v[72:75], v[8:11]
    v_mfma_f32_32x32x16_bf16 v[12:27], v[72:75], v[72:75], v[12:27]
    s_cmp_lg_u32 s44, 5
    s_cbranch_scc1 L_xs_29
    buffer_store_dwordx4 v[72:75], v3, s[28:31], 0 offen offset:1024 sc1
L_xs_29:
    s_waitcnt lgkmcnt(2)
    v_mfma_f32_32x32x16_bf16 v[36:51], v[84:87], v[68:71], v[36:51]
    ds_read_b128 v[72:75], v79 offset:0
    ds_read_b64_tr_b16 v[92:93], v104 offset:6144
    ds_read_b64_tr_b16 v[94:95], v104 offset:6656
    s_waitcnt lgkmcnt(3)
    v_mfma_f32_32x32x16_bf16 v[52:67], v[88:91], v[68:71], v[52:67]
    ds_read_b64_tr_b16 v[96:97], v105 offset:6144
    ds_read_b64_tr_b16 v[98:99], v105 offset:6656
    v_mfma_f32_16x16x32_bf16 v[8:11], v[4:7], v[68:71], v[8:11]
    v_mfma_f32_32x32x16_bf16 v[12:27], v[68:71], v[68:71], v[12:27]
    s_cmp_lg_u32 s44, 5
    s_cbranch_scc1 L_xs_30
    buffer_store_dwordx4 v[68:71], v3, s[28:31], 0 offen offset:2048 sc1
L_xs_30:
    s_waitcnt lgkmcnt(2)
    v_mfma_f32_32x32x16_bf16 v[36:51], v[92:95], v[72:75], v[36:51]
    s_add_u32 s48, s48, 8192
    s_cmp_ge_u32 s48, 40960
    s_cselect_b32 s48, 0, s48
    v_add_u32 v102, s48, v100
    v_add_u32 v103, s48, v101
    s_barrier
    ds_read_b128 v[68:71], v76 offset:4096
    ds_read_b64_tr_b16 v[84:85], v102 offset:0
    ds_read_b64_tr_b16 v[86:87], v102 offset:512
    s_waitcnt lgkmcnt(3)
    v_mfma_f32_32x32x16_bf16 v[52:67], v[96:99], v[72:75], v[52:67]
    ds_read_b64_tr_b16 v[88:89], v103 offset:0
    ds_read_b64_tr_b16 v[90:91], v103 offset:512
    v_mfma_f32_16x16x32_bf16 v[8:11], v[4:7], v[72:75], v[8:11]
    v_mfma_f32_32x32x16_bf16 v[12:27], v[72:75], v[72:75], v[12:27]
    s_cmp_lg_u32 s44, 5
    s_cbranch_scc1 L_xs_31
    buffer_store_dwordx4 v[72:75], v3, s[28:31], 0 offen offset:3072 sc1
L_xs_31:
    s_waitcnt lgkmcnt(2)
    v_mfma_f32_32x32x16_bf16 v[36:51], v[84:87], v[68:71], v[36:51]
    ds_read_b128 v[72:75], v77 offset:4096
    ds_read_b64_tr_b16 v[92:93], v102 offset:2048
    ds_read_b64_tr_b16 v[94:95], v102 offset:2560
    s_waitcnt lgkmcnt(3)
    v_mfma_f32_32x32x16_bf16 v[52:67], v[88:91], v[68:71], v[52:67]
    ds_read_b64_tr_b16 v[96:97], v103 offset:2048
    ds_read_b64_tr_b16 v[98:99], v103 offset:2560
    v_mfma_f32_16x16x32_bf16 v[8:11], v[4:7], v[68:71], v[8:11]
    v_mfma_f32_32x32x16_bf16 v[12:27], v[68:71], v[68:71], v[12:27]
    s_cmp_lg_u32 s44, 6
    s_cbranch_scc1 L_xs_32
    buffer_store_dwordx4 v[68:71], v3, s[28:31], 0 offen offset:0 sc1
L_xs_32:
    s_waitcnt lgkmcnt(2)
    v_mfma_f32_32x32x16_bf16 v[36:51], v[92:95], v[72:75], v[36:51]
    ds_read_b128 v[68:71], v78 offset:4096
    ds_read_b64_tr_b16 v[84:85], v102 offset:4096
    ds_read_b64_tr_b16 v[86:87], v102 offset:4608
    s_waitcnt lgkmcnt(3)
    v_mfma_f32_32x32x16_bf16 v[52:67], v[96:99], v[72:75], v[52:67]
    ds_read_b64_tr_b16 v[88:89], v103 offset:4096
    ds_read_b64_tr_b16 v[90:91], v103 offset:4608
    v_mfma_f32_16x16x32_bf16 v[8:11], v[4:7], v[72:75], v[8:11]
    v_mfma_f32_32x32x16_bf16 v[12:27], v[72:75], v[72:75], v[12:27]
    s_cmp_lg_u32 s44, 6
    s_cbranch_scc1 L_xs_33
    buffer_store_dwordx4 v[72:75], v3, s[28:31], 0 offen offset:1024 sc1
L_xs_33:
    s_waitcnt lgkmcnt(2)
    v_mfma_f32_32x32x16_bf16 v[36:51], v[84:87], v[68:71], v[36:51]
    ds_read_b128 v[72:75], v79 offset:4096
    ds_read_b64_tr_b16 v[92:93], v102 offset:6144
    ds_read_b64_tr_b16 v[94:95], v102 offset:6656
    s_waitcnt lgkmcnt(3)
    v_mfma_f32_32x32x16_bf16 v[52:67], v[88:91], v[68:71], v[52:67]
    ds_read_b64_tr_b16 v[96:97], v103 offset:6144
    ds_read_b64_tr_b16 v[98:99], v103 offset:6656
    v_mfma_f32_16x16x32_bf16 v[8:11], v[4:7], v[68:71], v[8:11]
    v_mfma_f32_32x32x16_bf16 v[12:27], v[68:71], v[68:71], v[12:27]
    s_cmp_lg_u32 s44, 6
    s_cbranch_scc1 L_xs_34
    buffer_store_dwordx4 v[68:71], v3, s[28:31], 0 offen offset:2048 sc1
L_xs_34:
    s_waitcnt lgkmcnt(2)
    v_mfma_f32_32x32x16_bf16 v[36:51], v[92:95], v[72:75], v[36:51]
    s_add_u32 s48, s48, 8192
    s_cmp_ge_u32 s48, 40960
    s_cselect_b32 s48, 0, s48
    v_add_u32 v104, s48, v100
    v_add_u32 v105, s48, v101
    s_barrier
    ds_read_b128 v[68:71], v76 offset:8192
    ds_read_b64_tr_b16 v[84:85], v104 offset:0
    ds_read_b64_tr_b16 v[86:87], v104 offset:512
    s_waitcnt lgkmcnt(3)
    v_mfma_f32_32x32x16_bf16 v[52:67], v[96:99], v[72:75], v[52:67]
    ds_read_b64_tr_b16 v[88:89], v105 offset:0
    ds_read_b64_tr_b16 v[90:91], v105 offset:512
    v_mfma_f32_16x16x32_bf16 v[8:11], v[4:7], v[72:75], v[8:11]
    v_mfma_f32_32x32x16_bf16 v[12:27], v[72:75], v[72:75], v[12:27]
    s_cmp_lg_u32 s44, 6
    s_cbranch_scc1 L_xs_35
    buffer_store_dwordx4 v[72:75], v3, s[28:31], 0 offen offset:3072 sc1
L_xs_35:
    s_waitcnt lgkmcnt(2)
    v_mfma_f32_32x32x16_bf16 v[36:51], v[84:87], v[68:71], v[36:51]
    ds_read_b128 v[72:75], v77 offset:8192
    ds_read_b64_tr_b16 v[92:93], v104 offset:2048
    ds_read_b64_tr_b16 v[94:95], v104 offset:2560
    s_waitcnt lgkmcnt(3)
    v_mfma_f32_32x32x16_bf16 v[52:67], v[88:91], v[68:71], v[52:67]
    ds_read_b64_tr_b16 v[96:97], v105 offset:2048
    ds_read_b64_tr_b16 v[98:99], v105 offset:2560
    v_mfma_f32_16x16x32_bf16 v[8:11], v[4:7], v[68:71], v[8:11]
    v_mfma_f32_32x32x16_bf16 v[12:27], v[68:71], v[68:71], v[12:27]
    s_cmp_lg_u32 s44, 7
    s_cbranch_scc1 L_xs_36
    buffer_store_dwordx4 v[68:71], v3, s[28:31], 0 offen offset:0 sc1
L_xs_36:
    s_waitcnt lgkmcnt(2)
    v_mfma_f32_32x32x16_bf16 v[36:51], v[92:95], v[72:75], v[36:51]
    ds_read_b128 v[68:71], v78 offset:8192
    ds_read_b64_tr_b16 v[84:85], v104 offset:4096
    ds_read_b64_tr_b16 v[86:87], v104 offset:4608
    s_waitcnt lgkmcnt(3)
    v_mfma_f32_32x32x16_bf16 v[52:67], v[96:99], v[72:75], v[52:67]
    ds_read_b64_tr_b16 v[88:89], v105 offset:4096
    ds_read_b64_tr_b16 v[90:91], v105 offset:4608
    v_mfma_f32_16x16x32_bf16 v[8:11], v[4:7], v[72:75], v[8:11]
    v_mfma_f32_32x32x16_bf16 v[12:27], v[72:75], v[72:75], v[12:27]
    s_cmp_lg_u32 s44, 7
    s_cbranch_scc1 L_xs_37
    buffer_store_dwordx4 v[72:75], v3, s[28:31], 0 offen offset:1024 sc1
L_xs_37:
    s_waitcnt lgkmcnt(2)
    v_mfma_f32_32x32x16_bf16 v[36:51], v[84:87], v[68:71], v[36:51]
    ds_read_b128 v[72:75], v79 offset:8192
    ds_read_b64_tr_b16 v[92:93], v104 offset:6144
    ds_read_b64_tr_b16 v[94:95], v104 offset:6656
    s_waitcnt lgkmcnt(3)
    v_mfma_f32_32x32x16_bf16 v[52:67], v[88:91], v[68:71], v[52:67]
    ds_read_b64_tr_b16 v[96:97], v105 offset:6144
    ds_read_b64_tr_b16 v[98:99], v105 offset:6656
    v_mfma_f32_16x16x32_bf16 v[8:11], v[4:7], v[68:71], v[8:11]
    v_mfma_f32_32x32x16_bf16 v[12:27], v[68:71], v[68:71], v[12:27]
    s_cmp_lg_u32 s44, 7
    s_cbranch_scc1 L_xs_38
    buffer_store_dwordx4 v[68:71], v3, s[28:31], 0 offen offset:2048 sc1
L_xs_38:
    s_waitcnt lgkmcnt(2)
    v_mfma_f32_32x32x16_bf16 v[36:51], v[92:95], v[72:75], v[36:51]
    s_add_u32 s48, s48, 8192
    s_cmp_ge_u32 s48, 40960
    s_cselect_b32 s48, 0, s48
    v_add_u32 v102, s48, v100
    v_add_u32 v103, s48, v101
    s_barrier
    ds_read_b128 v[68:71], v76 offset:12288
    ds_read_b64_tr_b16 v[84:85], v102 offset:0
    ds_read_b64_tr_b16 v[86:87], v102 offset:512
    s_waitcnt lgkmcnt(3)
    v_mfma_f32_32x32x16_bf16 v[52:67], v[96:99], v[72:75], v[52:67]
    ds_read_b64_tr_b16 v[88:89], v103 offset:0
    ds_read_b64_tr_b16 v[90:91], v103 offset:512
    v_mfma_f32_16x16x32_bf16 v[8:11], v[4:7], v[72:75], v[8:11]
    v_mfma_f32_32x32x16_bf16 v[12:27], v[72:75], v[72:75], v[12:27]
    s_cmp_lg_u32 s44, 7
    s_cbranch_scc1 L_xs_39
    buffer_store_dwordx4 v[72:75], v3, s[28:31], 0 offen offset:3072 sc1
L_xs_39:
    s_waitcnt lgkmcnt(2)
    v_mfma_f32_32x32x16_bf16 v[36:51], v[84:87], v[68:71], v[36:51]
    ds_read_b128 v[72:75], v77 offset:12288
    ds_read_b64_tr_b16 v[92:93], v102 offset:2048
    ds_read_b64_tr_b16 v[94:95], v102 offset:2560
    s_waitcnt lgkmcnt(3)
    v_mfma_f32_32x32x16_bf16 v[52:67], v[88:91], v[68:71], v[52:67]
    ds_read_b64_tr_b16 v[96:97], v103 offset:2048
    ds_read_b64_tr_b16 v[98:99], v103 offset:2560
    v_mfma_f32_16x16x32_bf16 v[8:11], v[4:7], v[68:71], v[8:11]
    v_mfma_f32_32x32x16_bf16 v[12:27], v[68:71], v[68:71], v[12:27]
    s_cmp_lg_u32 s44, 8
    s_cbranch_scc1 L_xs_40
    buffer_store_dwordx4 v[68:71], v3, s[28:31], 0 offen offset:0 sc1
L_xs_40:
    s_waitcnt lgkmcnt(2)
    v_mfma_f32_32x32x16_bf16 v[36:51], v[92:95], v[72:75], v[36:51]
    ds_read_b128 v[68:71], v78 offset:12288
    ds_read_b64_tr_b16 v[84:85], v102 offset:4096
    ds_read_b64_tr_b16 v[86:87], v102 offset:4608
    s_waitcnt lgkmcnt(3)
    v_mfma_f32_32x32x16_bf16 v[52:67], v[96:99], v[72:75], v[52:67]
    ds_read_b64_tr_b16 v[88:89], v103 offset:4096
    ds_read_b64_tr_b16 v[90:91], v103 offset:4608
    v_mfma_f32_16x16x32_bf16 v[8:11], v[4:7], v[72:75], v[8:11]
    v_mfma_f32_32x32x16_bf16 v[12:27], v[72:75], v[72:75], v[12:27]
    s_cmp_lg_u32 s44, 8
    s_cbranch_scc1 L_xs_41
    buffer_store_dwordx4 v[72:75], v3, s[28:31], 0 offen offset:1024 sc1
L_xs_41:
    s_waitcnt lgkmcnt(2)
    v_mfma_f32_32x32x16_bf16 v[36:51], v[84:87], v[68:71], v[36:51]
    ds_read_b128 v[72:75], v79 offset:12288
    ds_read_b64_tr_b16 v[92:93], v102 offset:6144
    ds_read_b64_tr_b16 v[94:95], v102 offset:6656
    s_waitcnt lgkmcnt(3)
    v_mfma_f32_32x32x16_bf16 v[52:67], v[88:91], v[68:71], v[52:67]
    ds_read_b64_tr_b16 v[96:97], v103 offset:6144
    ds_read_b64_tr_b16 v[98:99], v103 offset:6656
    v_mfma_f32_16x16x32_bf16 v[8:11], v[4:7], v[68:71], v[8:11]
    v_mfma_f32_32x32x16_bf16 v[12:27], v[68:71], v[68:71], v[12:27]
    s_cmp_lg_u32 s44, 8
    s_cbranch_scc1 L_xs_42
    buffer_store_dwordx4 v[68:71], v3, s[28:31], 0 offen offset:2048 sc1
L_xs_42:
    s_waitcnt lgkmcnt(2)
    v_mfma_f32_32x32x16_bf16 v[36:51], v[92:95], v[72:75], v[36:51]
    s_add_u32 s48, s48, 8192
    s_cmp_ge_u32 s48, 40960
    s_cselect_b32 s48, 0, s48
    v_add_u32 v104, s48, v100
    v_add_u32 v105, s48, v101
    s_barrier
    ds_read_b128 v[68:71], v76 offset:16384
    ds_read_b64_tr_b16 v[84:85], v104 offset:0
    ds_read_b64_tr_b16 v[86:87], v104 offset:512
    s_waitcnt lgkmcnt(3)
    v_mfma_f32_32x32x16_bf16 v[52:67], v[96:99], v[72:75], v[52:67]
    ds_read_b64_tr_b16 v[88:89], v105 offset:0
    ds_read_b64_tr_b16 v[90:91], v105 offset:512
    v_mfma_f32_16x16x32_bf16 v[8:11], v[4:7], v[72:75], v[8:11]
    v_mfma_f32_32x32x16_bf16 v[12:27], v[72:75], v[72:75], v[12:27]
    s_cmp_lg_u32 s44, 8
    s_cbranch_scc1 L_xs_43
    buffer_store_dwordx4 v[72:75], v3, s[28:31], 0 offen offset:3072 sc1
L_xs_43:
    s_waitcnt lgkmcnt(2)
    v_mfma_f32_32x32x16_bf16 v[36:51], v[84:87], v[68:71], v[36:51]
    ds_read_b128 v[72:75], v77 offset:16384
    ds_read_b64_tr_b16 v[92:93], v104 offset:2048
    ds_read_b64_tr_b16 v[94:95], v104 offset:2560
    s_waitcnt lgkmcnt(3)
    v_mfma_f32_32x32x16_bf16 v[52:67], v[88:91], v[68:71], v[52:67]
    ds_read_b64_tr_b16 v[96:97], v105 offset:2048
    ds_read_b64_tr_b16 v[98:99], v105 offset:2560
    v_mfma_f32_16x16x32_bf16 v[8:11], v[4:7], v[68:71], v[8:11]
    v_mfma_f32_32x32x16_bf16 v[12:27], v[68:71], v[68:71], v[12:27]
    s_cmp_lg_u32 s44, 9
    s_cbranch_scc1 L_xs_44
    buffer_store_dwordx4 v[68:71], v3, s[28:31], 0 offen offset:0 sc1
L_xs_44:
    s_waitcnt lgkmcnt(2)
    v_mfma_f32_32x32x16_bf16 v[36:51], v[92:95], v[72:75], v[36:51]
    ds_read_b128 v[68:71], v78 offset:16384
    ds_read_b64_tr_b16 v[84:85], v104 offset:4096
    ds_read_b64_tr_b16 v[86:87], v104 offset:4608
    s_waitcnt lgkmcnt(3)
    v_mfma_f32_32x32x16_bf16 v[52:67], v[96:99], v[72:75], v[52:67]
    ds_read_b64_tr_b16 v[88:89], v105 offset:4096
    ds_read_b64_tr_b16 v[90:91], v105 offset:4608
    v_mfma_f32_16x16x32_bf16 v[8:11], v[4:7], v[72:75], v[8:11]
    v_mfma_f32_32x32x16_bf16 v[12:27], v[72:75], v[72:75], v[12:27]
    s_cmp_lg_u32 s44, 9
    s_cbranch_scc1 L_xs_45
    buffer_store_dwordx4 v[72:75], v3, s[28:31], 0 offen offset:1024 sc1
L_xs_45:
    s_waitcnt lgkmcnt(2)
    v_mfma_f32_32x32x16_bf16 v[36:51], v[84:87], v[68:71], v[36:51]
    ds_read_b128 v[72:75], v79 offset:16384
    ds_read_b64_tr_b16 v[92:93], v104 offset:6144
    ds_read_b64_tr_b16 v[94:95], v104 offset:6656
    s_waitcnt lgkmcnt(3)
    v_mfma_f32_32x32x16_bf16 v[52:67], v[88:91], v[68:71], v[52:67]
    ds_read_b64_tr_b16 v[96:97], v105 offset:6144
    ds_read_b64_tr_b16 v[98:99], v105 offset:6656
    v_mfma_f32_16x16x32_bf16 v[8:11], v[4:7], v[68:71], v[8:11]
    v_mfma_f32_32x32x16_bf16 v[12:27], v[68:71], v[68:71], v[12:27]
    s_cmp_lg_u32 s44, 9
    s_cbranch_scc1 L_xs_46
    buffer_store_dwordx4 v[68:71], v3, s[28:31], 0 offen offset:2048 sc1
L_xs_46:
    s_waitcnt lgkmcnt(2)
    v_mfma_f32_32x32x16_bf16 v[36:51], v[92:95], v[72:75], v[36:51]
    s_waitcnt lgkmcnt(0)
    v_mfma_f32_32x32x16_bf16 v[52:67], v[96:99], v[72:75], v[52:67]
    v_mfma_f32_16x16x32_bf16 v[8:11], v[4:7], v[72:75], v[8:11]
    v_mfma_f32_32x32x16_bf16 v[12:27], v[72:75], v[72:75], v[12:27]
    s_cmp_lg_u32 s44, 9
    s_cbranch_scc1 L_xs_47
    buffer_store_dwordx4 v[72:75], v3, s[28:31], 0 offen offset:3072 sc1
L_xs_47:
    s_waitcnt vmcnt(0) lgkmcnt(0)
    s_nop 11
    v_and_b32 v110, 1, v1
    v_cmp_ne_u32 vcc, 0, v110
    s_nop 1
    v_cndmask_b32 v12, v12, v13, vcc
    v_cndmask_b32 v14, v14, v15, vcc
    v_cndmask_b32 v16, v16, v17, vcc
    v_cndmask_b32 v18, v18, v19, vcc
    v_cndmask_b32 v20, v20, v21, vcc
    v_cndmask_b32 v22, v22, v23, vcc
    v_cndmask_b32 v24, v24, v25, vcc
    v_cndmask_b32 v26, v26, v27, vcc
    v_and_b32 v110, 2, v1
    v_cmp_ne_u32 vcc, 0, v110
    s_nop 1
    v_cndmask_b32 v12, v12, v14, vcc
    v_cndmask_b32 v16, v16, v18, vcc
    v_cndmask_b32 v20, v20, v22, vcc
    v_cndmask_b32 v24, v24, v26, vcc
    v_and_b32 v110, 8, v1
    v_cmp_ne_u32 vcc, 0, v110
    s_nop 1
    v_cndmask_b32 v12, v12, v16, vcc
    v_cndmask_b32 v20, v20, v24, vcc
    v_and_b32 v110, 16, v1
    v_cmp_ne_u32 vcc, 0, v110
    s_nop 1
    v_cndmask_b32 v12, v12, v20, vcc
    v_lshrrev_b32 v110, 3, v1
    v_xor_b32 v110, v110, v1
    v_and_b32 v110, 4, v110
    v_cmp_eq_u32 vcc, 0, v110
    s_nop 1
    v_cndmask_b32 v12, 0, v12, vcc
    v_mov_b32 v110, v12
    v_mov_b32 v111, v12
    s_nop 1
    v_permlane32_swap_b32 v110, v111
    s_nop 1
    v_add_f32 v12, v110, v111
    v_mul_f32 v112, 0xbacccccd, v8
    v_mul_f32 v110, 0x3acccccd, v12
    v_fma_f32 v110, -v112, v112, v110
    v_max_f32 v110, 0, v110
    v_add_f32 v110, 0x3727c5ac, v110
    v_rsq_f32 v113, v110
    s_nop 0
    v_lshlrev_b32 v114, 4, v2
    v_add_u32 v114, 102400, v114
    s_barrier
    ds_read_b128 v[116:119], v114 offset:0
    ds_read_b128 v[120:123], v114 offset:32
    ds_read_b128 v[124:127], v114 offset:64
    ds_read_b128 v[128:131], v114 offset:96
    ds_read_b128 v[132:135], v114 offset:128
    ds_read_b128 v[136:139], v114 offset:160
    ds_read_b128 v[140:143], v114 offset:192
    ds_read_b128 v[144:147], v114 offset:224
    v_mul_f32 v113, 0x3ea52b5c, v113
    s_waitcnt lgkmcnt(4)
    v_fma_f32 v116, v112, v116, v36
    v_mul_f32 v116, v113, v116
    v_fma_f32 v117, v112, v117, v37
    v_mul_f32 v117, v113, v117
    v_fma_f32 v118, v112, v118, v38
    v_mul_f32 v118, v113, v118
    v_fma_f32 v119, v112, v119, v39
    v_mul_f32 v119, v113, v119
    v_fma_f32 v120, v112, v120, v40
    v_mul_f32 v120, v113, v120
    v_fma_f32 v121, v112, v121, v41
    v_mul_f32 v121, v113, v121
    v_fma_f32 v122, v112, v122, v42
    v_mul_f32 v122, v113, v122
    v_fma_f32 v123, v112, v123, v43
    v_mul_f32 v123, v113, v123
    v_fma_f32 v124, v112, v124, v44
    v_mul_f32 v124, v113, v124
    v_fma_f32 v125, v112, v125, v45
    v_mul_f32 v125, v113, v125
    v_fma_f32 v126, v112, v126, v46
    v_mul_f32 v126, v113, v126
    v_fma_f32 v127, v112, v127, v47
    v_mul_f32 v127, v113, v127
    v_fma_f32 v128, v112, v128, v48
    v_mul_f32 v128, v113, v128
    v_fma_f32 v129, v112, v129, v49
    v_mul_f32 v129, v113, v129
    v_fma_f32 v130, v112, v130, v50
    v_mul_f32 v130, v113, v130
    v_fma_f32 v131, v112, v131, v51
    v_mul_f32 v131, v113, v131
    v_cvt_pk_bf16_f32 v148, v116, v117
    v_cvt_pk_bf16_f32 v149, v118, v119
    v_cvt_pk_bf16_f32 v150, v120, v121
    v_cvt_pk_bf16_f32 v151, v122, v123
    v_cvt_pk_bf16_f32 v152, v124, v125
    v_cvt_pk_bf16_f32 v153, v126, v127
    v_cvt_pk_bf16_f32 v154, v128, v129
    v_cvt_pk_bf16_f32 v155, v130, v131
    buffer_store_dwordx4 v[148:151], v3, s[24:27], 0 offen offset:0 sc1
    buffer_store_dwordx4 v[152:155], v3, s[24:27], 0 offen offset:1024 sc1
    s_waitcnt lgkmcnt(0)
    v_fma_f32 v132, v112, v132, v52
    v_mul_f32 v132, v113, v132
    v_fma_f32 v133, v112, v133, v53
    v_mul_f32 v133, v113, v133
    v_fma_f32 v134, v112, v134, v54
    v_mul_f32 v134, v113, v134
    v_fma_f32 v135, v112, v135, v55
    v_mul_f32 v135, v113, v135
    v_fma_f32 v136, v112, v136, v56
    v_mul_f32 v136, v113, v136
    v_fma_f32 v137, v112, v137, v57
    v_mul_f32 v137, v113, v137
    v_fma_f32 v138, v112, v138, v58
    v_mul_f32 v138, v113, v138
    v_fma_f32 v139, v112, v139, v59
    v_mul_f32 v139, v113, v139
    v_fma_f32 v140, v112, v140, v60
    v_mul_f32 v140, v113, v140
    v_fma_f32 v141, v112, v141, v61
    v_mul_f32 v141, v113, v141
    v_fma_f32 v142, v112, v142, v62
    v_mul_f32 v142, v113, v142
    v_fma_f32 v143, v112, v143, v63
    v_mul_f32 v143, v113, v143
    v_fma_f32 v144, v112, v144, v64
    v_mul_f32 v144, v113, v144
    v_fma_f32 v145, v112, v145, v65
    v_mul_f32 v145, v113, v145
    v_fma_f32 v146, v112, v146, v66
    v_mul_f32 v146, v113, v146
    v_fma_f32 v147, v112, v147, v67
    v_mul_f32 v147, v113, v147
    v_cvt_pk_bf16_f32 v156, v132, v133
    v_cvt_pk_bf16_f32 v157, v134, v135
    v_cvt_pk_bf16_f32 v158, v136, v137
    v_cvt_pk_bf16_f32 v159, v138, v139
    v_cvt_pk_bf16_f32 v160, v140, v141
    v_cvt_pk_bf16_f32 v161, v142, v143
    v_cvt_pk_bf16_f32 v162, v144, v145
    v_cvt_pk_bf16_f32 v163, v146, v147
    buffer_store_dwordx4 v[156:159], v3, s[24:27], 0 offen offset:2048 sc1
    buffer_store_dwordx4 v[160:163], v3, s[24:27], 0 offen offset:3072 sc1
    s_endpgm
K1_kv:
    s_mov_b32 s43, s61
    s_mov_b32 s55, 0
    s_mul_i32 s56, s43, 3
    s_add_u32 s56, s56, s40
    v_lshrrev_b32 v2, 5, v1
    v_lshlrev_b32 v3, 4, v1
    s_mul_i32 s57, s43, 122880
    s_cmp_lt_u32 s40, 3
    s_cbranch_scc1 L_compute_48
    s_cmp_eq_u32 s40, 3
    s_cbranch_scc1 L_wloader_49
    v_lshrrev_b32 v103, 3, v1
    v_bfe_u32 v104, v103, 1, 3
    v_and_b32 v105, 7, v1
    v_xor_b32 v104, v104, v105
    v_mul_u32_u24 v103, 1280, v103
    v_lshl_add_u32 v103, v104, 4, v103
    v_add_u32 v84, s57, v103
    v_lshrrev_b32 v103, 3, v1
    v_add_u32 v103, 8, v103
    v_bfe_u32 v104, v103, 1, 3
    v_and_b32 v105, 7, v1
    v_xor_b32 v104, v104, v105
    v_mul_u32_u24 v103, 1280, v103
    v_lshl_add_u32 v103, v104, 4, v103
    v_add_u32 v85, s57, v103
    v_add_u32 v86, 20480, v84
    v_add_u32 v87, 20480, v85
    v_add_u32 v88, 20480, v86
    v_add_u32 v89, 20480, v87
    v_add_u32 v90, 20480, v88
    v_add_u32 v91, 20480, v89
    v_add_u32 v92, 20480, v90
    v_add_u32 v93, 20480, v91
    v_add_u32 v94, 20480, v92
    v_add_u32 v95, 20480, v93
    s_waitcnt lgkmcnt(0)
    s_mov_b32 s20, s64
    s_and_b32 s21, s65, 0xffff
    s_mov_b32 s22, 2621440
    s_mov_b32 s23, 0x00020000
    s_mov_b32 s53, 30720
    s_mov_b32 s45, 0
    s_mov_b32 s47, s53
    s_add_u32 s51, s53, 20480
    s_mov_b32 s49, 4
L_ldn_50:
    s_mov_b32 m0, s47
    s_nop 0
    buffer_load_dwordx4 v84, s[20:23], s45 offen lds
    s_add_u32 m0, s47, 1024
    s_nop 0
    buffer_load_dwordx4 v85, s[20:23], s45 offen lds
    s_add_u32 m0, s47, 2048
    s_nop 0
    buffer_load_dwordx4 v86, s[20:23], s45 offen lds
    s_add_u32 m0, s47, 3072
    s_nop 0
    buffer_load_dwordx4 v87, s[20:23], s45 offen lds
    s_add_u32 m0, s47, 20480
    s_nop 0
    buffer_load_dwordx4 v88, s[20:23], s45 offen lds
    s_add_u32 m0, s47, 21504
    s_nop 0
    buffer_load_dwordx4 v89, s[20:23], s45 offen lds
    s_add_u32 m0, s47, 22528
    s_nop 0
    buffer_load_dwordx4 v90, s[20:23], s45 offen lds
    s_add_u32 m0, s47, 23552
    s_nop 0
    buffer_load_dwordx4 v91, s[20:23], s45 offen lds
    s_add_u32 m0, s47, 40960
    s_nop 0
    buffer_load_dwordx4 v92, s[20:23], s45 offen lds
    s_add_u32 m0, s47, 41984
    s_nop 0
    buffer_load_dwordx4 v93, s[20:23], s45 offen lds
    s_add_u32 m0, s47, 43008
    s_nop 0
    buffer_load_dwordx4 v94, s[20:23], s45 offen lds
    s_add_u32 m0, s47, 44032
    s_nop 0
    buffer_load_dwordx4 v95, s[20:23], s45 offen lds
    s_add_u32 s45, s45, 128
    s_add_u32 s47, s47, 4096
    s_cmp_ge_u32 s47, s51
    s_cselect_b32 s47, s53, s47
    s_sub_u32 s49, s49, 1
    s_cmp_lg_u32 s49, 0
    s_cbranch_scc1 L_ldn_50
    s_waitcnt vmcnt(36)
    s_barrier
    s_mov_b32 s46, 6
L_ldloop_51:
    s_waitcnt vmcnt(24)
    s_barrier
    s_mov_b32 m0, s47
    s_nop 0
    buffer_load_dwordx4 v84, s[20:23], s45 offen lds
    s_add_u32 m0, s47, 1024
    s_nop 0
    buffer_load_dwordx4 v85, s[20:23], s45 offen lds
    s_add_u32 m0, s47, 2048
    s_nop 0
    buffer_load_dwordx4 v86, s[20:23], s45 offen lds
    s_add_u32 m0, s47, 3072
    s_nop 0
    buffer_load_dwordx4 v87, s[20:23], s45 offen lds
    s_add_u32 m0, s47, 20480
    s_nop 0
    buffer_load_dwordx4 v88, s[20:23], s45 offen lds
    s_add_u32 m0, s47, 21504
    s_nop 0
    buffer_load_dwordx4 v89, s[20:23], s45 offen lds
    s_add_u32 m0, s47, 22528
    s_nop 0
    buffer_load_dwordx4 v90, s[20:23], s45 offen lds
    s_add_u32 m0, s47, 23552
    s_nop 0
    buffer_load_dwordx4 v91, s[20:23], s45 offen lds
    s_add_u32 m0, s47, 40960
    s_nop 0
    buffer_load_dwordx4 v92, s[20:23], s45 offen lds
    s_add_u32 m0, s47, 41984
    s_nop 0
    buffer_load_dwordx4 v93, s[20:23], s45 offen lds
    s_add_u32 m0, s47, 43008
    s_nop 0
    buffer_load_dwordx4 v94, s[20:23], s45 offen lds
    s_add_u32 m0, s47, 44032
    s_nop 0
    buffer_load_dwordx4 v95, s[20:23], s45 offen lds
    s_add_u32 s45, s45, 128
    s_add_u32 s47, s47, 4096
    s_cmp_ge_u32 s47, s51
    s_cselect_b32 s47, s53, s47
    s_sub_u32 s46, s46, 1
    s_cmp_lg_u32 s46, 0
    s_cbranch_scc1 L_ldloop_51
    s_waitcnt vmcnt(24)
    s_barrier
    s_waitcnt vmcnt(12)
    s_barrier
    s_waitcnt vmcnt(0)
    s_barrier
    s_endpgm
L_wloader_49:
    s_mov_b32 s53, 0
    v_mov_b32 v103, v1
    v_lshlrev_b32 v84, 4, v103
    v_add_u32 v85, 1024, v84
    v_add_u32 v86, 1024, v85
    s_mov_b32 s45, 0
    s_add_u32 s47, s53, 0
    s_add_u32 s51, s53, 30720
    s_waitcnt lgkmcnt(0)
    s_mov_b32 s16, s68
    s_and_b32 s17, s69, 0xffff
    s_mov_b32 s18, 25600
    s_mov_b32 s19, 0x00020000
    s_mov_b32 s36, s70
    s_and_b32 s37, s71, 0xffff
    s_mov_b32 s38, 25600
    s_mov_b32 s39, 0x00020000
    s_mov_b32 s49, 4
L_ldn_52:
    s_mov_b32 m0, s47
    s_nop 0
    buffer_load_dwordx4 v84, s[16:19], s45 offen lds
    s_add_u32 m0, s47, 1024
    s_nop 0
    buffer_load_dwordx4 v85, s[16:19], s45 offen lds
    s_add_u32 m0, s47, 2048
    s_nop 0
    buffer_load_dwordx4 v86, s[16:19], s45 offen lds
    s_add_u32 m0, s47, 3072
    s_nop 0
    buffer_load_dwordx4 v84, s[36:39], s45 offen lds
    s_add_u32 m0, s47, 4096
    s_nop 0
    buffer_load_dwordx4 v85, s[36:39], s45 offen lds
    s_add_u32 m0, s47, 5120
    s_nop 0
    buffer_load_dwordx4 v86, s[36:39], s45 offen lds
    s_add_u32 s45, s45, 2560
    s_add_u32 s47, s47, 6144
    s_cmp_ge_u32 s47, s51
    s_cselect_b32 s47, s53, s47
    s_sub_u32 s49, s49, 1
    s_cmp_lg_u32 s49, 0
    s_cbranch_scc1 L_ldn_52
    v_lshrrev_b32 v103, 5, v1
    v_mul_u32_u24 v100, 320, v103
    v_bfe_u32 v103, v1, 4, 1
    v_mul_u32_u24 v103, 32, v103
    v_add_u32 v100, v100, v103
    v_bfe_u32 v103, v1, 2, 2
    v_mul_u32_u24 v104, 40, v103
    v_add_u32 v100, v100, v104
    v_and_b32 v104, 3, v1
    v_lshl_add_u32 v100, v104, 3, v100
    v_lshrrev_b32 v103, 2, v1
    v_xor_b32 v103, v103, v1
    v_bfe_u32 v103, v103, 2, 1
    v_cmp_eq_u32 vcc, 0, v103
    v_mov_b32 v104, 0x3f803f80
    s_nop 0
    v_cndmask_b32 v76, 0, v104, vcc
    v_cndmask_b32 v77, 0, v104, vcc
    v_cndmask_b32 v78, 0, v104, vcc
    v_cndmask_b32 v79, 0, v104, vcc
    v_mov_b32 v68, 0
    v_mov_b32 v69, 0
    v_mov_b32 v70, 0
    v_mov_b32 v71, 0
    v_mov_b32 v72, 0
    v_mov_b32 v73, 0
    v_mov_b32 v74, 0
    v_mov_b32 v75, 0
    s_mov_b32 s48, 0
    s_waitcnt vmcnt(18)
    s_barrier
    v_add_u32 v101, s48, v100
    ds_read_b64_tr_b16 v[36:37], v101 offset:0
    ds_read_b64_tr_b16 v[38:39], v101 offset:160
    ds_read_b64_tr_b16 v[52:53], v101 offset:3072
    ds_read_b64_tr_b16 v[54:55], v101 offset:3232
    ds_read_b64_tr_b16 v[40:41], v101 offset:640
    ds_read_b64_tr_b16 v[42:43], v101 offset:800
    ds_read_b64_tr_b16 v[56:57], v101 offset:3712
    ds_read_b64_tr_b16 v[58:59], v101 offset:3872
    ds_read_b64_tr_b16 v[44:45], v101 offset:1280
    ds_read_b64_tr_b16 v[46:47], v101 offset:1440
    ds_read_b64_tr_b16 v[60:61], v101 offset:4352
    ds_read_b64_tr_b16 v[62:63], v101 offset:4512
    ds_read_b64_tr_b16 v[48:49], v101 offset:1920
    ds_read_b64_tr_b16 v[50:51], v101 offset:2080
    ds_read_b64_tr_b16 v[64:65], v101 offset:4992
    ds_read_b64_tr_b16 v[66:67], v101 offset:5152
    s_waitcnt lgkmcnt(12)
    v_mfma_f32_16x16x32_bf16 v[68:71], v[76:79], v[36:39], v[68:71]
    v_mfma_f32_16x16x32_bf16 v[72:75], v[76:79], v[52:55], v[72:75]
    s_waitcnt lgkmcnt(8)
    v_mfma_f32_16x16x32_bf16 v[68:71], v[76:79], v[40:43], v[68:71]
    v_mfma_f32_16x16x32_bf16 v[72:75], v[76:79], v[56:59], v[72:75]
    s_waitcnt lgkmcnt(4)
    v_mfma_f32_16x16x32_bf16 v[68:71], v[76:79], v[44:47], v[68:71]
    v_mfma_f32_16x16x32_bf16 v[72:75], v[76:79], v[60:63], v[72:75]
    s_waitcnt lgkmcnt(0)
    v_mfma_f32_16x16x32_bf16 v[68:71], v[76:79], v[48:51], v[68:71]
    v_mfma_f32_16x16x32_bf16 v[72:75], v[76:79], v[64:67], v[72:75]
    s_add_u32 s48, s48, 6144
    s_cmp_ge_u32 s48, 30720
    s_cselect_b32 s48, 0, s48
    s_mov_b32 s46, 6
L_ldloop_53:
    s_waitcnt vmcnt(12)
    s_barrier
    s_mov_b32 m0, s47
    s_nop 0
    buffer_load_dwordx4 v84, s[16:19], s45 offen lds
    s_add_u32 m0, s47, 1024
    s_nop 0
    buffer_load_dwordx4 v85, s[16:19], s45 offen lds
    s_add_u32 m0, s47, 2048
    s_nop 0
    buffer_load_dwordx4 v86, s[16:19], s45 offen lds
    s_add_u32 m0, s47, 3072
    s_nop 0
    buffer_load_dwordx4 v84, s[36:39], s45 offen lds
    s_add_u32 m0, s47, 4096
    s_nop 0
    buffer_load_dwordx4 v85, s[36:39], s45 offen lds
    s_add_u32 m0, s47, 5120
    s_nop 0
    buffer_load_dwordx4 v86, s[36:39], s45 offen lds
    s_add_u32 s45, s45, 2560
    s_add_u32 s47, s47, 6144
    s_cmp_ge_u32 s47, s51
    s_cselect_b32 s47, s53, s47
    v_add_u32 v101, s48, v100
    ds_read_b64_tr_b16 v[36:37], v101 offset:0
    ds_read_b64_tr_b16 v[38:39], v101 offset:160
    ds_read_b64_tr_b16 v[52:53], v101 offset:3072
    ds_read_b64_tr_b16 v[54:55], v101 offset:3232
    ds_read_b64_tr_b16 v[40:41], v101 offset:640
    ds_read_b64_tr_b16 v[42:43], v101 offset:800
    ds_read_b64_tr_b16 v[56:57], v101 offset:3712
    ds_read_b64_tr_b16 v[58:59], v101 offset:3872
    ds_read_b64_tr_b16 v[44:45], v101 offset:1280
    ds_read_b64_tr_b16 v[46:47], v101 offset:1440
    ds_read_b64_tr_b16 v[60:61], v101 offset:4352
    ds_read_b64_tr_b16 v[62:63], v101 offset:4512
    ds_read_b64_tr_b16 v[48:49], v101 offset:1920
    ds_read_b64_tr_b16 v[50:51], v101 offset:2080
    ds_read_b64_tr_b16 v[64:65], v101 offset:4992
    ds_read_b64_tr_b16 v[66:67], v101 offset:5152
    s_waitcnt lgkmcnt(12)
    v_mfma_f32_16x16x32_bf16 v[68:71], v[76:79], v[36:39], v[68:71]
    v_mfma_f32_16x16x32_bf16 v[72:75], v[76:79], v[52:55], v[72:75]
    s_waitcnt lgkmcnt(8)
    v_mfma_f32_16x16x32_bf16 v[68:71], v[76:79], v[40:43], v[68:71]
    v_mfma_f32_16x16x32_bf16 v[72:75], v[76:79], v[56:59], v[72:75]
    s_waitcnt lgkmcnt(4)
    v_mfma_f32_16x16x32_bf16 v[68:71], v[76:79], v[44:47], v[68:71]
    v_mfma_f32_16x16x32_bf16 v[72:75], v[76:79], v[60:63], v[72:75]
    s_waitcnt lgkmcnt(0)
    v_mfma_f32_16x16x32_bf16 v[68:71], v[76:79], v[48:51], v[68:71]
    v_mfma_f32_16x16x32_bf16 v[72:75], v[76:79], v[64:67], v[72:75]
    s_add_u32 s48, s48, 6144
    s_cmp_ge_u32 s48, 30720
    s_cselect_b32 s48, 0, s48
    s_sub_u32 s46, s46, 1
    s_cmp_lg_u32 s46, 0
    s_cbranch_scc1 L_ldloop_53
    s_waitcnt vmcnt(12)
    s_barrier
    v_add_u32 v101, s48, v100
    ds_read_b64_tr_b16 v[36:37], v101 offset:0
    ds_read_b64_tr_b16 v[38:39], v101 offset:160
    ds_read_b64_tr_b16 v[52:53], v101 offset:3072
    ds_read_b64_tr_b16 v[54:55], v101 offset:3232
    ds_read_b64_tr_b16 v[40:41], v101 offset:640
    ds_read_b64_tr_b16 v[42:43], v101 offset:800
    ds_read_b64_tr_b16 v[56:57], v101 offset:3712
    ds_read_b64_tr_b16 v[58:59], v101 offset:3872
    ds_read_b64_tr_b16 v[44:45], v101 offset:1280
    ds_read_b64_tr_b16 v[46:47], v101 offset:1440
    ds_read_b64_tr_b16 v[60:61], v101 offset:4352
    ds_read_b64_tr_b16 v[62:63], v101 offset:4512
    ds_read_b64_tr_b16 v[48:49], v101 offset:1920
    ds_read_b64_tr_b16 v[50:51], v101 offset:2080
    ds_read_b64_tr_b16 v[64:65], v101 offset:4992
    ds_read_b64_tr_b16 v[66:67], v101 offset:5152
    s_waitcnt lgkmcnt(12)
    v_mfma_f32_16x16x32_bf16 v[68:71], v[76:79], v[36:39], v[68:71]
    v_mfma_f32_16x16x32_bf16 v[72:75], v[76:79], v[52:55], v[72:75]
    s_waitcnt lgkmcnt(8)
    v_mfma_f32_16x16x32_bf16 v[68:71], v[76:79], v[40:43], v[68:71]
    v_mfma_f32_16x16x32_bf16 v[72:75], v[76:79], v[56:59], v[72:75]
    s_waitcnt lgkmcnt(4)
    v_mfma_f32_16x16x32_bf16 v[68:71], v[76:79], v[44:47], v[68:71]
    v_mfma_f32_16x16x32_bf16 v[72:75], v[76:79], v[60:63], v[72:75]
    s_waitcnt lgkmcnt(0)
    v_mfma_f32_16x16x32_bf16 v[68:71], v[76:79], v[48:51], v[68:71]
    v_mfma_f32_16x16x32_bf16 v[72:75], v[76:79], v[64:67], v[72:75]
    s_add_u32 s48, s48, 6144
    s_cmp_ge_u32 s48, 30720
    s_cselect_b32 s48, 0, s48
    s_waitcnt vmcnt(6)
    s_barrier
    v_add_u32 v101, s48, v100
    ds_read_b64_tr_b16 v[36:37], v101 offset:0
    ds_read_b64_tr_b16 v[38:39], v101 offset:160
    ds_read_b64_tr_b16 v[52:53], v101 offset:3072
    ds_read_b64_tr_b16 v[54:55], v101 offset:3232
    ds_read_b64_tr_b16 v[40:41], v101 offset:640
    ds_read_b64_tr_b16 v[42:43], v101 offset:800
    ds_read_b64_tr_b16 v[56:57], v101 offset:3712
    ds_read_b64_tr_b16 v[58:59], v101 offset:3872
    ds_read_b64_tr_b16 v[44:45], v101 offset:1280
    ds_read_b64_tr_b16 v[46:47], v101 offset:1440
    ds_read_b64_tr_b16 v[60:61], v101 offset:4352
    ds_read_b64_tr_b16 v[62:63], v101 offset:4512
    ds_read_b64_tr_b16 v[48:49], v101 offset:1920
    ds_read_b64_tr_b16 v[50:51], v101 offset:2080
    ds_read_b64_tr_b16 v[64:65], v101 offset:4992
    ds_read_b64_tr_b16 v[66:67], v101 offset:5152
    s_waitcnt lgkmcnt(12)
    v_mfma_f32_16x16x32_bf16 v[68:71], v[76:79], v[36:39], v[68:71]
    v_mfma_f32_16x16x32_bf16 v[72:75], v[76:79], v[52:55], v[72:75]
    s_waitcnt lgkmcnt(8)
    v_mfma_f32_16x16x32_bf16 v[68:71], v[76:79], v[40:43], v[68:71]
    v_mfma_f32_16x16x32_bf16 v[72:75], v[76:79], v[56:59], v[72:75]
    s_waitcnt lgkmcnt(4)
    v_mfma_f32_16x16x32_bf16 v[68:71], v[76:79], v[44:47], v[68:71]
    v_mfma_f32_16x16x32_bf16 v[72:75], v[76:79], v[60:63], v[72:75]
    s_waitcnt lgkmcnt(0)
    v_mfma_f32_16x16x32_bf16 v[68:71], v[76:79], v[48:51], v[68:71]
    v_mfma_f32_16x16x32_bf16 v[72:75], v[76:79], v[64:67], v[72:75]
    s_add_u32 s48, s48, 6144
    s_cmp_ge_u32 s48, 30720
    s_cselect_b32 s48, 0, s48
    s_waitcnt vmcnt(0)
    s_barrier
    v_add_u32 v101, s48, v100
    ds_read_b64_tr_b16 v[36:37], v101 offset:0
    ds_read_b64_tr_b16 v[38:39], v101 offset:160
    ds_read_b64_tr_b16 v[52:53], v101 offset:3072
    ds_read_b64_tr_b16 v[54:55], v101 offset:3232
    ds_read_b64_tr_b16 v[40:41], v101 offset:640
    ds_read_b64_tr_b16 v[42:43], v101 offset:800
    ds_read_b64_tr_b16 v[56:57], v101 offset:3712
    ds_read_b64_tr_b16 v[58:59], v101 offset:3872
    ds_read_b64_tr_b16 v[44:45], v101 offset:1280
    ds_read_b64_tr_b16 v[46:47], v101 offset:1440
    ds_read_b64_tr_b16 v[60:61], v101 offset:4352
    ds_read_b64_tr_b16 v[62:63], v101 offset:4512
    ds_read_b64_tr_b16 v[48:49], v101 offset:1920
    ds_read_b64_tr_b16 v[50:51], v101 offset:2080
    ds_read_b64_tr_b16 v[64:65], v101 offset:4992
    ds_read_b64_tr_b16 v[66:67], v101 offset:5152
    s_waitcnt lgkmcnt(12)
    v_mfma_f32_16x16x32_bf16 v[68:71], v[76:79], v[36:39], v[68:71]
    v_mfma_f32_16x16x32_bf16 v[72:75], v[76:79], v[52:55], v[72:75]
    s_waitcnt lgkmcnt(8)
    v_mfma_f32_16x16x32_bf16 v[68:71], v[76:79], v[40:43], v[68:71]
    v_mfma_f32_16x16x32_bf16 v[72:75], v[76:79], v[56:59], v[72:75]
    s_waitcnt lgkmcnt(4)
    v_mfma_f32_16x16x32_bf16 v[68:71], v[76:79], v[44:47], v[68:71]
    v_mfma_f32_16x16x32_bf16 v[72:75], v[76:79], v[60:63], v[72:75]
    s_waitcnt lgkmcnt(0)
    v_mfma_f32_16x16x32_bf16 v[68:71], v[76:79], v[48:51], v[68:71]
    v_mfma_f32_16x16x32_bf16 v[72:75], v[76:79], v[64:67], v[72:75]
    s_add_u32 s48, s48, 6144
    s_cmp_ge_u32 s48, 30720
    s_cselect_b32 s48, 0, s48
    s_nop 7
    v_and_b32 v103, 31, v1
    v_lshlrev_b32 v103, 2, v103
    v_add_u32 v103, 92160, v103
    ds_write_b32 v103, v68 offset:0
    ds_write_b32 v103, v72 offset:128
    s_waitcnt lgkmcnt(0)
    s_barrier
    s_endpgm
L_compute_48:
    s_mul_i32 s60, s40, 20480
    s_add_u32 s60, s60, 30720
    v_lshrrev_b32 v103, 5, v1
    v_mul_u32_u24 v100, 320, v103
    v_bfe_u32 v103, v1, 4, 1
    v_mul_u32_u24 v103, 32, v103
    v_add_u32 v100, v100, v103
    v_bfe_u32 v103, v1, 2, 2
    v_mul_u32_u24 v104, 40, v103
    v_add_u32 v100, v100, v104
    v_and_b32 v104, 3, v1
    v_lshl_add_u32 v100, v104, 3, v100
    v_lshrrev_b32 v103, 5, v1
    v_bfe_u32 v104, v1, 1, 3
    v_xor_b32 v103, v103, v104
    v_and_b32 v104, 31, v1
    v_lshlrev_b32 v104, 7, v104
    v_lshl_add_u32 v103, v103, 4, v104
    v_add_u32 v76, s60, v103
    v_lshrrev_b32 v103, 5, v1
    v_bfe_u32 v104, v1, 1, 3
    v_xor_b32 v103, v103, v104
    v_xor_b32 v103, 2, v103
    v_and_b32 v104, 31, v1
    v_lshlrev_b32 v104, 7, v104
    v_lshl_add_u32 v103, v103, 4, v104
    v_add_u32 v77, s60, v103
    v_lshrrev_b32 v103, 5, v1
    v_bfe_u32 v104, v1, 1, 3
    v_xor_b32 v103, v103, v104
    v_xor_b32 v103, 4, v103
    v_and_b32 v104, 31, v1
    v_lshlrev_b32 v104, 7, v104
    v_lshl_add_u32 v103, v103, 4, v104
    v_add_u32 v78, s60, v103
    v_lshrrev_b32 v103, 5, v1
    v_bfe_u32 v104, v1, 1, 3
    v_xor_b32 v103, v103, v104
    v_xor_b32 v103, 6, v103
    v_and_b32 v104, 31, v1
    v_lshlrev_b32 v104, 7, v104
    v_lshl_add_u32 v103, v103, 4, v104
    v_add_u32 v79, s60, v103
    v_mov_b32 v36, 0
    v_mov_b32 v37, 0
    v_mov_b32 v38, 0
    v_mov_b32 v39, 0
    v_mov_b32 v40, 0
    v_mov_b32 v41, 0
    v_mov_b32 v42, 0
    v_mov_b32 v43, 0
    v_mov_b32 v44, 0
    v_mov_b32 v45, 0
    v_mov_b32 v46, 0
    v_mov_b32 v47, 0
    v_mov_b32 v48, 0
    v_mov_b32 v49, 0
    v_mov_b32 v50, 0
    v_mov_b32 v51, 0
    v_mov_b32 v52, 0
    v_mov_b32 v53, 0
    v_mov_b32 v54, 0
    v_mov_b32 v55, 0
    v_mov_b32 v56, 0
    v_mov_b32 v57, 0
    v_mov_b32 v58, 0
    v_mov_b32 v59, 0
    v_mov_b32 v60, 0
    v_mov_b32 v61, 0
    v_mov_b32 v62, 0
    v_mov_b32 v63, 0
    v_mov_b32 v64, 0
    v_mov_b32 v65, 0
    v_mov_b32 v66, 0
    v_mov_b32 v67, 0
    s_waitcnt lgkmcnt(0)
    s_mul_i32 s50, s56, 4096
    s_add_u32 s50, s50, 2621440
    s_add_u32 s24, s86, s50
    s_addc_u32 s25, s87, 0
    s_and_b32 s25, s25, 0xffff
    s_mov_b32 s26, 4096
    s_mov_b32 s27, 0x00020000
    s_cmp_ge_u32 s56, 64
    s_cselect_b32 s26, 0, s26
    s_cmp_lg_u32 s40, 0
    s_cbranch_scc1 L_nozero_54
    s_add_u32 s4, s86, 17219584
    s_addc_u32 s5, s87, 0
    s_and_b32 s5, s5, 0xffff
    s_mov_b32 s6, 65536
    s_mov_b32 s7, 0x00020000
    v_lshlrev_b32 v8, 2, v1
    v_mov_b32 v9, 0
    s_lshl_b32 s50, s2, 8
    buffer_store_dword v9, v8, s[4:7], s50 offen
    s_nop 1
L_nozero_54:
    v_lshrrev_b32 v8, 2, v1
    v_xor_b32 v8, v8, v1
    v_bfe_u32 v8, v8, 2, 1
    v_cmp_eq_u32 vcc, 0, v8
    v_mov_b32 v9, 0x3f803f80
    s_nop 0
    v_cndmask_b32 v4, 0, v9, vcc
    v_cndmask_b32 v5, 0, v9, vcc
    v_cndmask_b32 v6, 0, v9, vcc
    v_cndmask_b32 v7, 0, v9, vcc
    v_mov_b32 v8, 0
    v_mov_b32 v9, 0
    v_mov_b32 v10, 0
    v_mov_b32 v11, 0
    v_mov_b32 v12, 0
    v_mov_b32 v13, 0
    v_mov_b32 v14, 0
    v_mov_b32 v15, 0
    v_mov_b32 v16, 0
    v_mov_b32 v17, 0
    v_mov_b32 v18, 0
    v_mov_b32 v19, 0
    v_mov_b32 v20, 0
    v_mov_b32 v21, 0
    v_mov_b32 v22, 0
    v_mov_b32 v23, 0
    v_mov_b32 v24, 0
    v_mov_b32 v25, 0
    v_mov_b32 v26, 0
    v_mov_b32 v27, 0
    v_add_u32 v101, 0, v100
    s_mov_b32 s48, 0
    s_barrier
    ds_read_b128 v[68:71], v76 offset:0
    ds_read_b64_tr_b16 v[84:85], v101 offset:0
    ds_read_b64_tr_b16 v[86:87], v101 offset:160
    ds_read_b64_tr_b16 v[88:89], v101 offset:3072
    ds_read_b64_tr_b16 v[90:91], v101 offset:3232
    s_waitcnt lgkmcnt(2)
    v_mfma_f32_32x32x16_bf16 v[36:51], v[84:87], v[68:71], v[36:51]
    ds_read_b128 v[72:75], v77 offset:0
    ds_read_b64_tr_b16 v[92:93], v101 offset:640
    ds_read_b64_tr_b16 v[94:95], v101 offset:800
    s_waitcnt lgkmcnt(3)
    v_mfma_f32_32x32x16_bf16 v[52:67], v[68:71], v[88:91], v[52:67]
    ds_read_b64_tr_b16 v[96:97], v101 offset:3712
    ds_read_b64_tr_b16 v[98:99], v101 offset:3872
    v_mfma_f32_16x16x32_bf16 v[8:11], v[4:7], v[68:71], v[8:11]
    v_mfma_f32_32x32x16_bf16 v[12:27], v[68:71], v[68:71], v[12:27]
    s_waitcnt lgkmcnt(2)
    v_mfma_f32_32x32x16_bf16 v[36:51], v[92:95], v[72:75], v[36:51]
    ds_read_b128 v[68:71], v78 offset:0
    ds_read_b64_tr_b16 v[84:85], v101 offset:1280
    ds_read_b64_tr_b16 v[86:87], v101 offset:1440
    s_waitcnt lgkmcnt(3)
    v_mfma_f32_32x32x16_bf16 v[52:67], v[72:75], v[96:99], v[52:67]
    ds_read_b64_tr_b16 v[88:89], v101 offset:4352
    ds_read_b64_tr_b16 v[90:91], v101 offset:4512
    v_mfma_f32_16x16x32_bf16 v[8:11], v[4:7], v[72:75], v[8:11]
    v_mfma_f32_32x32x16_bf16 v[12:27], v[72:75], v[72:75], v[12:27]
    s_waitcnt lgkmcnt(2)
    v_mfma_f32_32x32x16_bf16 v[36:51], v[84:87], v[68:71], v[36:51]
    ds_read_b128 v[72:75], v79 offset:0
    ds_read_b64_tr_b16 v[92:93], v101 offset:1920
    ds_read_b64_tr_b16 v[94:95], v101 offset:2080
    s_waitcnt lgkmcnt(3)
    v_mfma_f32_32x32x16_bf16 v[52:67], v[68:71], v[88:91], v[52:67]
    ds_read_b64_tr_b16 v[96:97], v101 offset:4992
    ds_read_b64_tr_b16 v[98:99], v101 offset:5152
    v_mfma_f32_16x16x32_bf16 v[8:11], v[4:7], v[68:71], v[8:11]
    v_mfma_f32_32x32x16_bf16 v[12:27], v[68:71], v[68:71], v[12:27]
    s_waitcnt lgkmcnt(2)
    v_mfma_f32_32x32x16_bf16 v[36:51], v[92:95], v[72:75], v[36:51]
    s_add_u32 s48, s48, 6144
    s_cmp_ge_u32 s48, 30720
    s_cselect_b32 s48, 0, s48
    v_add_u32 v102, s48, v100
    s_barrier
    ds_read_b128 v[68:71], v76 offset:4096
    ds_read_b64_tr_b16 v[84:85], v102 offset:0
    ds_read_b64_tr_b16 v[86:87], v102 offset:160
    s_waitcnt lgkmcnt(3)
    v_mfma_f32_32x32x16_bf16 v[52:67], v[72:75], v[96:99], v[52:67]
    ds_read_b64_tr_b16 v[88:89], v102 offset:3072
    ds_read_b64_tr_b16 v[90:91], v102 offset:3232
    v_mfma_f32_16x16x32_bf16 v[8:11], v[4:7], v[72:75], v[8:11]
    v_mfma_f32_32x32x16_bf16 v[12:27], v[72:75], v[72:75], v[12:27]
    s_waitcnt lgkmcnt(2)
    v_mfma_f32_32x32x16_bf16 v[36:51], v[84:87], v[68:71], v[36:51]
    ds_read_b128 v[72:75], v77 offset:4096
    ds_read_b64_tr_b16 v[92:93], v102 offset:640
    ds_read_b64_tr_b16 v[94:95], v102 offset:800
    s_waitcnt lgkmcnt(3)
    v_mfma_f32_32x32x16_bf16 v[52:67], v[68:71], v[88:91], v[52:67]
    ds_read_b64_tr_b16 v[96:97], v102 offset:3712
    ds_read_b64_tr_b16 v[98:99], v102 offset:3872
    v_mfma_f32_16x16x32_bf16 v[8:11], v[4:7], v[68:71], v[8:11]
    v_mfma_f32_32x32x16_bf16 v[12:27], v[68:71], v[68:71], v[12:27]
    s_waitcnt lgkmcnt(2)
    v_mfma_f32_32x32x16_bf16 v[36:51], v[92:95], v[72:75], v[36:51]
    ds_read_b128 v[68:71], v78 offset:4096
    ds_read_b64_tr_b16 v[84:85], v102 offset:1280
    ds_read_b64_tr_b16 v[86:87], v102 offset:1440
    s_waitcnt lgkmcnt(3)
    v_mfma_f32_32x32x16_bf16 v[52:67], v[72:75], v[96:99], v[52:67]
    ds_read_b64_tr_b16 v[88:89], v102 offset:4352
    ds_read_b64_tr_b16 v[90:91], v102 offset:4512
    v_mfma_f32_16x16x32_bf16 v[8:11], v[4:7], v[72:75], v[8:11]
    v_mfma_f32_32x32x16_bf16 v[12:27], v[72:75], v[72:75], v[12:27]
    s_waitcnt lgkmcnt(2)
    v_mfma_f32_32x32x16_bf16 v[36:51], v[84:87], v[68:71], v[36:51]
    ds_read_b128 v[72:75], v79 offset:4096
    ds_read_b64_tr_b16 v[92:93], v102 offset:1920
    ds_read_b64_tr_b16 v[94:95], v102 offset:2080
    s_waitcnt lgkmcnt(3)
    v_mfma_f32_32x32x16_bf16 v[52:67], v[68:71], v[88:91], v[52:67]
    ds_read_b64_tr_b16 v[96:97], v102 offset:4992
    ds_read_b64_tr_b16 v[98:99], v102 offset:5152
    v_mfma_f32_16x16x32_bf16 v[8:11], v[4:7], v[68:71], v[8:11]
    v_mfma_f32_32x32x16_bf16 v[12:27], v[68:71], v[68:71], v[12:27]
    s_waitcnt lgkmcnt(2)
    v_mfma_f32_32x32x16_bf16 v[36:51], v[92:95], v[72:75], v[36:51]
    s_add_u32 s48, s48, 6144
    s_cmp_ge_u32 s48, 30720
    s_cselect_b32 s48, 0, s48
    v_add_u32 v101, s48, v100
    s_barrier
    ds_read_b128 v[68:71], v76 offset:8192
    ds_read_b64_tr_b16 v[84:85], v101 offset:0
    ds_read_b64_tr_b16 v[86:87], v101 offset:160
    s_waitcnt lgkmcnt(3)
    v_mfma_f32_32x32x16_bf16 v[52:67], v[72:75], v[96:99], v[52:67]
    ds_read_b64_tr_b16 v[88:89], v101 offset:3072
    ds_read_b64_tr_b16 v[90:91], v101 offset:3232
    v_mfma_f32_16x16x32_bf16 v[8:11], v[4:7], v[72:75], v[8:11]
    v_mfma_f32_32x32x16_bf16 v[12:27], v[72:75], v[72:75], v[12:27]
    s_waitcnt lgkmcnt(2)
    v_mfma_f32_32x32x16_bf16 v[36:51], v[84:87], v[68:71], v[36:51]
    ds_read_b128 v[72:75], v77 offset:8192
    ds_read_b64_tr_b16 v[92:93], v101 offset:640
    ds_read_b64_tr_b16 v[94:95], v101 offset:800
    s_waitcnt lgkmcnt(3)
    v_mfma_f32_32x32x16_bf16 v[52:67], v[68:71], v[88:91], v[52:67]
    ds_read_b64_tr_b16 v[96:97], v101 offset:3712
    ds_read_b64_tr_b16 v[98:99], v101 offset:3872
    v_mfma_f32_16x16x32_bf16 v[8:11], v[4:7], v[68:71], v[8:11]
    v_mfma_f32_32x32x16_bf16 v[12:27], v[68:71], v[68:71], v[12:27]
    s_waitcnt lgkmcnt(2)
    v_mfma_f32_32x32x16_bf16 v[36:51], v[92:95], v[72:75], v[36:51]
    ds_read_b128 v[68:71], v78 offset:8192
    ds_read_b64_tr_b16 v[84:85], v101 offset:1280
    ds_read_b64_tr_b16 v[86:87], v101 offset:1440
    s_waitcnt lgkmcnt(3)
    v_mfma_f32_32x32x16_bf16 v[52:67], v[72:75], v[96:99], v[52:67]
    ds_read_b64_tr_b16 v[88:89], v101 offset:4352
    ds_read_b64_tr_b16 v[90:91], v101 offset:4512
    v_mfma_f32_16x16x32_bf16 v[8:11], v[4:7], v[72:75], v[8:11]
    v_mfma_f32_32x32x16_bf16 v[12:27], v[72:75], v[72:75], v[12:27]
    s_waitcnt lgkmcnt(2)
    v_mfma_f32_32x32x16_bf16 v[36:51], v[84:87], v[68:71], v[36:51]
    ds_read_b128 v[72:75], v79 offset:8192
    ds_read_b64_tr_b16 v[92:93], v101 offset:1920
    ds_read_b64_tr_b16 v[94:95], v101 offset:2080
    s_waitcnt lgkmcnt(3)
    v_mfma_f32_32x32x16_bf16 v[52:67], v[68:71], v[88:91], v[52:67]
    ds_read_b64_tr_b16 v[96:97], v101 offset:4992
    ds_read_b64_tr_b16 v[98:99], v101 offset:5152
    v_mfma_f32_16x16x32_bf16 v[8:11], v[4:7], v[68:71], v[8:11]
    v_mfma_f32_32x32x16_bf16 v[12:27], v[68:71], v[68:71], v[12:27]
    s_waitcnt lgkmcnt(2)
    v_mfma_f32_32x32x16_bf16 v[36:51], v[92:95], v[72:75], v[36:51]
    s_add_u32 s48, s48, 6144
    s_cmp_ge_u32 s48, 30720
    s_cselect_b32 s48, 0, s48
    v_add_u32 v102, s48, v100
    s_barrier
    ds_read_b128 v[68:71], v76 offset:12288
    ds_read_b64_tr_b16 v[84:85], v102 offset:0
    ds_read_b64_tr_b16 v[86:87], v102 offset:160
    s_waitcnt lgkmcnt(3)
    v_mfma_f32_32x32x16_bf16 v[52:67], v[72:75], v[96:99], v[52:67]
    ds_read_b64_tr_b16 v[88:89], v102 offset:3072
    ds_read_b64_tr_b16 v[90:91], v102 offset:3232
    v_mfma_f32_16x16x32_bf16 v[8:11], v[4:7], v[72:75], v[8:11]
    v_mfma_f32_32x32x16_bf16 v[12:27], v[72:75], v[72:75], v[12:27]
    s_waitcnt lgkmcnt(2)
    v_mfma_f32_32x32x16_bf16 v[36:51], v[84:87], v[68:71], v[36:51]
    ds_read_b128 v[72:75], v77 offset:12288
    ds_read_b64_tr_b16 v[92:93], v102 offset:640
    ds_read_b64_tr_b16 v[94:95], v102 offset:800
    s_waitcnt lgkmcnt(3)
    v_mfma_f32_32x32x16_bf16 v[52:67], v[68:71], v[88:91], v[52:67]
    ds_read_b64_tr_b16 v[96:97], v102 offset:3712
    ds_read_b64_tr_b16 v[98:99], v102 offset:3872
    v_mfma_f32_16x16x32_bf16 v[8:11], v[4:7], v[68:71], v[8:11]
    v_mfma_f32_32x32x16_bf16 v[12:27], v[68:71], v[68:71], v[12:27]
    s_waitcnt lgkmcnt(2)
    v_mfma_f32_32x32x16_bf16 v[36:51], v[92:95], v[72:75], v[36:51]
    ds_read_b128 v[68:71], v78 offset:12288
    ds_read_b64_tr_b16 v[84:85], v102 offset:1280
    ds_read_b64_tr_b16 v[86:87], v102 offset:1440
    s_waitcnt lgkmcnt(3)
    v_mfma_f32_32x32x16_bf16 v[52:67], v[72:75], v[96:99], v[52:67]
    ds_read_b64_tr_b16 v[88:89], v102 offset:4352
    ds_read_b64_tr_b16 v[90:91], v102 offset:4512
    v_mfma_f32_16x16x32_bf16 v[8:11], v[4:7], v[72:75], v[8:11]
    v_mfma_f32_32x32x16_bf16 v[12:27], v[72:75], v[72:75], v[12:27]
    s_waitcnt lgkmcnt(2)
    v_mfma_f32_32x32x16_bf16 v[36:51], v[84:87], v[68:71], v[36:51]
    ds_read_b128 v[72:75], v79 offset:12288
    ds_read_b64_tr_b16 v[92:93], v102 offset:1920
    ds_read_b64_tr_b16 v[94:95], v102 offset:2080
    s_waitcnt lgkmcnt(3)
    v_mfma_f32_32x32x16_bf16 v[52:67], v[68:71], v[88:91], v[52:67]
    ds_read_b64_tr_b16 v[96:97], v102 offset:4992
    ds_read_b64_tr_b16 v[98:99], v102 offset:5152
    v_mfma_f32_16x16x32_bf16 v[8:11], v[4:7], v[68:71], v[8:11]
    v_mfma_f32_32x32x16_bf16 v[12:27], v[68:71], v[68:71], v[12:27]
    s_waitcnt lgkmcnt(2)
    v_mfma_f32_32x32x16_bf16 v[36:51], v[92:95], v[72:75], v[36:51]
    s_add_u32 s48, s48, 6144
    s_cmp_ge_u32 s48, 30720
    s_cselect_b32 s48, 0, s48
    v_add_u32 v101, s48, v100
    s_barrier
    ds_read_b128 v[68:71], v76 offset:16384
    ds_read_b64_tr_b16 v[84:85], v101 offset:0
    ds_read_b64_tr_b16 v[86:87], v101 offset:160
    s_waitcnt lgkmcnt(3)
    v_mfma_f32_32x32x16_bf16 v[52:67], v[72:75], v[96:99], v[52:67]
    ds_read_b64_tr_b16 v[88:89], v101 offset:3072
    ds_read_b64_tr_b16 v[90:91], v101 offset:3232
    v_mfma_f32_16x16x32_bf16 v[8:11], v[4:7], v[72:75], v[8:11]
    v_mfma_f32_32x32x16_bf16 v[12:27], v[72:75], v[72:75], v[12:27]
    s_waitcnt lgkmcnt(2)
    v_mfma_f32_32x32x16_bf16 v[36:51], v[84:87], v[68:71], v[36:51]
    ds_read_b128 v[72:75], v77 offset:16384
    ds_read_b64_tr_b16 v[92:93], v101 offset:640
    ds_read_b64_tr_b16 v[94:95], v101 offset:800
    s_waitcnt lgkmcnt(3)
    v_mfma_f32_32x32x16_bf16 v[52:67], v[68:71], v[88:91], v[52:67]
    ds_read_b64_tr_b16 v[96:97], v101 offset:3712
    ds_read_b64_tr_b16 v[98:99], v101 offset:3872
    v_mfma_f32_16x16x32_bf16 v[8:11], v[4:7], v[68:71], v[8:11]
    v_mfma_f32_32x32x16_bf16 v[12:27], v[68:71], v[68:71], v[12:27]
    s_waitcnt lgkmcnt(2)
    v_mfma_f32_32x32x16_bf16 v[36:51], v[92:95], v[72:75], v[36:51]
    ds_read_b128 v[68:71], v78 offset:16384
    ds_read_b64_tr_b16 v[84:85], v101 offset:1280
    ds_read_b64_tr_b16 v[86:87], v101 offset:1440
    s_waitcnt lgkmcnt(3)
    v_mfma_f32_32x32x16_bf16 v[52:67], v[72:75], v[96:99], v[52:67]
    ds_read_b64_tr_b16 v[88:89], v101 offset:4352
    ds_read_b64_tr_b16 v[90:91], v101 offset:4512
    v_mfma_f32_16x16x32_bf16 v[8:11], v[4:7], v[72:75], v[8:11]
    v_mfma_f32_32x32x16_bf16 v[12:27], v[72:75], v[72:75], v[12:27]
    s_waitcnt lgkmcnt(2)
    v_mfma_f32_32x32x16_bf16 v[36:51], v[84:87], v[68:71], v[36:51]
    ds_read_b128 v[72:75], v79 offset:16384
    ds_read_b64_tr_b16 v[92:93], v101 offset:1920
    ds_read_b64_tr_b16 v[94:95], v101 offset:2080
    s_waitcnt lgkmcnt(3)
    v_mfma_f32_32x32x16_bf16 v[52:67], v[68:71], v[88:91], v[52:67]
    ds_read_b64_tr_b16 v[96:97], v101 offset:4992
    ds_read_b64_tr_b16 v[98:99], v101 offset:5152
    v_mfma_f32_16x16x32_bf16 v[8:11], v[4:7], v[68:71], v[8:11]
    v_mfma_f32_32x32x16_bf16 v[12:27], v[68:71], v[68:71], v[12:27]
    s_waitcnt lgkmcnt(2)
    v_mfma_f32_32x32x16_bf16 v[36:51], v[92:95], v[72:75], v[36:51]
    s_add_u32 s48, s48, 6144
    s_cmp_ge_u32 s48, 30720
    s_cselect_b32 s48, 0, s48
    v_add_u32 v102, s48, v100
    s_barrier
    ds_read_b128 v[68:71], v76 offset:0
    ds_read_b64_tr_b16 v[84:85], v102 offset:0
    ds_read_b64_tr_b16 v[86:87], v102 offset:160
    s_waitcnt lgkmcnt(3)
    v_mfma_f32_32x32x16_bf16 v[52:67], v[72:75], v[96:99], v[52:67]
    ds_read_b64_tr_b16 v[88:89], v102 offset:3072
    ds_read_b64_tr_b16 v[90:91], v102 offset:3232
    v_mfma_f32_16x16x32_bf16 v[8:11], v[4:7], v[72:75], v[8:11]
    v_mfma_f32_32x32x16_bf16 v[12:27], v[72:75], v[72:75], v[12:27]
    s_waitcnt lgkmcnt(2)
    v_mfma_f32_32x32x16_bf16 v[36:51], v[84:87], v[68:71], v[36:51]
    ds_read_b128 v[72:75], v77 offset:0
    ds_read_b64_tr_b16 v[92:93], v102 offset:640
    ds_read_b64_tr_b16 v[94:95], v102 offset:800
    s_waitcnt lgkmcnt(3)
    v_mfma_f32_32x32x16_bf16 v[52:67], v[68:71], v[88:91], v[52:67]
    ds_read_b64_tr_b16 v[96:97], v102 offset:3712
    ds_read_b64_tr_b16 v[98:99], v102 offset:3872
    v_mfma_f32_16x16x32_bf16 v[8:11], v[4:7], v[68:71], v[8:11]
    v_mfma_f32_32x32x16_bf16 v[12:27], v[68:71], v[68:71], v[12:27]
    s_waitcnt lgkmcnt(2)
    v_mfma_f32_32x32x16_bf16 v[36:51], v[92:95], v[72:75], v[36:51]
    ds_read_b128 v[68:71], v78 offset:0
    ds_read_b64_tr_b16 v[84:85], v102 offset:1280
    ds_read_b64_tr_b16 v[86:87], v102 offset:1440
    s_waitcnt lgkmcnt(3)
    v_mfma_f32_32x32x16_bf16 v[52:67], v[72:75], v[96:99], v[52:67]
    ds_read_b64_tr_b16 v[88:89], v102 offset:4352
    ds_read_b64_tr_b16 v[90:91], v102 offset:4512
    v_mfma_f32_16x16x32_bf16 v[8:11], v[4:7], v[72:75], v[8:11]
    v_mfma_f32_32x32x16_bf16 v[12:27], v[72:75], v[72:75], v[12:27]
    s_waitcnt lgkmcnt(2)
    v_mfma_f32_32x32x16_bf16 v[36:51], v[84:87], v[68:71], v[36:51]
    ds_read_b128 v[72:75], v79 offset:0
    ds_read_b64_tr_b16 v[92:93], v102 offset:1920
    ds_read_b64_tr_b16 v[94:95], v102 offset:2080
    s_waitcnt lgkmcnt(3)
    v_mfma_f32_32x32x16_bf16 v[52:67], v[68:71], v[88:91], v[52:67]
    ds_read_b64_tr_b16 v[96:97], v102 offset:4992
    ds_read_b64_tr_b16 v[98:99], v102 offset:5152
    v_mfma_f32_16x16x32_bf16 v[8:11], v[4:7], v[68:71], v[8:11]
    v_mfma_f32_32x32x16_bf16 v[12:27], v[68:71], v[68:71], v[12:27]
    s_waitcnt lgkmcnt(2)
    v_mfma_f32_32x32x16_bf16 v[36:51], v[92:95], v[72:75], v[36:51]
    s_add_u32 s48, s48, 6144
    s_cmp_ge_u32 s48, 30720
    s_cselect_b32 s48, 0, s48
    v_add_u32 v101, s48, v100
    s_barrier
    ds_read_b128 v[68:71], v76 offset:4096
    ds_read_b64_tr_b16 v[84:85], v101 offset:0
    ds_read_b64_tr_b16 v[86:87], v101 offset:160
    s_waitcnt lgkmcnt(3)
    v_mfma_f32_32x32x16_bf16 v[52:67], v[72:75], v[96:99], v[52:67]
    ds_read_b64_tr_b16 v[88:89], v101 offset:3072
    ds_read_b64_tr_b16 v[90:91], v101 offset:3232
    v_mfma_f32_16x16x32_bf16 v[8:11], v[4:7], v[72:75], v[8:11]
    v_mfma_f32_32x32x16_bf16 v[12:27], v[72:75], v[72:75], v[12:27]
    s_waitcnt lgkmcnt(2)
    v_mfma_f32_32x32x16_bf16 v[36:51], v[84:87], v[68:71], v[36:51]
    ds_read_b128 v[72:75], v77 offset:4096
    ds_read_b64_tr_b16 v[92:93], v101 offset:640
    ds_read_b64_tr_b16 v[94:95], v101 offset:800
    s_waitcnt lgkmcnt(3)
    v_mfma_f32_32x32x16_bf16 v[52:67], v[68:71], v[88:91], v[52:67]
    ds_read_b64_tr_b16 v[96:97], v101 offset:3712
    ds_read_b64_tr_b16 v[98:99], v101 offset:3872
    v_mfma_f32_16x16x32_bf16 v[8:11], v[4:7], v[68:71], v[8:11]
    v_mfma_f32_32x32x16_bf16 v[12:27], v[68:71], v[68:71], v[12:27]
    s_waitcnt lgkmcnt(2)
    v_mfma_f32_32x32x16_bf16 v[36:51], v[92:95], v[72:75], v[36:51]
    ds_read_b128 v[68:71], v78 offset:4096
    ds_read_b64_tr_b16 v[84:85], v101 offset:1280
    ds_read_b64_tr_b16 v[86:87], v101 offset:1440
    s_waitcnt lgkmcnt(3)
    v_mfma_f32_32x32x16_bf16 v[52:67], v[72:75], v[96:99], v[52:67]
    ds_read_b64_tr_b16 v[88:89], v101 offset:4352
    ds_read_b64_tr_b16 v[90:91], v101 offset:4512
    v_mfma_f32_16x16x32_bf16 v[8:11], v[4:7], v[72:75], v[8:11]
    v_mfma_f32_32x32x16_bf16 v[12:27], v[72:75], v[72:75], v[12:27]
    s_waitcnt lgkmcnt(2)
    v_mfma_f32_32x32x16_bf16 v[36:51], v[84:87], v[68:71], v[36:51]
    ds_read_b128 v[72:75], v79 offset:4096
    ds_read_b64_tr_b16 v[92:93], v101 offset:1920
    ds_read_b64_tr_b16 v[94:95], v101 offset:2080
    s_waitcnt lgkmcnt(3)
    v_mfma_f32_32x32x16_bf16 v[52:67], v[68:71], v[88:91], v[52:67]
    ds_read_b64_tr_b16 v[96:97], v101 offset:4992
    ds_read_b64_tr_b16 v[98:99], v101 offset:5152
    v_mfma_f32_16x16x32_bf16 v[8:11], v[4:7], v[68:71], v[8:11]
    v_mfma_f32_32x32x16_bf16 v[12:27], v[68:71], v[68:71], v[12:27]
    s_waitcnt lgkmcnt(2)
    v_mfma_f32_32x32x16_bf16 v[36:51], v[92:95], v[72:75], v[36:51]
    s_add_u32 s48, s48, 6144
    s_cmp_ge_u32 s48, 30720
    s_cselect_b32 s48, 0, s48
    v_add_u32 v102, s48, v100
    s_barrier
    ds_read_b128 v[68:71], v76 offset:8192
    ds_read_b64_tr_b16 v[84:85], v102 offset:0
    ds_read_b64_tr_b16 v[86:87], v102 offset:160
    s_waitcnt lgkmcnt(3)
    v_mfma_f32_32x32x16_bf16 v[52:67], v[72:75], v[96:99], v[52:67]
    ds_read_b64_tr_b16 v[88:89], v102 offset:3072
    ds_read_b64_tr_b16 v[90:91], v102 offset:3232
    v_mfma_f32_16x16x32_bf16 v[8:11], v[4:7], v[72:75], v[8:11]
    v_mfma_f32_32x32x16_bf16 v[12:27], v[72:75], v[72:75], v[12:27]
    s_waitcnt lgkmcnt(2)
    v_mfma_f32_32x32x16_bf16 v[36:51], v[84:87], v[68:71], v[36:51]
    ds_read_b128 v[72:75], v77 offset:8192
    ds_read_b64_tr_b16 v[92:93], v102 offset:640
    ds_read_b64_tr_b16 v[94:95], v102 offset:800
    s_waitcnt lgkmcnt(3)
    v_mfma_f32_32x32x16_bf16 v[52:67], v[68:71], v[88:91], v[52:67]
    ds_read_b64_tr_b16 v[96:97], v102 offset:3712
    ds_read_b64_tr_b16 v[98:99], v102 offset:3872
    v_mfma_f32_16x16x32_bf16 v[8:11], v[4:7], v[68:71], v[8:11]
    v_mfma_f32_32x32x16_bf16 v[12:27], v[68:71], v[68:71], v[12:27]
    s_waitcnt lgkmcnt(2)
    v_mfma_f32_32x32x16_bf16 v[36:51], v[92:95], v[72:75], v[36:51]
    ds_read_b128 v[68:71], v78 offset:8192
    ds_read_b64_tr_b16 v[84:85], v102 offset:1280
    ds_read_b64_tr_b16 v[86:87], v102 offset:1440
    s_waitcnt lgkmcnt(3)
    v_mfma_f32_32x32x16_bf16 v[52:67], v[72:75], v[96:99], v[52:67]
    ds_read_b64_tr_b16 v[88:89], v102 offset:4352
    ds_read_b64_tr_b16 v[90:91], v102 offset:4512
    v_mfma_f32_16x16x32_bf16 v[8:11], v[4:7], v[72:75], v[8:11]
    v_mfma_f32_32x32x16_bf16 v[12:27], v[72:75], v[72:75], v[12:27]
    s_waitcnt lgkmcnt(2)
    v_mfma_f32_32x32x16_bf16 v[36:51], v[84:87], v[68:71], v[36:51]
    ds_read_b128 v[72:75], v79 offset:8192
    ds_read_b64_tr_b16 v[92:93], v102 offset:1920
    ds_read_b64_tr_b16 v[94:95], v102 offset:2080
    s_waitcnt lgkmcnt(3)
    v_mfma_f32_32x32x16_bf16 v[52:67], v[68:71], v[88:91], v[52:67]
    ds_read_b64_tr_b16 v[96:97], v102 offset:4992
    ds_read_b64_tr_b16 v[98:99], v102 offset:5152
    v_mfma_f32_16x16x32_bf16 v[8:11], v[4:7], v[68:71], v[8:11]
    v_mfma_f32_32x32x16_bf16 v[12:27], v[68:71], v[68:71], v[12:27]
    s_waitcnt lgkmcnt(2)
    v_mfma_f32_32x32x16_bf16 v[36:51], v[92:95], v[72:75], v[36:51]
    s_add_u32 s48, s48, 6144
    s_cmp_ge_u32 s48, 30720
    s_cselect_b32 s48, 0, s48
    v_add_u32 v101, s48, v100
    s_barrier
    ds_read_b128 v[68:71], v76 offset:12288
    ds_read_b64_tr_b16 v[84:85], v101 offset:0
    ds_read_b64_tr_b16 v[86:87], v101 offset:160
    s_waitcnt lgkmcnt(3)
    v_mfma_f32_32x32x16_bf16 v[52:67], v[72:75], v[96:99], v[52:67]
    ds_read_b64_tr_b16 v[88:89], v101 offset:3072
    ds_read_b64_tr_b16 v[90:91], v101 offset:3232
    v_mfma_f32_16x16x32_bf16 v[8:11], v[4:7], v[72:75], v[8:11]
    v_mfma_f32_32x32x16_bf16 v[12:27], v[72:75], v[72:75], v[12:27]
    s_waitcnt lgkmcnt(2)
    v_mfma_f32_32x32x16_bf16 v[36:51], v[84:87], v[68:71], v[36:51]
    ds_read_b128 v[72:75], v77 offset:12288
    ds_read_b64_tr_b16 v[92:93], v101 offset:640
    ds_read_b64_tr_b16 v[94:95], v101 offset:800
    s_waitcnt lgkmcnt(3)
    v_mfma_f32_32x32x16_bf16 v[52:67], v[68:71], v[88:91], v[52:67]
    ds_read_b64_tr_b16 v[96:97], v101 offset:3712
    ds_read_b64_tr_b16 v[98:99], v101 offset:3872
    v_mfma_f32_16x16x32_bf16 v[8:11], v[4:7], v[68:71], v[8:11]
    v_mfma_f32_32x32x16_bf16 v[12:27], v[68:71], v[68:71], v[12:27]
    s_waitcnt lgkmcnt(2)
    v_mfma_f32_32x32x16_bf16 v[36:51], v[92:95], v[72:75], v[36:51]
    ds_read_b128 v[68:71], v78 offset:12288
    ds_read_b64_tr_b16 v[84:85], v101 offset:1280
    ds_read_b64_tr_b16 v[86:87], v101 offset:1440
    s_waitcnt lgkmcnt(3)
    v_mfma_f32_32x32x16_bf16 v[52:67], v[72:75], v[96:99], v[52:67]
    ds_read_b64_tr_b16 v[88:89], v101 offset:4352
    ds_read_b64_tr_b16 v[90:91], v101 offset:4512
    v_mfma_f32_16x16x32_bf16 v[8:11], v[4:7], v[72:75], v[8:11]
    v_mfma_f32_32x32x16_bf16 v[12:27], v[72:75], v[72:75], v[12:27]
    s_waitcnt lgkmcnt(2)
    v_mfma_f32_32x32x16_bf16 v[36:51], v[84:87], v[68:71], v[36:51]
    ds_read_b128 v[72:75], v79 offset:12288
    ds_read_b64_tr_b16 v[92:93], v101 offset:1920
    ds_read_b64_tr_b16 v[94:95], v101 offset:2080
    s_waitcnt lgkmcnt(3)
    v_mfma_f32_32x32x16_bf16 v[52:67], v[68:71], v[88:91], v[52:67]
    ds_read_b64_tr_b16 v[96:97], v101 offset:4992
    ds_read_b64_tr_b16 v[98:99], v101 offset:5152
    v_mfma_f32_16x16x32_bf16 v[8:11], v[4:7], v[68:71], v[8:11]
    v_mfma_f32_32x32x16_bf16 v[12:27], v[68:71], v[68:71], v[12:27]
    s_waitcnt lgkmcnt(2)
    v_mfma_f32_32x32x16_bf16 v[36:51], v[92:95], v[72:75], v[36:51]
    s_add_u32 s48, s48, 6144
    s_cmp_ge_u32 s48, 30720
    s_cselect_b32 s48, 0, s48
    v_add_u32 v102, s48, v100
    s_barrier
    ds_read_b128 v[68:71], v76 offset:16384
    ds_read_b64_tr_b16 v[84:85], v102 offset:0
    ds_read_b64_tr_b16 v[86:87], v102 offset:160
    s_waitcnt lgkmcnt(3)
    v_mfma_f32_32x32x16_bf16 v[52:67], v[72:75], v[96:99], v[52:67]
    ds_read_b64_tr_b16 v[88:89], v102 offset:3072
    ds_read_b64_tr_b16 v[90:91], v102 offset:3232
    v_mfma_f32_16x16x32_bf16 v[8:11], v[4:7], v[72:75], v[8:11]
    v_mfma_f32_32x32x16_bf16 v[12:27], v[72:75], v[72:75], v[12:27]
    s_waitcnt lgkmcnt(2)
    v_mfma_f32_32x32x16_bf16 v[36:51], v[84:87], v[68:71], v[36:51]
    ds_read_b128 v[72:75], v77 offset:16384
    ds_read_b64_tr_b16 v[92:93], v102 offset:640
    ds_read_b64_tr_b16 v[94:95], v102 offset:800
    s_waitcnt lgkmcnt(3)
    v_mfma_f32_32x32x16_bf16 v[52:67], v[68:71], v[88:91], v[52:67]
    ds_read_b64_tr_b16 v[96:97], v102 offset:3712
    ds_read_b64_tr_b16 v[98:99], v102 offset:3872
    v_mfma_f32_16x16x32_bf16 v[8:11], v[4:7], v[68:71], v[8:11]
    v_mfma_f32_32x32x16_bf16 v[12:27], v[68:71], v[68:71], v[12:27]
    s_waitcnt lgkmcnt(2)
    v_mfma_f32_32x32x16_bf16 v[36:51], v[92:95], v[72:75], v[36:51]
    ds_read_b128 v[68:71], v78 offset:16384
    ds_read_b64_tr_b16 v[84:85], v102 offset:1280
    ds_read_b64_tr_b16 v[86:87], v102 offset:1440
    s_waitcnt lgkmcnt(3)
    v_mfma_f32_32x32x16_bf16 v[52:67], v[72:75], v[96:99], v[52:67]
    ds_read_b64_tr_b16 v[88:89], v102 offset:4352
    ds_read_b64_tr_b16 v[90:91], v102 offset:4512
    v_mfma_f32_16x16x32_bf16 v[8:11], v[4:7], v[72:75], v[8:11]
    v_mfma_f32_32x32x16_bf16 v[12:27], v[72:75], v[72:75], v[12:27]
    s_waitcnt lgkmcnt(2)
    v_mfma_f32_32x32x16_bf16 v[36:51], v[84:87], v[68:71], v[36:51]
    ds_read_b128 v[72:75], v79 offset:16384
    ds_read_b64_tr_b16 v[92:93], v102 offset:1920
    ds_read_b64_tr_b16 v[94:95], v102 offset:2080
    s_waitcnt lgkmcnt(3)
    v_mfma_f32_32x32x16_bf16 v[52:67], v[68:71], v[88:91], v[52:67]
    ds_read_b64_tr_b16 v[96:97], v102 offset:4992
    ds_read_b64_tr_b16 v[98:99], v102 offset:5152
    v_mfma_f32_16x16x32_bf16 v[8:11], v[4:7], v[68:71], v[8:11]
    v_mfma_f32_32x32x16_bf16 v[12:27], v[68:71], v[68:71], v[12:27]
    s_waitcnt lgkmcnt(2)
    v_mfma_f32_32x32x16_bf16 v[36:51], v[92:95], v[72:75], v[36:51]
    s_waitcnt lgkmcnt(0)
    v_mfma_f32_32x32x16_bf16 v[52:67], v[72:75], v[96:99], v[52:67]
    v_mfma_f32_16x16x32_bf16 v[8:11], v[4:7], v[72:75], v[8:11]
    v_mfma_f32_32x32x16_bf16 v[12:27], v[72:75], v[72:75], v[12:27]
    s_waitcnt vmcnt(0) lgkmcnt(0)
    s_nop 11
    v_and_b32 v107, 1, v1
    v_cmp_ne_u32 vcc, 0, v107
    s_nop 1
    v_cndmask_b32 v12, v12, v13, vcc
    v_cndmask_b32 v14, v14, v15, vcc
    v_cndmask_b32 v16, v16, v17, vcc
    v_cndmask_b32 v18, v18, v19, vcc
    v_cndmask_b32 v20, v20, v21, vcc
    v_cndmask_b32 v22, v22, v23, vcc
    v_cndmask_b32 v24, v24, v25, vcc
    v_cndmask_b32 v26, v26, v27, vcc
    v_and_b32 v107, 2, v1
    v_cmp_ne_u32 vcc, 0, v107
    s_nop 1
    v_cndmask_b32 v12, v12, v14, vcc
    v_cndmask_b32 v16, v16, v18, vcc
    v_cndmask_b32 v20, v20, v22, vcc
    v_cndmask_b32 v24, v24, v26, vcc
    v_and_b32 v107, 8, v1
    v_cmp_ne_u32 vcc, 0, v107
    s_nop 1
    v_cndmask_b32 v12, v12, v16, vcc
    v_cndmask_b32 v20, v20, v24, vcc
    v_and_b32 v107, 16, v1
    v_cmp_ne_u32 vcc, 0, v107
    s_nop 1
    v_cndmask_b32 v12, v12, v20, vcc
    v_lshrrev_b32 v107, 3, v1
    v_xor_b32 v107, v107, v1
    v_and_b32 v107, 4, v107
    v_cmp_eq_u32 vcc, 0, v107
    s_nop 1
    v_cndmask_b32 v12, 0, v12, vcc
    v_mov_b32 v107, v12
    v_mov_b32 v108, v12
    s_nop 1
    v_permlane32_swap_b32 v107, v108
    s_nop 1
    v_add_f32 v12, v107, v108
    v_mul_f32 v109, 0xbacccccd, v8
    v_mul_f32 v107, 0x3acccccd, v12
    v_fma_f32 v107, -v109, v109, v107
    v_max_f32 v107, 0, v107
    v_add_f32 v107, 0x3727c5ac, v107
    v_rsq_f32 v110, v107
    s_nop 0
    v_lshlrev_b32 v111, 4, v2
    v_add_u32 v111, 92160, v111
    s_barrier
    ds_read_b128 v[112:115], v111 offset:0
    ds_read_b128 v[116:119], v111 offset:32
    ds_read_b128 v[120:123], v111 offset:64
    s_lshl_b32 s50, s40, 10
    s_add_u32 s50, s50, 93184
    v_and_b32 v111, 31, v1
    v_lshlrev_b32 v111, 2, v111
    v_add_u32 v160, 92160, v111
    ds_read_b32 v160, v160 offset:128
    v_add_u32 v111, s50, v111
    ds_write_b32 v111, v109 offset:256
    ds_write_b32 v111, v110 offset:384
    v_lshlrev_b32 v161, 4, v2
    v_add_u32 v161, s50, v161
    s_waitcnt lgkmcnt(0)
    v_fma_f32 v112, v109, v112, v36
    v_mul_f32 v112, v110, v112
    v_fma_f32 v113, v109, v113, v37
    v_mul_f32 v113, v110, v113
    v_fma_f32 v114, v109, v114, v38
    v_mul_f32 v114, v110, v114
    v_fma_f32 v115, v109, v115, v39
    v_mul_f32 v115, v110, v115
    v_fma_f32 v116, v109, v116, v40
    v_mul_f32 v116, v110, v116
    v_fma_f32 v117, v109, v117, v41
    v_mul_f32 v117, v110, v117
    v_fma_f32 v118, v109, v118, v42
    v_mul_f32 v118, v110, v118
    v_fma_f32 v119, v109, v119, v43
    v_mul_f32 v119, v110, v119
    v_fma_f32 v120, v109, v120, v44
    v_mul_f32 v120, v110, v120
    v_fma_f32 v121, v109, v121, v45
    v_mul_f32 v121, v110, v121
    v_fma_f32 v122, v109, v122, v46
    v_mul_f32 v122, v110, v122
    v_fma_f32 v123, v109, v123, v47
    v_mul_f32 v123, v110, v123
    v_cvt_pk_bf16_f32 v144, v112, v113
    v_cvt_pk_bf16_f32 v145, v114, v115
    v_cvt_pk_bf16_f32 v146, v116, v117
    v_cvt_pk_bf16_f32 v147, v118, v119
    v_cvt_pk_bf16_f32 v148, v120, v121
    v_cvt_pk_bf16_f32 v149, v122, v123
    v_cmp_eq_u32 vcc, 1, v2
    v_mov_b32 v107, 0x3f803f80
    v_mov_b32 v108, 0x00003f80
    v_cndmask_b32 v148, v148, v107, vcc
    v_cndmask_b32 v149, v149, v108, vcc
    v_and_b32 v162, 31, v1
    v_lshlrev_b32 v162, 4, v162
    v_lshl_add_u32 v162, v2, 3, v162
    buffer_store_dwordx2 v[144:145], v162, s[24:27], 0 offen offset:0
    buffer_store_dwordx2 v[146:147], v162, s[24:27], 0 offen offset:512
    v_lshlrev_b32 v162, 3, v1
    buffer_store_dwordx2 v[148:149], v162, s[24:27], 0 offen offset:1024
    ds_read_b128 v[112:115], v161 offset:256
    ds_read_b128 v[128:131], v161 offset:384
    ds_read_b128 v[116:119], v161 offset:288
    ds_read_b128 v[132:135], v161 offset:416
    ds_read_b128 v[120:123], v161 offset:320
    ds_read_b128 v[136:139], v161 offset:448
    ds_read_b128 v[124:127], v161 offset:352
    ds_read_b128 v[140:143], v161 offset:480
    s_waitcnt lgkmcnt(0)
    v_and_b32 v107, 31, v1
    v_cmp_gt_u32 s[58:59], 20, v107
    v_cmp_eq_u32 vcc, 20, v107
    v_mov_b32 v108, 0
    s_nop 1
    v_cndmask_b32 v108, v108, 1.0, vcc
    v_fma_f32 v112, v112, v160, v52
    v_mul_f32 v112, v128, v112
    v_cndmask_b32 v112, v108, v112, s[58:59]
    v_fma_f32 v113, v113, v160, v53
    v_mul_f32 v113, v129, v113
    v_cndmask_b32 v113, v108, v113, s[58:59]
    v_fma_f32 v114, v114, v160, v54
    v_mul_f32 v114, v130, v114
    v_cndmask_b32 v114, v108, v114, s[58:59]
    v_fma_f32 v115, v115, v160, v55
    v_mul_f32 v115, v131, v115
    v_cndmask_b32 v115, v108, v115, s[58:59]
    v_fma_f32 v116, v116, v160, v56
    v_mul_f32 v116, v132, v116
    v_cndmask_b32 v116, v108, v116, s[58:59]
    v_fma_f32 v117, v117, v160, v57
    v_mul_f32 v117, v133, v117
    v_cndmask_b32 v117, v108, v117, s[58:59]
    v_fma_f32 v118, v118, v160, v58
    v_mul_f32 v118, v134, v118
    v_cndmask_b32 v118, v108, v118, s[58:59]
    v_fma_f32 v119, v119, v160, v59
    v_mul_f32 v119, v135, v119
    v_cndmask_b32 v119, v108, v119, s[58:59]
    v_fma_f32 v120, v120, v160, v60
    v_mul_f32 v120, v136, v120
    v_cndmask_b32 v120, v108, v120, s[58:59]
    v_fma_f32 v121, v121, v160, v61
    v_mul_f32 v121, v137, v121
    v_cndmask_b32 v121, v108, v121, s[58:59]
    v_fma_f32 v122, v122, v160, v62
    v_mul_f32 v122, v138, v122
    v_cndmask_b32 v122, v108, v122, s[58:59]
    v_fma_f32 v123, v123, v160, v63
    v_mul_f32 v123, v139, v123
    v_cndmask_b32 v123, v108, v123, s[58:59]
    v_fma_f32 v124, v124, v160, v64
    v_mul_f32 v124, v140, v124
    v_cndmask_b32 v124, v108, v124, s[58:59]
    v_fma_f32 v125, v125, v160, v65
    v_mul_f32 v125, v141, v125
    v_cndmask_b32 v125, v108, v125, s[58:59]
    v_fma_f32 v126, v126, v160, v66
    v_mul_f32 v126, v142, v126
    v_cndmask_b32 v126, v108, v126, s[58:59]
    v_fma_f32 v127, v127, v160, v67
    v_mul_f32 v127, v143, v127
    v_cndmask_b32 v127, v108, v127, s[58:59]
    v_cvt_pk_bf16_f32 v152, v112, v113
    v_cvt_pk_bf16_f32 v153, v114, v115
    v_cvt_pk_bf16_f32 v154, v116, v117
    v_cvt_pk_bf16_f32 v155, v118, v119
    v_cvt_pk_bf16_f32 v156, v120, v121
    v_cvt_pk_bf16_f32 v157, v122, v123
    v_cvt_pk_bf16_f32 v158, v124, v125
    v_cvt_pk_bf16_f32 v159, v126, v127
    buffer_store_dwordx4 v[152:155], v3, s[24:27], 0 offen offset:2048
    buffer_store_dwordx4 v[156:159], v3, s[24:27], 0 offen offset:3072
K1_end:
    s_endpgm
.globl k2_tail_kernel
.p2align 8
.type k2_tail_kernel,@function
k2_tail_kernel:
    s_load_dwordx16 s[64:79], s[0:1], 0
    s_load_dwordx8 s[80:87], s[0:1], 64
    s_cmp_ge_u32 s2, 256
    s_cbranch_scc1 F_end
    v_lshrrev_b32 v1, 6, v0
    s_nop 0
    v_readfirstlane_b32 s40, v1
    v_and_b32 v1, 63, v0
    s_mov_b32 s41, s40
    s_mov_b32 s42, 0
    s_mov_b32 s11, 0x40000000
    s_and_b32 s3, s2, 7
    s_lshr_b32 s44, s2, 3
    s_mul_i32 s50, s44, 205
    s_lshr_b32 s50, s50, 11
    s_mul_i32 s51, s50, 10
    s_lshl_b32 s43, s50, 3
    s_add_u32 s43, s43, s3
    s_lshl_b32 s61, s44, 1
    s_add_u32 s61, s61, s3
    s_sub_u32 s61, s61, 46
    s_sub_u32 s52, s2, 220
    s_cmp_ge_u32 s2, 240
    s_cselect_b32 s61, s52, s61
    s_sub_u32 s44, s44, s51
    s_cmp_ge_u32 s43, 22
    s_cbranch_scc1 F_nb_free
    s_lshl_b32 s55, s44, 7
    s_mov_b32 s8, 10
    s_mov_b32 s11, s55
    s_branch F_nb_done
F_nb_free:
    s_cmp_lt_u32 s61, 24
    s_cselect_b32 s8, 1, 0
F_nb_done:
    s_waitcnt lgkmcnt(0)
    s_add_u32 s16, s86, 2621440
    s_addc_u32 s17, s87, 0
    s_and_b32 s17, s17, 0xffff
    s_mov_b32 s18, 262144
    s_mov_b32 s19, 0x00020000
    v_lshlrev_b32 v4, 4, v1
    s_and_b32 s46, s40, 3
    s_lshl_b32 s43, s46, 10
    s_mov_b32 m0, s43
    v_add_u32 v148, s43, v4
    s_mul_i32 s48, s2, 10240
    s_cmp_ge_u32 s40, 4
    s_cbranch_scc1 L_whi_55
    buffer_load_dwordx4 v148, s[16:19], 0 offen lds
    s_add_u32 s20, s86, 0
    s_addc_u32 s21, s87, 0
    s_and_b32 s21, s21, 0xffff
    s_mov_b32 s22, 2621440
    s_mov_b32 s23, 0x00020000
    s_lshl1_add_u32 m0, s43, 148736
    s_add_u32 s50, s48, s43
    s_and_b32 s51, s43, 1024
    buffer_load_dwordx4 v148, s[20:23], s50 offen lds
    buffer_load_dwordx4 v148, s[20:23], s50 offen offset:1024 lds
    s_add_u32 m0, s51, 156928
    s_add_u32 s51, s51, 8192
    s_add_u32 s50, s48, s51
    buffer_load_dwordx4 v4, s[20:23], s50 offen lds
    s_add_u32 m0, s43, 16384
    s_mov_b32 s13, 131072
    buffer_load_dwordx4 v148, s[16:19], s13 offen lds
L_whi_55:
    s_lshr_b32 s45, s40, 2
    s_lshl_b32 s14, s40, 10
    v_add_u32 v143, s14, v4
    s_lshl_b32 s54, s45, 17
    s_lshl_b32 s50, s45, 14
    s_add_u32 s43, s43, s50
    s_lshl_b32 s12, s40, 12
    s_mul_i32 s50, s45, 114688
    s_add_u32 s50, s50, s12
    v_add_u32 v129, s50, v4
    v_lshlrev_b32 v5, 3, v1
    v_lshrrev_b32 v2, 5, v1
    v_and_b32 v3, 0x1f0, v4
    s_lshr_b32 s44, s2, 2
    s_mul_i32 s50, s46, 5
    s_lshr_b32 s50, s50, 1
    s_lshl_b32 s50, s50, 10
    s_add_u32 s50, s50, 148736
    s_bitcmp1_b32 s40, 0
    s_cselect_b32 s51, 1016, 8
    s_cselect_b32 s52, 8, 1016
    s_cselect_b32 s3, 8, 0
    s_add_u32 s50, s50, s3
    v_add_u32 v8, s50, v3
    v_mad_u32_u24 v6, v2, s51, v8
    v_add_u32 v7, s51, v8
    v_mad_u32_u24 v7, v2, s52, v7
    v_add_u32 v7, 1024, v7
    v_add_u32 v8, 1536, v6
    v_add_u32 v9, 512, v6
    s_cmp_eq_u32 s45, 1
    s_cselect_b64 s[58:59], -1, 0
    v_cndmask_b32 v145, v6, v8, s[58:59]
    v_cndmask_b32 v144, v8, v6, s[58:59]
    v_cndmask_b32 v147, v9, v7, s[58:59]
    v_cndmask_b32 v146, v7, v9, s[58:59]
    v_mov_b32 v20, 0
    v_mov_b32 v21, 0
    v_mov_b32 v22, 0
    v_mov_b32 v23, 0
    s_mov_b32 s28, s72
    s_and_b32 s29, s73, 0xffff
    s_mov_b32 s30, 819200
    s_mov_b32 s31, 0x00020000
    s_lshr_b32 s50, s2, 3
    s_mul_i32 s56, s50, 25
    s_add_u32 s56, s56, s40
    s_lshl_b32 s56, s56, 10
    v_lshrrev_b32 v6, 4, v1
    v_mul_u32_u24 v6, 3072, v6
    v_and_b32 v7, 0xf0, v4
    v_add_u32 v136, v6, v7
    s_mul_i32 s50, s40, 10240
    s_add_u32 s50, s50, s11
    v_lshrrev_b32 v7, 3, v1
    v_and_b32 v8, 0x70, v4
    v_lshrrev_b32 v9, 2, v4
    v_and_b32 v9, 64, v9
    v_mul_u32_u24 v7, 1280, v7
    v_xad_u32 v8, v8, v9, s50
    v_add_u32 v130, v7, v8
    s_lshl_b32 s50, s45, 14
    v_add_u32 v124, s50, v4
    v_add_u32 v126, s50, v5
    v_add_u32 v125, 0x10000, v124
    v_add_u32 v127, 0x10000, v126
    s_mul_i32 s50, s40, 3072
    s_add_u32 s50, s50, 65536
    v_add_u32 v138, s50, v4
    s_xor_b32 s50, s40, 4
    s_mul_i32 s50, s50, 3072
    s_add_u32 s50, s50, 65536
    v_add_u32 v139, s50, v4
    s_lshl1_add_u32 s50, s46, s45
    s_mul_i32 s50, s50, 5
    s_lshr_b32 s50, s50, 1
    s_lshl_b32 s50, s50, 9
    s_lshl3_add_u32 s50, s45, s50
    s_add_u32 s50, s50, 148736
    s_mul_i32 s51, s45, 496
    s_add_u32 s51, s51, 8
    v_add_u32 v6, s50, v3
    v_mad_u32_u24 v140, v2, s51, v6
    s_mov_b32 s58, 0
    s_mov_b32 s59, -1
    v_cndmask_b32 v142, v140, v3, s[58:59]
    s_mov_b32 s15, 0x07060302
    s_add_u32 m0, s43, 4096
    s_add_u32 s13, s54, 4096
    buffer_load_dwordx4 v148, s[16:19], s13 offen lds
    s_waitcnt vmcnt(1)
    s_barrier
    ds_read_b128 v[100:103], v4
    ds_read_b64 v[12:13], v144
    ds_read_b64 v[14:15], v146
    ds_read_b64 v[106:107], v5 offset:1024
    s_mov_b64 exec, 0xffffffff
    ds_read_b64 v[20:21], v144 offset:1024
    ds_read_b64 v[22:23], v145 offset:1024
    s_mov_b64 exec, -1
    ds_read_b64 v[16:17], v145
    ds_read_b64 v[18:19], v147
    ds_read_b128 v[96:99], v124 offset:0
    ds_read_b64 v[104:105], v126 offset:1024
    ds_read_b128 v[108:111], v124 offset:2048
    ds_read_b128 v[116:119], v124 offset:3072
    s_add_u32 m0, s43, 8192
    s_add_u32 s13, s54, 8192
    buffer_load_dwordx4 v148, s[16:19], s13 offen lds
    s_add_u32 m0, s43, 12288
    s_add_u32 s13, s54, 12288
    buffer_load_dwordx4 v148, s[16:19], s13 offen lds
    s_waitcnt lgkmcnt(9)
    v_mfma_f32_32x32x16_bf16 v[24:39], v[100:103], v[12:15], 0
    s_waitcnt lgkmcnt(7)
    v_mfma_f32_32x32x8_bf16 v[24:39], v[106:107], v[20:21], v[24:39]
    s_waitcnt lgkmcnt(4)
    v_mfma_f32_32x32x16_bf16 v[40:55], v[100:103], v[16:19], 0
    v_mfma_f32_32x32x8_bf16 v[40:55], v[106:107], v[22:23], v[40:55]
    s_add_u32 m0, s12, 32768
    s_mov_b32 s13, 16384
    buffer_load_dwordx4 v129, s[16:19], s13 offen offset:0 lds
    buffer_load_dwordx4 v129, s[16:19], s13 offen offset:1024 lds
    s_nop 4
    v_max3_f32 v128, v24, v25, v26
    v_max3_f32 v128, v128, v27, v28
    v_max3_f32 v128, v128, v29, v30
    v_max3_f32 v128, v128, v31, v32
    v_max3_f32 v128, v128, v33, v34
    v_max3_f32 v128, v128, v35, v36
    v_max3_f32 v128, v128, v37, v38
    v_max_f32 v128, v128, v39
    v_max3_f32 v9, v40, v41, v42
    v_max3_f32 v9, v9, v43, v44
    v_max3_f32 v9, v9, v45, v46
    v_max3_f32 v9, v9, v47, v48
    v_max3_f32 v9, v9, v49, v50
    v_max3_f32 v9, v9, v51, v52
    v_max3_f32 v9, v9, v53, v54
    v_max_f32 v9, v9, v55
    s_waitcnt lgkmcnt(2)
    v_mfma_f32_32x32x16_bf16 v[24:39], v[96:99], v[12:15], 0
    v_permlane32_swap_b32 v128, v9
    s_nop 1
    v_min_f32 v128, -v128, -v9
    v_and_b32 v6, 0xffff0000, v128
    v_sub_f32 v7, v128, v6
    v_and_b32 v8, 0xffff0000, v7
    v_perm_b32 v6, v7, v128, s15
    v_sub_f32 v7, v7, v8
    v_lshrrev_b32 v7, 16, v7
    s_nop 0
    v_permlane32_swap_b32 v20, v6
    v_permlane32_swap_b32 v21, v7
    s_nop 1
    v_mfma_f32_32x32x8_bf16 v[24:39], v[104:105], v[20:21], v[24:39]
    v_or_b32 v22, v22, v6
    v_or_b32 v23, v23, v7
    s_waitcnt vmcnt(4)
    s_barrier
    ds_read_b128 v[100:103], v124 offset:4096
    ds_read_b64 v[106:107], v126 offset:5120
    v_mfma_f32_32x32x16_bf16 v[40:55], v[96:99], v[16:19], 0
    v_mfma_f32_32x32x8_bf16 v[40:55], v[104:105], v[22:23], v[40:55]
    buffer_load_dwordx4 v129, s[16:19], s13 offen offset:2048 lds
    buffer_load_dwordx4 v129, s[16:19], s13 offen offset:3072 lds
    buffer_load_dwordx4 v[132:135], v4, s[28:31], s56 offen
    s_add_u32 s56, s56, 8192
    s_nop 1
    v_exp_f32 v24, v24
    v_exp_f32 v25, v25
    v_exp_f32 v26, v26
    v_exp_f32 v27, v27
    v_exp_f32 v28, v28
    v_exp_f32 v29, v29
    v_exp_f32 v30, v30
    v_exp_f32 v31, v31
    v_cvt_pk_bf16_f32 v56, v24, v25
    v_cvt_pk_bf16_f32 v57, v26, v27
    v_cvt_pk_bf16_f32 v58, v28, v29
    v_cvt_pk_bf16_f32 v59, v30, v31
    v_exp_f32 v32, v32
    v_exp_f32 v33, v33
    s_waitcnt lgkmcnt(2)
    v_mfma_f32_32x32x16_bf16 v[64:79], v[108:111], v[56:59], 0
    v_exp_f32 v34, v34
    v_exp_f32 v35, v35
    v_exp_f32 v36, v36
    v_exp_f32 v37, v37
    v_exp_f32 v38, v38
    v_exp_f32 v39, v39
    v_cvt_pk_bf16_f32 v60, v32, v33
    v_cvt_pk_bf16_f32 v61, v34, v35
    v_cvt_pk_bf16_f32 v62, v36, v37
    v_cvt_pk_bf16_f32 v63, v38, v39
    s_nop 1
    v_mfma_f32_32x32x16_bf16 v[64:79], v[116:119], v[60:63], v[64:79]
    s_waitcnt lgkmcnt(0)
    ds_read_b128 v[112:115], v124 offset:6144
    ds_read_b128 v[120:123], v124 offset:7168
    v_exp_f32 v40, v40
    s_mov_b32 s32, s76
    v_exp_f32 v41, v41
    s_and_b32 s33, s77, 0xffff
    v_exp_f32 v42, v42
    s_mov_b32 s34, 1966080
    v_exp_f32 v43, v43
    s_mov_b32 s35, 0x00020000
    v_mfma_f32_32x32x16_bf16 v[24:39], v[100:103], v[12:15], 0
    v_exp_f32 v44, v44
    s_mov_b32 s36, s78
    v_exp_f32 v45, v45
    s_and_b32 s37, s79, 0xffff
    v_exp_f32 v46, v46
    s_mov_b32 s38, 1966080
    v_exp_f32 v47, v47
    s_mov_b32 s39, 0x00020000
    v_mfma_f32_32x32x8_bf16 v[24:39], v[106:107], v[20:21], v[24:39]
    v_cvt_pk_bf16_f32 v56, v40, v41
    v_cvt_pk_bf16_f32 v57, v42, v43
    v_cvt_pk_bf16_f32 v58, v44, v45
    v_cvt_pk_bf16_f32 v59, v46, v47
    v_exp_f32 v48, v48
    s_mov_b32 s24, s80
    v_exp_f32 v49, v49
    s_and_b32 s25, s81, 0xffff
    v_mfma_f32_32x32x16_bf16 v[80:95], v[108:111], v[56:59], 0
    v_exp_f32 v50, v50
    s_mov_b32 s26, 1966080
    v_exp_f32 v51, v51
    s_mov_b32 s27, 0x00020000
    v_exp_f32 v52, v52
    v_exp_f32 v53, v53
    v_exp_f32 v54, v54
    v_exp_f32 v55, v55
    v_cvt_pk_bf16_f32 v60, v48, v49
    v_cvt_pk_bf16_f32 v61, v50, v51
    v_cvt_pk_bf16_f32 v62, v52, v53
    v_cvt_pk_bf16_f32 v63, v54, v55
    s_nop 1
    v_mfma_f32_32x32x16_bf16 v[80:95], v[116:119], v[60:63], v[80:95]
    s_waitcnt vmcnt(5)
    s_barrier
    ds_read_b128 v[96:99], v124 offset:8192
    ds_read_b64 v[104:105], v126 offset:9216
    v_exp_f32 v24, v24
    s_add_u32 s20, s86, 2883584
    v_exp_f32 v25, v25
    s_addc_u32 s21, s87, 0
    v_exp_f32 v26, v26
    s_and_b32 s21, s21, 0xffff
    v_exp_f32 v27, v27
    s_mov_b32 s22, 2621440
    v_mfma_f32_32x32x16_bf16 v[40:55], v[100:103], v[16:19], 0
    v_exp_f32 v28, v28
    s_mov_b32 s23, 0x00020000
    v_exp_f32 v29, v29
    s_add_u32 s4, s86, 17219584
    v_exp_f32 v30, v30
    s_addc_u32 s5, s87, 0
    v_exp_f32 v31, v31
    s_and_b32 s5, s5, 0xffff
    v_mfma_f32_32x32x8_bf16 v[40:55], v[106:107], v[22:23], v[40:55]
    v_cvt_pk_bf16_f32 v56, v24, v25
    v_cvt_pk_bf16_f32 v57, v26, v27
    v_cvt_pk_bf16_f32 v58, v28, v29
    v_cvt_pk_bf16_f32 v59, v30, v31
    v_exp_f32 v32, v32
    s_mov_b32 s6, 65536
    v_exp_f32 v33, v33
    s_mov_b32 s7, 0x00020000
    s_waitcnt lgkmcnt(2)
    v_mfma_f32_32x32x16_bf16 v[64:79], v[112:115], v[56:59], v[64:79]
    v_exp_f32 v34, v34
    s_lshr_b32 s50, s2, 3
    v_exp_f32 v35, v35
    s_lshl3_add_u32 s50, s50, s40
    v_exp_f32 v36, v36
    v_exp_f32 v37, v37
    v_exp_f32 v38, v38
    v_exp_f32 v39, v39
    v_cvt_pk_bf16_f32 v60, v32, v33
    v_cvt_pk_bf16_f32 v61, v34, v35
    v_cvt_pk_bf16_f32 v62, v36, v37
    v_cvt_pk_bf16_f32 v63, v38, v39
    s_nop 1
    v_mfma_f32_32x32x16_bf16 v[64:79], v[120:123], v[60:63], v[64:79]
    s_waitcnt lgkmcnt(0)
    ds_read_b128 v[108:111], v124 offset:10240
    ds_read_b128 v[116:119], v124 offset:11264
    v_exp_f32 v40, v40
    s_and_b32 s52, s2, 3
    v_exp_f32 v41, v41
    s_mul_i32 s52, s52, 768
    v_exp_f32 v42, v42
    s_lshl1_add_u32 s51, s50, 0
    v_exp_f32 v43, v43
    s_min_u32 s51, s51, 479
    v_mfma_f32_32x32x16_bf16 v[24:39], v[96:99], v[12:15], 0
    v_exp_f32 v44, v44
    s_mul_i32 s57, s51, 21846
    v_exp_f32 v45, v45
    s_lshr_b32 s57, s57, 16
    v_exp_f32 v46, v46
    s_mul_i32 s57, s57, 11520
    v_exp_f32 v47, v47
    s_lshl_b32 s51, s51, 8
    v_mfma_f32_32x32x8_bf16 v[24:39], v[104:105], v[20:21], v[24:39]
    v_cvt_pk_bf16_f32 v56, v40, v41
    v_cvt_pk_bf16_f32 v57, v42, v43
    v_cvt_pk_bf16_f32 v58, v44, v45
    v_cvt_pk_bf16_f32 v59, v46, v47
    v_exp_f32 v48, v48
    s_add_u32 s57, s57, s51
    v_exp_f32 v49, v49
    s_add_u32 s57, s57, s52
    v_mfma_f32_32x32x16_bf16 v[80:95], v[112:115], v[56:59], v[80:95]
    v_exp_f32 v50, v50
    s_lshl1_add_u32 s51, s50, 1
    v_exp_f32 v51, v51
    s_min_u32 s51, s51, 479
    v_exp_f32 v52, v52
    v_exp_f32 v53, v53
    v_exp_f32 v54, v54
    v_exp_f32 v55, v55
    v_cvt_pk_bf16_f32 v60, v48, v49
    v_cvt_pk_bf16_f32 v61, v50, v51
    v_cvt_pk_bf16_f32 v62, v52, v53
    v_cvt_pk_bf16_f32 v63, v54, v55
    s_nop 1
    v_mfma_f32_32x32x16_bf16 v[80:95], v[120:123], v[60:63], v[80:95]
    ds_read_b128 v[100:103], v124 offset:12288
    ds_read_b64 v[106:107], v126 offset:13312
    v_exp_f32 v24, v24
    s_mul_i32 s53, s51, 21846
    v_exp_f32 v25, v25
    s_lshr_b32 s53, s53, 16
    v_exp_f32 v26, v26
    s_mul_i32 s53, s53, 11520
    v_exp_f32 v27, v27
    s_lshl_b32 s51, s51, 8
    v_mfma_f32_32x32x16_bf16 v[40:55], v[96:99], v[16:19], 0
    v_exp_f32 v28, v28
    s_add_u32 s53, s53, s51
    v_exp_f32 v29, v29
    s_add_u32 s53, s53, s52
    v_exp_f32 v30, v30
    s_lshl3_add_u32 s3, s2, s40
    v_exp_f32 v31, v31
    s_lshl_b32 s3, s3, 10
    v_mfma_f32_32x32x8_bf16 v[40:55], v[104:105], v[22:23], v[40:55]
    v_cvt_pk_bf16_f32 v56, v24, v25
    v_cvt_pk_bf16_f32 v57, v26, v27
    v_cvt_pk_bf16_f32 v58, v28, v29
    v_cvt_pk_bf16_f32 v59, v30, v31
    v_exp_f32 v32, v32
    s_lshl_b32 s49, s44, 8
    v_exp_f32 v33, v33
    s_waitcnt lgkmcnt(2)
    v_mfma_f32_32x32x16_bf16 v[64:79], v[108:111], v[56:59], v[64:79]
    v_exp_f32 v34, v34
    v_exp_f32 v35, v35
    v_exp_f32 v36, v36
    v_exp_f32 v37, v37
    v_exp_f32 v38, v38
    v_exp_f32 v39, v39
    v_cvt_pk_bf16_f32 v60, v32, v33
    v_cvt_pk_bf16_f32 v61, v34, v35
    v_cvt_pk_bf16_f32 v62, v36, v37
    v_cvt_pk_bf16_f32 v63, v38, v39
    s_nop 1
    v_mfma_f32_32x32x16_bf16 v[64:79], v[116:119], v[60:63], v[64:79]
    s_waitcnt lgkmcnt(0)
    ds_read_b128 v[112:115], v124 offset:14336
    ds_read_b128 v[120:123], v124 offset:15360
    v_exp_f32 v40, v40
    v_exp_f32 v41, v41
    v_exp_f32 v42, v42
    v_exp_f32 v43, v43
    v_mfma_f32_32x32x16_bf16 v[24:39], v[100:103], v[12:15], 0
    v_exp_f32 v44, v44
    v_exp_f32 v45, v45
    v_exp_f32 v46, v46
    v_exp_f32 v47, v47
    v_mfma_f32_32x32x8_bf16 v[24:39], v[106:107], v[20:21], v[24:39]
    v_cvt_pk_bf16_f32 v56, v40, v41
    v_cvt_pk_bf16_f32 v57, v42, v43
    v_cvt_pk_bf16_f32 v58, v44, v45
    v_cvt_pk_bf16_f32 v59, v46, v47
    v_exp_f32 v48, v48
    v_exp_f32 v49, v49
    v_mfma_f32_32x32x16_bf16 v[80:95], v[108:111], v[56:59], v[80:95]
    v_exp_f32 v50, v50
    v_exp_f32 v51, v51
    v_exp_f32 v52, v52
    v_exp_f32 v53, v53
    v_exp_f32 v54, v54
    v_exp_f32 v55, v55
    v_cvt_pk_bf16_f32 v60, v48, v49
    v_cvt_pk_bf16_f32 v61, v50, v51
    v_cvt_pk_bf16_f32 v62, v52, v53
    v_cvt_pk_bf16_f32 v63, v54, v55
    s_nop 1
    v_mfma_f32_32x32x16_bf16 v[80:95], v[116:119], v[60:63], v[80:95]
    s_waitcnt vmcnt(1)
    s_barrier
    ds_read_b128 v[96:99], v124 offset:32768
    ds_read_b64 v[104:105], v126 offset:33792
    v_exp_f32 v24, v24
    s_add_u32 m0, s12, 65536
    v_exp_f32 v25, v25
    s_mov_b32 s13, 32768
    v_exp_f32 v26, v26
    buffer_load_dwordx4 v129, s[16:19], s13 offen offset:0 lds
    v_exp_f32 v27, v27
    v_mfma_f32_32x32x16_bf16 v[40:55], v[100:103], v[16:19], 0
    v_exp_f32 v28, v28
    v_exp_f32 v29, v29
    v_exp_f32 v30, v30
    v_exp_f32 v31, v31
    v_mfma_f32_32x32x8_bf16 v[40:55], v[106:107], v[22:23], v[40:55]
    v_cvt_pk_bf16_f32 v56, v24, v25
    v_cvt_pk_bf16_f32 v57, v26, v27
    v_cvt_pk_bf16_f32 v58, v28, v29
    v_cvt_pk_bf16_f32 v59, v30, v31
    v_exp_f32 v32, v32
    v_exp_f32 v33, v33
    s_waitcnt lgkmcnt(2)
    v_mfma_f32_32x32x16_bf16 v[64:79], v[112:115], v[56:59], v[64:79]
    v_exp_f32 v34, v34
    v_exp_f32 v35, v35
    v_exp_f32 v36, v36
    v_exp_f32 v37, v37
    v_exp_f32 v38, v38
    v_exp_f32 v39, v39
    v_cvt_pk_bf16_f32 v60, v32, v33
    v_cvt_pk_bf16_f32 v61, v34, v35
    v_cvt_pk_bf16_f32 v62, v36, v37
    v_cvt_pk_bf16_f32 v63, v38, v39
    s_nop 1
    v_mfma_f32_32x32x16_bf16 v[64:79], v[120:123], v[60:63], v[64:79]
    s_waitcnt lgkmcnt(0)
    ds_read_b128 v[108:111], v124 offset:34816
    ds_read_b128 v[116:119], v124 offset:35840
    v_exp_f32 v40, v40
    buffer_load_dwordx4 v129, s[16:19], s13 offen offset:1024 lds
    v_exp_f32 v41, v41
    v_exp_f32 v42, v42
    v_exp_f32 v43, v43
    v_mfma_f32_32x32x16_bf16 v[24:39], v[96:99], v[12:15], 0
    v_exp_f32 v44, v44
    v_exp_f32 v45, v45
    v_exp_f32 v46, v46
    v_exp_f32 v47, v47
    v_mfma_f32_32x32x8_bf16 v[24:39], v[104:105], v[20:21], v[24:39]
    v_cvt_pk_bf16_f32 v56, v40, v41
    v_cvt_pk_bf16_f32 v57, v42, v43
    v_cvt_pk_bf16_f32 v58, v44, v45
    v_cvt_pk_bf16_f32 v59, v46, v47
    v_exp_f32 v48, v48
    v_exp_f32 v49, v49
    v_mfma_f32_32x32x16_bf16 v[80:95], v[112:115], v[56:59], v[80:95]
    v_exp_f32 v50, v50
    v_exp_f32 v51, v51
    v_exp_f32 v52, v52
    v_exp_f32 v53, v53
    v_exp_f32 v54, v54
    v_exp_f32 v55, v55
    v_cvt_pk_bf16_f32 v60, v48, v49
    v_cvt_pk_bf16_f32 v61, v50, v51
    v_cvt_pk_bf16_f32 v62, v52, v53
    v_cvt_pk_bf16_f32 v63, v54, v55
    s_nop 1
    v_mfma_f32_32x32x16_bf16 v[80:95], v[120:123], v[60:63], v[80:95]
    ds_read_b128 v[100:103], v124 offset:36864
    ds_read_b64 v[106:107], v126 offset:37888
    v_exp_f32 v24, v24
    buffer_load_dwordx4 v129, s[16:19], s13 offen offset:2048 lds
    v_exp_f32 v25, v25
    v_exp_f32 v26, v26
    v_exp_f32 v27, v27
    v_mfma_f32_32x32x16_bf16 v[40:55], v[96:99], v[16:19], 0
    v_exp_f32 v28, v28
    v_exp_f32 v29, v29
    v_exp_f32 v30, v30
    v_exp_f32 v31, v31
    v_mfma_f32_32x32x8_bf16 v[40:55], v[104:105], v[22:23], v[40:55]
    v_cvt_pk_bf16_f32 v56, v24, v25
    v_cvt_pk_bf16_f32 v57, v26, v27
    v_cvt_pk_bf16_f32 v58, v28, v29
    v_cvt_pk_bf16_f32 v59, v30, v31
    v_exp_f32 v32, v32
    v_exp_f32 v33, v33
    s_waitcnt lgkmcnt(2)
    v_mfma_f32_32x32x16_bf16 v[64:79], v[108:111], v[56:59], v[64:79]
    v_exp_f32 v34, v34
    v_exp_f32 v35, v35
    v_exp_f32 v36, v36
    v_exp_f32 v37, v37
    v_exp_f32 v38, v38
    v_exp_f32 v39, v39
    v_cvt_pk_bf16_f32 v60, v32, v33
    v_cvt_pk_bf16_f32 v61, v34, v35
    v_cvt_pk_bf16_f32 v62, v36, v37
    v_cvt_pk_bf16_f32 v63, v38, v39
    s_nop 1
    v_mfma_f32_32x32x16_bf16 v[64:79], v[116:119], v[60:63], v[64:79]
    s_waitcnt lgkmcnt(0)
    ds_read_b128 v[112:115], v124 offset:38912
    ds_read_b128 v[120:123], v124 offset:39936
    v_exp_f32 v40, v40
    buffer_load_dwordx4 v129, s[16:19], s13 offen offset:3072 lds
    v_exp_f32 v41, v41
    v_exp_f32 v42, v42
    v_exp_f32 v43, v43
    v_mfma_f32_32x32x16_bf16 v[24:39], v[100:103], v[12:15], 0
    v_exp_f32 v44, v44
    v_exp_f32 v45, v45
    v_exp_f32 v46, v46
    v_exp_f32 v47, v47
    v_mfma_f32_32x32x8_bf16 v[24:39], v[106:107], v[20:21], v[24:39]
    v_cvt_pk_bf16_f32 v56, v40, v41
    v_cvt_pk_bf16_f32 v57, v42, v43
    v_cvt_pk_bf16_f32 v58, v44, v45
    v_cvt_pk_bf16_f32 v59, v46, v47
    v_exp_f32 v48, v48
    v_exp_f32 v49, v49
    v_mfma_f32_32x32x16_bf16 v[80:95], v[108:111], v[56:59], v[80:95]
    v_exp_f32 v50, v50
    v_exp_f32 v51, v51
    v_exp_f32 v52, v52
    v_exp_f32 v53, v53
    v_exp_f32 v54, v54
    v_exp_f32 v55, v55
    v_cvt_pk_bf16_f32 v60, v48, v49
    v_cvt_pk_bf16_f32 v61, v50, v51
    v_cvt_pk_bf16_f32 v62, v52, v53
    v_cvt_pk_bf16_f32 v63, v54, v55
    s_nop 1
    v_mfma_f32_32x32x16_bf16 v[80:95], v[116:119], v[60:63], v[80:95]
    ds_read_b128 v[96:99], v124 offset:40960
    ds_read_b64 v[104:105], v126 offset:41984
    v_exp_f32 v24, v24
    buffer_load_dwordx4 v[132:135], v4, s[28:31], s56 offen
    v_exp_f32 v25, v25
    s_add_u32 s56, s56, 8192
    v_exp_f32 v26, v26
    v_exp_f32 v27, v27
    v_mfma_f32_32x32x16_bf16 v[40:55], v[100:103], v[16:19], 0
    v_exp_f32 v28, v28
    v_exp_f32 v29, v29
    v_exp_f32 v30, v30
    v_exp_f32 v31, v31
    v_mfma_f32_32x32x8_bf16 v[40:55], v[106:107], v[22:23], v[40:55]
    v_cvt_pk_bf16_f32 v56, v24, v25
    v_cvt_pk_bf16_f32 v57, v26, v27
    v_cvt_pk_bf16_f32 v58, v28, v29
    v_cvt_pk_bf16_f32 v59, v30, v31
    v_exp_f32 v32, v32
    v_exp_f32 v33, v33
    s_waitcnt lgkmcnt(2)
    v_mfma_f32_32x32x16_bf16 v[64:79], v[112:115], v[56:59], v[64:79]
    v_exp_f32 v34, v34
    v_exp_f32 v35, v35
    v_exp_f32 v36, v36
    v_exp_f32 v37, v37
    v_exp_f32 v38, v38
    v_exp_f32 v39, v39
    v_cvt_pk_bf16_f32 v60, v32, v33
    v_cvt_pk_bf16_f32 v61, v34, v35
    v_cvt_pk_bf16_f32 v62, v36, v37
    v_cvt_pk_bf16_f32 v63, v38, v39
    s_nop 1
    v_mfma_f32_32x32x16_bf16 v[64:79], v[120:123], v[60:63], v[64:79]
    s_waitcnt lgkmcnt(0)
    ds_read_b128 v[108:111], v124 offset:43008
    ds_read_b128 v[116:119], v124 offset:44032
    v_exp_f32 v40, v40
    v_exp_f32 v41, v41
    v_exp_f32 v42, v42
    v_exp_f32 v43, v43
    v_mfma_f32_32x32x16_bf16 v[24:39], v[96:99], v[12:15], 0
    v_exp_f32 v44, v44
    v_exp_f32 v45, v45
    v_exp_f32 v46, v46
    v_exp_f32 v47, v47
    v_mfma_f32_32x32x8_bf16 v[24:39], v[104:105], v[20:21], v[24:39]
    v_cvt_pk_bf16_f32 v56, v40, v41
    v_cvt_pk_bf16_f32 v57, v42, v43
    v_cvt_pk_bf16_f32 v58, v44, v45
    v_cvt_pk_bf16_f32 v59, v46, v47
    v_exp_f32 v48, v48
    v_exp_f32 v49, v49
    v_mfma_f32_32x32x16_bf16 v[80:95], v[112:115], v[56:59], v[80:95]
    v_exp_f32 v50, v50
    v_exp_f32 v51, v51
    v_exp_f32 v52, v52
    v_exp_f32 v53, v53
    v_exp_f32 v54, v54
    v_exp_f32 v55, v55
    v_cvt_pk_bf16_f32 v60, v48, v49
    v_cvt_pk_bf16_f32 v61, v50, v51
    v_cvt_pk_bf16_f32 v62, v52, v53
    v_cvt_pk_bf16_f32 v63, v54, v55
    s_nop 1
    v_mfma_f32_32x32x16_bf16 v[80:95], v[120:123], v[60:63], v[80:95]
    ds_read_b128 v[100:103], v124 offset:45056
    ds_read_b64 v[106:107], v126 offset:46080
    v_exp_f32 v24, v24
    v_exp_f32 v25, v25
    v_exp_f32 v26, v26
    v_exp_f32 v27, v27
    v_mfma_f32_32x32x16_bf16 v[40:55], v[96:99], v[16:19], 0
    v_exp_f32 v28, v28
    v_exp_f32 v29, v29
    v_exp_f32 v30, v30
    v_exp_f32 v31, v31
    v_mfma_f32_32x32x8_bf16 v[40:55], v[104:105], v[22:23], v[40:55]
    v_cvt_pk_bf16_f32 v56, v24, v25
    v_cvt_pk_bf16_f32 v57, v26, v27
    v_cvt_pk_bf16_f32 v58, v28, v29
    v_cvt_pk_bf16_f32 v59, v30, v31
    v_exp_f32 v32, v32
    v_exp_f32 v33, v33
    s_waitcnt lgkmcnt(2)
    v_mfma_f32_32x32x16_bf16 v[64:79], v[108:111], v[56:59], v[64:79]
    v_exp_f32 v34, v34
    v_exp_f32 v35, v35
    v_exp_f32 v36, v36
    v_exp_f32 v37, v37
    v_exp_f32 v38, v38
    v_exp_f32 v39, v39
    v_cvt_pk_bf16_f32 v60, v32, v33
    v_cvt_pk_bf16_f32 v61, v34, v35
    v_cvt_pk_bf16_f32 v62, v36, v37
    v_cvt_pk_bf16_f32 v63, v38, v39
    s_nop 1
    v_mfma_f32_32x32x16_bf16 v[64:79], v[116:119], v[60:63], v[64:79]
    s_waitcnt lgkmcnt(0)
    ds_read_b128 v[112:115], v124 offset:47104
    ds_read_b128 v[120:123], v124 offset:48128
    v_exp_f32 v40, v40
    v_exp_f32 v41, v41
    v_exp_f32 v42, v42
    v_exp_f32 v43, v43
    v_mfma_f32_32x32x16_bf16 v[24:39], v[100:103], v[12:15], 0
    v_exp_f32 v44, v44
    v_exp_f32 v45, v45
    v_exp_f32 v46, v46
    v_exp_f32 v47, v47
    v_mfma_f32_32x32x8_bf16 v[24:39], v[106:107], v[20:21], v[24:39]
    v_cvt_pk_bf16_f32 v56, v40, v41
    v_cvt_pk_bf16_f32 v57, v42, v43
    v_cvt_pk_bf16_f32 v58, v44, v45
    v_cvt_pk_bf16_f32 v59, v46, v47
    v_exp_f32 v48, v48
    v_exp_f32 v49, v49
    v_mfma_f32_32x32x16_bf16 v[80:95], v[108:111], v[56:59], v[80:95]
    v_exp_f32 v50, v50
    v_exp_f32 v51, v51
    v_exp_f32 v52, v52
    v_exp_f32 v53, v53
    v_exp_f32 v54, v54
    v_exp_f32 v55, v55
    v_cvt_pk_bf16_f32 v60, v48, v49
    v_cvt_pk_bf16_f32 v61, v50, v51
    v_cvt_pk_bf16_f32 v62, v52, v53
    v_cvt_pk_bf16_f32 v63, v54, v55
    s_nop 1
    v_mfma_f32_32x32x16_bf16 v[80:95], v[116:119], v[60:63], v[80:95]
    s_waitcnt vmcnt(1)
    s_barrier
    ds_read_b128 v[96:99], v125 offset:0
    ds_read_b64 v[104:105], v127 offset:1024
    v_exp_f32 v24, v24
    s_add_u32 m0, s12, 0
    v_exp_f32 v25, v25
    s_mov_b32 s13, 49152
    v_exp_f32 v26, v26
    buffer_load_dwordx4 v129, s[16:19], s13 offen offset:0 lds
    v_exp_f32 v27, v27
    v_mfma_f32_32x32x16_bf16 v[40:55], v[100:103], v[16:19], 0
    v_exp_f32 v28, v28
    v_exp_f32 v29, v29
    v_exp_f32 v30, v30
    v_exp_f32 v31, v31
    v_mfma_f32_32x32x8_bf16 v[40:55], v[106:107], v[22:23], v[40:55]
    v_cvt_pk_bf16_f32 v56, v24, v25
    v_cvt_pk_bf16_f32 v57, v26, v27
    v_cvt_pk_bf16_f32 v58, v28, v29
    v_cvt_pk_bf16_f32 v59, v30, v31
    v_exp_f32 v32, v32
    v_exp_f32 v33, v33
    s_waitcnt lgkmcnt(2)
    v_mfma_f32_32x32x16_bf16 v[64:79], v[112:115], v[56:59], v[64:79]
    v_exp_f32 v34, v34
    v_exp_f32 v35, v35
    v_exp_f32 v36, v36
    v_exp_f32 v37, v37
    v_exp_f32 v38, v38
    v_exp_f32 v39, v39
    v_cvt_pk_bf16_f32 v60, v32, v33
    v_cvt_pk_bf16_f32 v61, v34, v35
    v_cvt_pk_bf16_f32 v62, v36, v37
    v_cvt_pk_bf16_f32 v63, v38, v39
    s_nop 1
    v_mfma_f32_32x32x16_bf16 v[64:79], v[120:123], v[60:63], v[64:79]
    s_waitcnt lgkmcnt(0)
    ds_read_b128 v[108:111], v125 offset:2048
    ds_read_b128 v[116:119], v125 offset:3072
    v_exp_f32 v40, v40
    buffer_load_dwordx4 v129, s[16:19], s13 offen offset:1024 lds
    v_exp_f32 v41, v41
    v_exp_f32 v42, v42
    v_exp_f32 v43, v43
    v_mfma_f32_32x32x16_bf16 v[24:39], v[96:99], v[12:15], 0
    v_exp_f32 v44, v44
    v_exp_f32 v45, v45
    v_exp_f32 v46, v46
    v_exp_f32 v47, v47
    v_mfma_f32_32x32x8_bf16 v[24:39], v[104:105], v[20:21], v[24:39]
    v_cvt_pk_bf16_f32 v56, v40, v41
    v_cvt_pk_bf16_f32 v57, v42, v43
    v_cvt_pk_bf16_f32 v58, v44, v45
    v_cvt_pk_bf16_f32 v59, v46, v47
    v_exp_f32 v48, v48
    v_exp_f32 v49, v49
    v_mfma_f32_32x32x16_bf16 v[80:95], v[112:115], v[56:59], v[80:95]
    v_exp_f32 v50, v50
    v_exp_f32 v51, v51
    v_exp_f32 v52, v52
    v_exp_f32 v53, v53
    v_exp_f32 v54, v54
    v_exp_f32 v55, v55
    v_cvt_pk_bf16_f32 v60, v48, v49
    v_cvt_pk_bf16_f32 v61, v50, v51
    v_cvt_pk_bf16_f32 v62, v52, v53
    v_cvt_pk_bf16_f32 v63, v54, v55
    s_nop 1
    v_mfma_f32_32x32x16_bf16 v[80:95], v[120:123], v[60:63], v[80:95]
    ds_read_b128 v[100:103], v125 offset:4096
    ds_read_b64 v[106:107], v127 offset:5120
    v_exp_f32 v24, v24
    buffer_load_dwordx4 v129, s[16:19], s13 offen offset:2048 lds
    v_exp_f32 v25, v25
    v_exp_f32 v26, v26
    v_exp_f32 v27, v27
    v_mfma_f32_32x32x16_bf16 v[40:55], v[96:99], v[16:19], 0
    v_exp_f32 v28, v28
    v_exp_f32 v29, v29
    v_exp_f32 v30, v30
    v_exp_f32 v31, v31
    v_mfma_f32_32x32x8_bf16 v[40:55], v[104:105], v[22:23], v[40:55]
    v_cvt_pk_bf16_f32 v56, v24, v25
    v_cvt_pk_bf16_f32 v57, v26, v27
    v_cvt_pk_bf16_f32 v58, v28, v29
    v_cvt_pk_bf16_f32 v59, v30, v31
    v_exp_f32 v32, v32
    v_exp_f32 v33, v33
    s_waitcnt lgkmcnt(2)
    v_mfma_f32_32x32x16_bf16 v[64:79], v[108:111], v[56:59], v[64:79]
    v_exp_f32 v34, v34
    v_exp_f32 v35, v35
    v_exp_f32 v36, v36
    v_exp_f32 v37, v37
    v_exp_f32 v38, v38
    v_exp_f32 v39, v39
    v_cvt_pk_bf16_f32 v60, v32, v33
    v_cvt_pk_bf16_f32 v61, v34, v35
    v_cvt_pk_bf16_f32 v62, v36, v37
    v_cvt_pk_bf16_f32 v63, v38, v39
    s_nop 1
    v_mfma_f32_32x32x16_bf16 v[64:79], v[116:119], v[60:63], v[64:79]
    s_waitcnt lgkmcnt(0)
    ds_read_b128 v[112:115], v125 offset:6144
    ds_read_b128 v[120:123], v125 offset:7168
    v_exp_f32 v40, v40
    buffer_load_dwordx4 v129, s[16:19], s13 offen offset:3072 lds
    v_exp_f32 v41, v41
    v_exp_f32 v42, v42
    v_exp_f32 v43, v43
    v_mfma_f32_32x32x16_bf16 v[24:39], v[100:103], v[12:15], 0
    v_exp_f32 v44, v44
    v_exp_f32 v45, v45
    v_exp_f32 v46, v46
    v_exp_f32 v47, v47
    v_mfma_f32_32x32x8_bf16 v[24:39], v[106:107], v[20:21], v[24:39]
    v_cvt_pk_bf16_f32 v56, v40, v41
    v_cvt_pk_bf16_f32 v57, v42, v43
    v_cvt_pk_bf16_f32 v58, v44, v45
    v_cvt_pk_bf16_f32 v59, v46, v47
    v_exp_f32 v48, v48
    v_exp_f32 v49, v49
    v_mfma_f32_32x32x16_bf16 v[80:95], v[108:111], v[56:59], v[80:95]
    v_exp_f32 v50, v50
    v_exp_f32 v51, v51
    v_exp_f32 v52, v52
    v_exp_f32 v53, v53
    v_exp_f32 v54, v54
    v_exp_f32 v55, v55
    v_cvt_pk_bf16_f32 v60, v48, v49
    v_cvt_pk_bf16_f32 v61, v50, v51
    v_cvt_pk_bf16_f32 v62, v52, v53
    v_cvt_pk_bf16_f32 v63, v54, v55
    s_nop 1
    v_mfma_f32_32x32x16_bf16 v[80:95], v[116:119], v[60:63], v[80:95]
    ds_read_b128 v[96:99], v125 offset:8192
    ds_read_b64 v[104:105], v127 offset:9216
    v_exp_f32 v24, v24
    buffer_load_dwordx4 v[132:135], v4, s[28:31], s56 offen
    v_exp_f32 v25, v25
    s_add_u32 s56, s56, 8192
    v_exp_f32 v26, v26
    v_exp_f32 v27, v27
    v_mfma_f32_32x32x16_bf16 v[40:55], v[100:103], v[16:19], 0
    v_exp_f32 v28, v28
    v_exp_f32 v29, v29
    v_exp_f32 v30, v30
    v_exp_f32 v31, v31
    v_mfma_f32_32x32x8_bf16 v[40:55], v[106:107], v[22:23], v[40:55]
    v_cvt_pk_bf16_f32 v56, v24, v25
    v_cvt_pk_bf16_f32 v57, v26, v27
    v_cvt_pk_bf16_f32 v58, v28, v29
    v_cvt_pk_bf16_f32 v59, v30, v31
    v_exp_f32 v32, v32
    v_exp_f32 v33, v33
    s_waitcnt lgkmcnt(2)
    v_mfma_f32_32x32x16_bf16 v[64:79], v[112:115], v[56:59], v[64:79]
    v_exp_f32 v34, v34
    v_exp_f32 v35, v35
    v_exp_f32 v36, v36
    v_exp_f32 v37, v37
    v_exp_f32 v38, v38
    v_exp_f32 v39, v39
    v_cvt_pk_bf16_f32 v60, v32, v33
    v_cvt_pk_bf16_f32 v61, v34, v35
    v_cvt_pk_bf16_f32 v62, v36, v37
    v_cvt_pk_bf16_f32 v63, v38, v39
    s_nop 1
    v_mfma_f32_32x32x16_bf16 v[64:79], v[120:123], v[60:63], v[64:79]
    s_waitcnt lgkmcnt(0)
    ds_read_b128 v[108:111], v125 offset:10240
    ds_read_b128 v[116:119], v125 offset:11264
    v_exp_f32 v40, v40
    v_exp_f32 v41, v41
    v_exp_f32 v42, v42
    v_exp_f32 v43, v43
    v_mfma_f32_32x32x16_bf16 v[24:39], v[96:99], v[12:15], 0
    v_exp_f32 v44, v44
    v_exp_f32 v45, v45
    v_exp_f32 v46, v46
    v_exp_f32 v47, v47
    v_mfma_f32_32x32x8_bf16 v[24:39], v[104:105], v[20:21], v[24:39]
    v_cvt_pk_bf16_f32 v56, v40, v41
    v_cvt_pk_bf16_f32 v57, v42, v43
    v_cvt_pk_bf16_f32 v58, v44, v45
    v_cvt_pk_bf16_f32 v59, v46, v47
    v_exp_f32 v48, v48
    v_exp_f32 v49, v49
    v_mfma_f32_32x32x16_bf16 v[80:95], v[112:115], v[56:59], v[80:95]
    v_exp_f32 v50, v50
    v_exp_f32 v51, v51
    v_exp_f32 v52, v52
    v_exp_f32 v53, v53
    v_exp_f32 v54, v54
    v_exp_f32 v55, v55
    v_cvt_pk_bf16_f32 v60, v48, v49
    v_cvt_pk_bf16_f32 v61, v50, v51
    v_cvt_pk_bf16_f32 v62, v52, v53
    v_cvt_pk_bf16_f32 v63, v54, v55
    s_nop 1
    v_mfma_f32_32x32x16_bf16 v[80:95], v[120:123], v[60:63], v[80:95]
    ds_read_b128 v[100:103], v125 offset:12288
    ds_read_b64 v[106:107], v127 offset:13312
    v_exp_f32 v24, v24
    v_exp_f32 v25, v25
    v_exp_f32 v26, v26
    v_exp_f32 v27, v27
    v_mfma_f32_32x32x16_bf16 v[40:55], v[96:99], v[16:19], 0
    v_exp_f32 v28, v28
    v_exp_f32 v29, v29
    v_exp_f32 v30, v30
    v_exp_f32 v31, v31
    v_mfma_f32_32x32x8_bf16 v[40:55], v[104:105], v[22:23], v[40:55]
    v_cvt_pk_bf16_f32 v56, v24, v25
    v_cvt_pk_bf16_f32 v57, v26, v27
    v_cvt_pk_bf16_f32 v58, v28, v29
    v_cvt_pk_bf16_f32 v59, v30, v31
    v_exp_f32 v32, v32
    v_exp_f32 v33, v33
    s_waitcnt lgkmcnt(2)
    v_mfma_f32_32x32x16_bf16 v[64:79], v[108:111], v[56:59], v[64:79]
    v_exp_f32 v34, v34
    v_exp_f32 v35, v35
    v_exp_f32 v36, v36
    v_exp_f32 v37, v37
    v_exp_f32 v38, v38
    v_exp_f32 v39, v39
    v_cvt_pk_bf16_f32 v60, v32, v33
    v_cvt_pk_bf16_f32 v61, v34, v35
    v_cvt_pk_bf16_f32 v62, v36, v37
    v_cvt_pk_bf16_f32 v63, v38, v39
    s_nop 1
    v_mfma_f32_32x32x16_bf16 v[64:79], v[116:119], v[60:63], v[64:79]
    s_waitcnt lgkmcnt(0)
    ds_read_b128 v[112:115], v125 offset:14336
    ds_read_b128 v[120:123], v125 offset:15360
    v_exp_f32 v40, v40
    v_exp_f32 v41, v41
    v_exp_f32 v42, v42
    v_exp_f32 v43, v43
    v_mfma_f32_32x32x16_bf16 v[24:39], v[100:103], v[12:15], 0
    v_exp_f32 v44, v44
    v_exp_f32 v45, v45
    v_exp_f32 v46, v46
    v_exp_f32 v47, v47
    v_mfma_f32_32x32x8_bf16 v[24:39], v[106:107], v[20:21], v[24:39]
    v_cvt_pk_bf16_f32 v56, v40, v41
    v_cvt_pk_bf16_f32 v57, v42, v43
    v_cvt_pk_bf16_f32 v58, v44, v45
    v_cvt_pk_bf16_f32 v59, v46, v47
    v_exp_f32 v48, v48
    v_exp_f32 v49, v49
    v_mfma_f32_32x32x16_bf16 v[80:95], v[108:111], v[56:59], v[80:95]
    v_exp_f32 v50, v50
    v_exp_f32 v51, v51
    v_exp_f32 v52, v52
    v_exp_f32 v53, v53
    v_exp_f32 v54, v54
    v_exp_f32 v55, v55
    v_cvt_pk_bf16_f32 v60, v48, v49
    v_cvt_pk_bf16_f32 v61, v50, v51
    v_cvt_pk_bf16_f32 v62, v52, v53
    v_cvt_pk_bf16_f32 v63, v54, v55
    s_nop 1
    v_mfma_f32_32x32x16_bf16 v[80:95], v[116:119], v[60:63], v[80:95]
    s_waitcnt vmcnt(1)
    s_barrier
    ds_read_b128 v[96:99], v124 offset:0
    ds_read_b64 v[104:105], v126 offset:1024
    v_exp_f32 v24, v24
    s_add_u32 m0, s12, 32768
    v_exp_f32 v25, v25
    s_mov_b32 s13, 65536
    v_exp_f32 v26, v26
    buffer_load_dwordx4 v129, s[16:19], s13 offen offset:0 lds
    v_exp_f32 v27, v27
    v_mfma_f32_32x32x16_bf16 v[40:55], v[100:103], v[16:19], 0
    v_exp_f32 v28, v28
    v_exp_f32 v29, v29
    v_exp_f32 v30, v30
    v_exp_f32 v31, v31
    v_mfma_f32_32x32x8_bf16 v[40:55], v[106:107], v[22:23], v[40:55]
    v_cvt_pk_bf16_f32 v56, v24, v25
    v_cvt_pk_bf16_f32 v57, v26, v27
    v_cvt_pk_bf16_f32 v58, v28, v29
    v_cvt_pk_bf16_f32 v59, v30, v31
    v_exp_f32 v32, v32
    v_exp_f32 v33, v33
    s_waitcnt lgkmcnt(2)
    v_mfma_f32_32x32x16_bf16 v[64:79], v[112:115], v[56:59], v[64:79]
    v_exp_f32 v34, v34
    v_exp_f32 v35, v35
    v_exp_f32 v36, v36
    v_exp_f32 v37, v37
    v_exp_f32 v38, v38
    v_exp_f32 v39, v39
    v_cvt_pk_bf16_f32 v60, v32, v33
    v_cvt_pk_bf16_f32 v61, v34, v35
    v_cvt_pk_bf16_f32 v62, v36, v37
    v_cvt_pk_bf16_f32 v63, v38, v39
    s_nop 1
    v_mfma_f32_32x32x16_bf16 v[64:79], v[120:123], v[60:63], v[64:79]
    s_waitcnt lgkmcnt(0)
    ds_read_b128 v[108:111], v124 offset:2048
    ds_read_b128 v[116:119], v124 offset:3072
    v_exp_f32 v40, v40
    buffer_load_dwordx4 v129, s[16:19], s13 offen offset:1024 lds
    v_exp_f32 v41, v41
    v_exp_f32 v42, v42
    v_exp_f32 v43, v43
    v_mfma_f32_32x32x16_bf16 v[24:39], v[96:99], v[12:15], 0
    v_exp_f32 v44, v44
    v_exp_f32 v45, v45
    v_exp_f32 v46, v46
    v_exp_f32 v47, v47
    v_mfma_f32_32x32x8_bf16 v[24:39], v[104:105], v[20:21], v[24:39]
    v_cvt_pk_bf16_f32 v56, v40, v41
    v_cvt_pk_bf16_f32 v57, v42, v43
    v_cvt_pk_bf16_f32 v58, v44, v45
    v_cvt_pk_bf16_f32 v59, v46, v47
    v_exp_f32 v48, v48
    v_exp_f32 v49, v49
    v_mfma_f32_32x32x16_bf16 v[80:95], v[112:115], v[56:59], v[80:95]
    v_exp_f32 v50, v50
    v_exp_f32 v51, v51
    v_exp_f32 v52, v52
    v_exp_f32 v53, v53
    v_exp_f32 v54, v54
    v_exp_f32 v55, v55
    v_cvt_pk_bf16_f32 v60, v48, v49
    v_cvt_pk_bf16_f32 v61, v50, v51
    v_cvt_pk_bf16_f32 v62, v52, v53
    v_cvt_pk_bf16_f32 v63, v54, v55
    s_nop 1
    v_mfma_f32_32x32x16_bf16 v[80:95], v[120:123], v[60:63], v[80:95]
    ds_read_b128 v[100:103], v124 offset:4096
    ds_read_b64 v[106:107], v126 offset:5120
    v_exp_f32 v24, v24
    buffer_load_dwordx4 v129, s[16:19], s13 offen offset:2048 lds
    v_exp_f32 v25, v25
    v_exp_f32 v26, v26
    v_exp_f32 v27, v27
    v_mfma_f32_32x32x16_bf16 v[40:55], v[96:99], v[16:19], 0
    v_exp_f32 v28, v28
    v_exp_f32 v29, v29
    v_exp_f32 v30, v30
    v_exp_f32 v31, v31
    v_mfma_f32_32x32x8_bf16 v[40:55], v[104:105], v[22:23], v[40:55]
    v_cvt_pk_bf16_f32 v56, v24, v25
    v_cvt_pk_bf16_f32 v57, v26, v27
    v_cvt_pk_bf16_f32 v58, v28, v29
    v_cvt_pk_bf16_f32 v59, v30, v31
    v_exp_f32 v32, v32
    v_exp_f32 v33, v33
    s_waitcnt lgkmcnt(2)
    v_mfma_f32_32x32x16_bf16 v[64:79], v[108:111], v[56:59], v[64:79]
    v_exp_f32 v34, v34
    v_exp_f32 v35, v35
    v_exp_f32 v36, v36
    v_exp_f32 v37, v37
    v_exp_f32 v38, v38
    v_exp_f32 v39, v39
    v_cvt_pk_bf16_f32 v60, v32, v33
    v_cvt_pk_bf16_f32 v61, v34, v35
    v_cvt_pk_bf16_f32 v62, v36, v37
    v_cvt_pk_bf16_f32 v63, v38, v39
    s_nop 1
    v_mfma_f32_32x32x16_bf16 v[64:79], v[116:119], v[60:63], v[64:79]
    s_waitcnt lgkmcnt(0)
    ds_read_b128 v[112:115], v124 offset:6144
    ds_read_b128 v[120:123], v124 offset:7168
    v_exp_f32 v40, v40
    buffer_load_dwordx4 v129, s[16:19], s13 offen offset:3072 lds
    v_exp_f32 v41, v41
    v_exp_f32 v42, v42
    v_exp_f32 v43, v43
    v_mfma_f32_32x32x16_bf16 v[24:39], v[100:103], v[12:15], 0
    v_exp_f32 v44, v44
    v_exp_f32 v45, v45
    v_exp_f32 v46, v46
    v_exp_f32 v47, v47
    v_mfma_f32_32x32x8_bf16 v[24:39], v[106:107], v[20:21], v[24:39]
    v_cvt_pk_bf16_f32 v56, v40, v41
    v_cvt_pk_bf16_f32 v57, v42, v43
    v_cvt_pk_bf16_f32 v58, v44, v45
    v_cvt_pk_bf16_f32 v59, v46, v47
    v_exp_f32 v48, v48
    v_exp_f32 v49, v49
    v_mfma_f32_32x32x16_bf16 v[80:95], v[108:111], v[56:59], v[80:95]
    v_exp_f32 v50, v50
    v_exp_f32 v51, v51
    v_exp_f32 v52, v52
    v_exp_f32 v53, v53
    v_exp_f32 v54, v54
    v_exp_f32 v55, v55
    v_cvt_pk_bf16_f32 v60, v48, v49
    v_cvt_pk_bf16_f32 v61, v50, v51
    v_cvt_pk_bf16_f32 v62, v52, v53
    v_cvt_pk_bf16_f32 v63, v54, v55
    s_nop 1
    v_mfma_f32_32x32x16_bf16 v[80:95], v[116:119], v[60:63], v[80:95]
    ds_read_b128 v[96:99], v124 offset:8192
    ds_read_b64 v[104:105], v126 offset:9216
    v_exp_f32 v24, v24
    buffer_load_dwordx4 v[132:135], v136, s[32:35], s57 offen
    v_exp_f32 v25, v25
    v_exp_f32 v26, v26
    v_exp_f32 v27, v27
    v_mfma_f32_32x32x16_bf16 v[40:55], v[100:103], v[16:19], 0
    v_exp_f32 v28, v28
    v_exp_f32 v29, v29
    v_exp_f32 v30, v30
    v_exp_f32 v31, v31
    v_mfma_f32_32x32x8_bf16 v[40:55], v[106:107], v[22:23], v[40:55]
    v_cvt_pk_bf16_f32 v56, v24, v25
    v_cvt_pk_bf16_f32 v57, v26, v27
    v_cvt_pk_bf16_f32 v58, v28, v29
    v_cvt_pk_bf16_f32 v59, v30, v31
    v_exp_f32 v32, v32
    v_exp_f32 v33, v33
    s_waitcnt lgkmcnt(2)
    v_mfma_f32_32x32x16_bf16 v[64:79], v[112:115], v[56:59], v[64:79]
    v_exp_f32 v34, v34
    v_exp_f32 v35, v35
    v_exp_f32 v36, v36
    v_exp_f32 v37, v37
    v_exp_f32 v38, v38
    v_exp_f32 v39, v39
    v_cvt_pk_bf16_f32 v60, v32, v33
    v_cvt_pk_bf16_f32 v61, v34, v35
    v_cvt_pk_bf16_f32 v62, v36, v37
    v_cvt_pk_bf16_f32 v63, v38, v39
    s_nop 1
    v_mfma_f32_32x32x16_bf16 v[64:79], v[120:123], v[60:63], v[64:79]
    s_waitcnt lgkmcnt(0)
    ds_read_b128 v[108:111], v124 offset:10240
    ds_read_b128 v[116:119], v124 offset:11264
    v_exp_f32 v40, v40
    v_exp_f32 v41, v41
    v_exp_f32 v42, v42
    v_exp_f32 v43, v43
    v_mfma_f32_32x32x16_bf16 v[24:39], v[96:99], v[12:15], 0
    v_exp_f32 v44, v44
    v_exp_f32 v45, v45
    v_exp_f32 v46, v46
    v_exp_f32 v47, v47
    v_mfma_f32_32x32x8_bf16 v[24:39], v[104:105], v[20:21], v[24:39]
    v_cvt_pk_bf16_f32 v56, v40, v41
    v_cvt_pk_bf16_f32 v57, v42, v43
    v_cvt_pk_bf16_f32 v58, v44, v45
    v_cvt_pk_bf16_f32 v59, v46, v47
    v_exp_f32 v48, v48
    v_exp_f32 v49, v49
    v_mfma_f32_32x32x16_bf16 v[80:95], v[112:115], v[56:59], v[80:95]
    v_exp_f32 v50, v50
    v_exp_f32 v51, v51
    v_exp_f32 v52, v52
    v_exp_f32 v53, v53
    v_exp_f32 v54, v54
    v_exp_f32 v55, v55
    v_cvt_pk_bf16_f32 v60, v48, v49
    v_cvt_pk_bf16_f32 v61, v50, v51
    v_cvt_pk_bf16_f32 v62, v52, v53
    v_cvt_pk_bf16_f32 v63, v54, v55
    s_nop 1
    v_mfma_f32_32x32x16_bf16 v[80:95], v[120:123], v[60:63], v[80:95]
    ds_read_b128 v[100:103], v124 offset:12288
    ds_read_b64 v[106:107], v126 offset:13312
    v_exp_f32 v24, v24
    v_exp_f32 v25, v25
    v_exp_f32 v26, v26
    v_exp_f32 v27, v27
    v_mfma_f32_32x32x16_bf16 v[40:55], v[96:99], v[16:19], 0
    v_exp_f32 v28, v28
    v_exp_f32 v29, v29
    v_exp_f32 v30, v30
    v_exp_f32 v31, v31
    v_mfma_f32_32x32x8_bf16 v[40:55], v[104:105], v[22:23], v[40:55]
    v_cvt_pk_bf16_f32 v56, v24, v25
    v_cvt_pk_bf16_f32 v57, v26, v27
    v_cvt_pk_bf16_f32 v58, v28, v29
    v_cvt_pk_bf16_f32 v59, v30, v31
    v_exp_f32 v32, v32
    v_exp_f32 v33, v33
    s_waitcnt lgkmcnt(2)
    v_mfma_f32_32x32x16_bf16 v[64:79], v[108:111], v[56:59], v[64:79]
    v_exp_f32 v34, v34
    v_exp_f32 v35, v35
    v_exp_f32 v36, v36
    v_exp_f32 v37, v37
    v_exp_f32 v38, v38
    v_exp_f32 v39, v39
    v_cvt_pk_bf16_f32 v60, v32, v33
    v_cvt_pk_bf16_f32 v61, v34, v35
    v_cvt_pk_bf16_f32 v62, v36, v37
    v_cvt_pk_bf16_f32 v63, v38, v39
    s_nop 1
    v_mfma_f32_32x32x16_bf16 v[64:79], v[116:119], v[60:63], v[64:79]
    s_waitcnt lgkmcnt(0)
    ds_read_b128 v[112:115], v124 offset:14336
    ds_read_b128 v[120:123], v124 offset:15360
    v_exp_f32 v40, v40
    v_exp_f32 v41, v41
    v_exp_f32 v42, v42
    v_exp_f32 v43, v43
    v_mfma_f32_32x32x16_bf16 v[24:39], v[100:103], v[12:15], 0
    v_exp_f32 v44, v44
    v_exp_f32 v45, v45
    v_exp_f32 v46, v46
    v_exp_f32 v47, v47
    v_mfma_f32_32x32x8_bf16 v[24:39], v[106:107], v[20:21], v[24:39]
    v_cvt_pk_bf16_f32 v56, v40, v41
    v_cvt_pk_bf16_f32 v57, v42, v43
    v_cvt_pk_bf16_f32 v58, v44, v45
    v_cvt_pk_bf16_f32 v59, v46, v47
    v_exp_f32 v48, v48
    v_exp_f32 v49, v49
    v_mfma_f32_32x32x16_bf16 v[80:95], v[108:111], v[56:59], v[80:95]
    v_exp_f32 v50, v50
    v_exp_f32 v51, v51
    v_exp_f32 v52, v52
    v_exp_f32 v53, v53
    v_exp_f32 v54, v54
    v_exp_f32 v55, v55
    v_cvt_pk_bf16_f32 v60, v48, v49
    v_cvt_pk_bf16_f32 v61, v50, v51
    v_cvt_pk_bf16_f32 v62, v52, v53
    v_cvt_pk_bf16_f32 v63, v54, v55
    s_nop 1
    v_mfma_f32_32x32x16_bf16 v[80:95], v[116:119], v[60:63], v[80:95]
    s_waitcnt vmcnt(1)
    s_barrier
    ds_read_b128 v[96:99], v124 offset:32768
    ds_read_b64 v[104:105], v126 offset:33792
    v_exp_f32 v24, v24
    s_add_u32 m0, s12, 65536
    v_exp_f32 v25, v25
    s_mov_b32 s13, 81920
    v_exp_f32 v26, v26
    buffer_load_dwordx4 v129, s[16:19], s13 offen offset:0 lds
    v_exp_f32 v27, v27
    v_mfma_f32_32x32x16_bf16 v[40:55], v[100:103], v[16:19], 0
    v_exp_f32 v28, v28
    v_exp_f32 v29, v29
    v_exp_f32 v30, v30
    v_exp_f32 v31, v31
    v_mfma_f32_32x32x8_bf16 v[40:55], v[106:107], v[22:23], v[40:55]
    v_cvt_pk_bf16_f32 v56, v24, v25
    v_cvt_pk_bf16_f32 v57, v26, v27
    v_cvt_pk_bf16_f32 v58, v28, v29
    v_cvt_pk_bf16_f32 v59, v30, v31
    v_exp_f32 v32, v32
    v_exp_f32 v33, v33
    s_waitcnt lgkmcnt(2)
    v_mfma_f32_32x32x16_bf16 v[64:79], v[112:115], v[56:59], v[64:79]
    v_exp_f32 v34, v34
    v_exp_f32 v35, v35
    v_exp_f32 v36, v36
    v_exp_f32 v37, v37
    v_exp_f32 v38, v38
    v_exp_f32 v39, v39
    v_cvt_pk_bf16_f32 v60, v32, v33
    v_cvt_pk_bf16_f32 v61, v34, v35
    v_cvt_pk_bf16_f32 v62, v36, v37
    v_cvt_pk_bf16_f32 v63, v38, v39
    s_nop 1
    v_mfma_f32_32x32x16_bf16 v[64:79], v[120:123], v[60:63], v[64:79]
    s_waitcnt lgkmcnt(0)
    ds_read_b128 v[108:111], v124 offset:34816
    ds_read_b128 v[116:119], v124 offset:35840
    v_exp_f32 v40, v40
    buffer_load_dwordx4 v129, s[16:19], s13 offen offset:1024 lds
    v_exp_f32 v41, v41
    v_exp_f32 v42, v42
    v_exp_f32 v43, v43
    v_mfma_f32_32x32x16_bf16 v[24:39], v[96:99], v[12:15], 0
    v_exp_f32 v44, v44
    v_exp_f32 v45, v45
    v_exp_f32 v46, v46
    v_exp_f32 v47, v47
    v_mfma_f32_32x32x8_bf16 v[24:39], v[104:105], v[20:21], v[24:39]
    v_cvt_pk_bf16_f32 v56, v40, v41
    v_cvt_pk_bf16_f32 v57, v42, v43
    v_cvt_pk_bf16_f32 v58, v44, v45
    v_cvt_pk_bf16_f32 v59, v46, v47
    v_exp_f32 v48, v48
    v_exp_f32 v49, v49
    v_mfma_f32_32x32x16_bf16 v[80:95], v[112:115], v[56:59], v[80:95]
    v_exp_f32 v50, v50
    v_exp_f32 v51, v51
    v_exp_f32 v52, v52
    v_exp_f32 v53, v53
    v_exp_f32 v54, v54
    v_exp_f32 v55, v55
    v_cvt_pk_bf16_f32 v60, v48, v49
    v_cvt_pk_bf16_f32 v61, v50, v51
    v_cvt_pk_bf16_f32 v62, v52, v53
    v_cvt_pk_bf16_f32 v63, v54, v55
    s_nop 1
    v_mfma_f32_32x32x16_bf16 v[80:95], v[120:123], v[60:63], v[80:95]
    ds_read_b128 v[100:103], v124 offset:36864
    ds_read_b64 v[106:107], v126 offset:37888
    v_exp_f32 v24, v24
    buffer_load_dwordx4 v129, s[16:19], s13 offen offset:2048 lds
    v_exp_f32 v25, v25
    v_exp_f32 v26, v26
    v_exp_f32 v27, v27
    v_mfma_f32_32x32x16_bf16 v[40:55], v[96:99], v[16:19], 0
    v_exp_f32 v28, v28
    v_exp_f32 v29, v29
    v_exp_f32 v30, v30
    v_exp_f32 v31, v31
    v_mfma_f32_32x32x8_bf16 v[40:55], v[104:105], v[22:23], v[40:55]
    v_cvt_pk_bf16_f32 v56, v24, v25
    v_cvt_pk_bf16_f32 v57, v26, v27
    v_cvt_pk_bf16_f32 v58, v28, v29
    v_cvt_pk_bf16_f32 v59, v30, v31
    v_exp_f32 v32, v32
    v_exp_f32 v33, v33
    s_waitcnt lgkmcnt(2)
    v_mfma_f32_32x32x16_bf16 v[64:79], v[108:111], v[56:59], v[64:79]
    v_exp_f32 v34, v34
    v_exp_f32 v35, v35
    v_exp_f32 v36, v36
    v_exp_f32 v37, v37
    v_exp_f32 v38, v38
    v_exp_f32 v39, v39
    v_cvt_pk_bf16_f32 v60, v32, v33
    v_cvt_pk_bf16_f32 v61, v34, v35
    v_cvt_pk_bf16_f32 v62, v36, v37
    v_cvt_pk_bf16_f32 v63, v38, v39
    s_nop 1
    v_mfma_f32_32x32x16_bf16 v[64:79], v[116:119], v[60:63], v[64:79]
    s_waitcnt lgkmcnt(0)
    ds_read_b128 v[112:115], v124 offset:38912
    ds_read_b128 v[120:123], v124 offset:39936
    v_exp_f32 v40, v40
    buffer_load_dwordx4 v129, s[16:19], s13 offen offset:3072 lds
    v_exp_f32 v41, v41
    v_exp_f32 v42, v42
    v_exp_f32 v43, v43
    v_mfma_f32_32x32x16_bf16 v[24:39], v[100:103], v[12:15], 0
    v_exp_f32 v44, v44
    v_exp_f32 v45, v45
    v_exp_f32 v46, v46
    v_exp_f32 v47, v47
    v_mfma_f32_32x32x8_bf16 v[24:39], v[106:107], v[20:21], v[24:39]
    v_cvt_pk_bf16_f32 v56, v40, v41
    v_cvt_pk_bf16_f32 v57, v42, v43
    v_cvt_pk_bf16_f32 v58, v44, v45
    v_cvt_pk_bf16_f32 v59, v46, v47
    v_exp_f32 v48, v48
    v_exp_f32 v49, v49
    v_mfma_f32_32x32x16_bf16 v[80:95], v[108:111], v[56:59], v[80:95]
    v_exp_f32 v50, v50
    v_exp_f32 v51, v51
    v_exp_f32 v52, v52
    v_exp_f32 v53, v53
    v_exp_f32 v54, v54
    v_exp_f32 v55, v55
    v_cvt_pk_bf16_f32 v60, v48, v49
    v_cvt_pk_bf16_f32 v61, v50, v51
    v_cvt_pk_bf16_f32 v62, v52, v53
    v_cvt_pk_bf16_f32 v63, v54, v55
    s_nop 1
    v_mfma_f32_32x32x16_bf16 v[80:95], v[116:119], v[60:63], v[80:95]
    ds_read_b128 v[96:99], v124 offset:40960
    ds_read_b64 v[104:105], v126 offset:41984
    v_exp_f32 v24, v24
    buffer_load_dwordx4 v[132:135], v136, s[32:35], s53 offen
    v_exp_f32 v25, v25
    v_exp_f32 v26, v26
    v_exp_f32 v27, v27
    v_mfma_f32_32x32x16_bf16 v[40:55], v[100:103], v[16:19], 0
    v_exp_f32 v28, v28
    v_exp_f32 v29, v29
    v_exp_f32 v30, v30
    v_exp_f32 v31, v31
    v_mfma_f32_32x32x8_bf16 v[40:55], v[106:107], v[22:23], v[40:55]
    v_cvt_pk_bf16_f32 v56, v24, v25
    v_cvt_pk_bf16_f32 v57, v26, v27
    v_cvt_pk_bf16_f32 v58, v28, v29
    v_cvt_pk_bf16_f32 v59, v30, v31
    v_exp_f32 v32, v32
    v_exp_f32 v33, v33
    s_waitcnt lgkmcnt(2)
    v_mfma_f32_32x32x16_bf16 v[64:79], v[112:115], v[56:59], v[64:79]
    v_exp_f32 v34, v34
    v_exp_f32 v35, v35
    v_exp_f32 v36, v36
    v_exp_f32 v37, v37
    v_exp_f32 v38, v38
    v_exp_f32 v39, v39
    v_cvt_pk_bf16_f32 v60, v32, v33
    v_cvt_pk_bf16_f32 v61, v34, v35
    v_cvt_pk_bf16_f32 v62, v36, v37
    v_cvt_pk_bf16_f32 v63, v38, v39
    s_nop 1
    v_mfma_f32_32x32x16_bf16 v[64:79], v[120:123], v[60:63], v[64:79]
    s_waitcnt lgkmcnt(0)
    ds_read_b128 v[108:111], v124 offset:43008
    ds_read_b128 v[116:119], v124 offset:44032
    v_exp_f32 v40, v40
    v_exp_f32 v41, v41
    v_exp_f32 v42, v42
    v_exp_f32 v43, v43
    v_mfma_f32_32x32x16_bf16 v[24:39], v[96:99], v[12:15], 0
    v_exp_f32 v44, v44
    v_exp_f32 v45, v45
    v_exp_f32 v46, v46
    v_exp_f32 v47, v47
    v_mfma_f32_32x32x8_bf16 v[24:39], v[104:105], v[20:21], v[24:39]
    v_cvt_pk_bf16_f32 v56, v40, v41
    v_cvt_pk_bf16_f32 v57, v42, v43
    v_cvt_pk_bf16_f32 v58, v44, v45
    v_cvt_pk_bf16_f32 v59, v46, v47
    v_exp_f32 v48, v48
    v_exp_f32 v49, v49
    v_mfma_f32_32x32x16_bf16 v[80:95], v[112:115], v[56:59], v[80:95]
    v_exp_f32 v50, v50
    v_exp_f32 v51, v51
    v_exp_f32 v52, v52
    v_exp_f32 v53, v53
    v_exp_f32 v54, v54
    v_exp_f32 v55, v55
    v_cvt_pk_bf16_f32 v60, v48, v49
    v_cvt_pk_bf16_f32 v61, v50, v51
    v_cvt_pk_bf16_f32 v62, v52, v53
    v_cvt_pk_bf16_f32 v63, v54, v55
    s_nop 1
    v_mfma_f32_32x32x16_bf16 v[80:95], v[120:123], v[60:63], v[80:95]
    ds_read_b128 v[100:103], v124 offset:45056
    ds_read_b64 v[106:107], v126 offset:46080
    v_exp_f32 v24, v24
    v_exp_f32 v25, v25
    v_exp_f32 v26, v26
    v_exp_f32 v27, v27
    v_mfma_f32_32x32x16_bf16 v[40:55], v[96:99], v[16:19], 0
    v_exp_f32 v28, v28
    v_exp_f32 v29, v29
    v_exp_f32 v30, v30
    v_exp_f32 v31, v31
    v_mfma_f32_32x32x8_bf16 v[40:55], v[104:105], v[22:23], v[40:55]
    v_cvt_pk_bf16_f32 v56, v24, v25
    v_cvt_pk_bf16_f32 v57, v26, v27
    v_cvt_pk_bf16_f32 v58, v28, v29
    v_cvt_pk_bf16_f32 v59, v30, v31
    v_exp_f32 v32, v32
    v_exp_f32 v33, v33
    s_waitcnt lgkmcnt(2)
    v_mfma_f32_32x32x16_bf16 v[64:79], v[108:111], v[56:59], v[64:79]
    v_exp_f32 v34, v34
    v_exp_f32 v35, v35
    v_exp_f32 v36, v36
    v_exp_f32 v37, v37
    v_exp_f32 v38, v38
    v_exp_f32 v39, v39
    v_cvt_pk_bf16_f32 v60, v32, v33
    v_cvt_pk_bf16_f32 v61, v34, v35
    v_cvt_pk_bf16_f32 v62, v36, v37
    v_cvt_pk_bf16_f32 v63, v38, v39
    s_nop 1
    v_mfma_f32_32x32x16_bf16 v[64:79], v[116:119], v[60:63], v[64:79]
    s_waitcnt lgkmcnt(0)
    ds_read_b128 v[112:115], v124 offset:47104
    ds_read_b128 v[120:123], v124 offset:48128
    v_exp_f32 v40, v40
    v_exp_f32 v41, v41
    v_exp_f32 v42, v42
    v_exp_f32 v43, v43
    v_mfma_f32_32x32x16_bf16 v[24:39], v[100:103], v[12:15], 0
    v_exp_f32 v44, v44
    v_exp_f32 v45, v45
    v_exp_f32 v46, v46
    v_exp_f32 v47, v47
    v_mfma_f32_32x32x8_bf16 v[24:39], v[106:107], v[20:21], v[24:39]
    v_cvt_pk_bf16_f32 v56, v40, v41
    v_cvt_pk_bf16_f32 v57, v42, v43
    v_cvt_pk_bf16_f32 v58, v44, v45
    v_cvt_pk_bf16_f32 v59, v46, v47
    v_exp_f32 v48, v48
    v_exp_f32 v49, v49
    v_mfma_f32_32x32x16_bf16 v[80:95], v[108:111], v[56:59], v[80:95]
    v_exp_f32 v50, v50
    v_exp_f32 v51, v51
    v_exp_f32 v52, v52
    v_exp_f32 v53, v53
    v_exp_f32 v54, v54
    v_exp_f32 v55, v55
    v_cvt_pk_bf16_f32 v60, v48, v49
    v_cvt_pk_bf16_f32 v61, v50, v51
    v_cvt_pk_bf16_f32 v62, v52, v53
    v_cvt_pk_bf16_f32 v63, v54, v55
    s_nop 1
    v_mfma_f32_32x32x16_bf16 v[80:95], v[116:119], v[60:63], v[80:95]
    s_waitcnt vmcnt(1)
    s_barrier
    ds_read_b128 v[96:99], v125 offset:0
    ds_read_b64 v[104:105], v127 offset:1024
    v_exp_f32 v24, v24
    s_add_u32 m0, s12, 0
    v_exp_f32 v25, v25
    s_mov_b32 s13, 98304
    v_exp_f32 v26, v26
    buffer_load_dwordx4 v129, s[16:19], s13 offen offset:0 lds
    v_exp_f32 v27, v27
    v_mfma_f32_32x32x16_bf16 v[40:55], v[100:103], v[16:19], 0
    v_exp_f32 v28, v28
    v_exp_f32 v29, v29
    v_exp_f32 v30, v30
    v_exp_f32 v31, v31
    v_mfma_f32_32x32x8_bf16 v[40:55], v[106:107], v[22:23], v[40:55]
    v_cvt_pk_bf16_f32 v56, v24, v25
    v_cvt_pk_bf16_f32 v57, v26, v27
    v_cvt_pk_bf16_f32 v58, v28, v29
    v_cvt_pk_bf16_f32 v59, v30, v31
    v_exp_f32 v32, v32
    v_exp_f32 v33, v33
    s_waitcnt lgkmcnt(2)
    v_mfma_f32_32x32x16_bf16 v[64:79], v[112:115], v[56:59], v[64:79]
    v_exp_f32 v34, v34
    v_exp_f32 v35, v35
    v_exp_f32 v36, v36
    v_exp_f32 v37, v37
    v_exp_f32 v38, v38
    v_exp_f32 v39, v39
    v_cvt_pk_bf16_f32 v60, v32, v33
    v_cvt_pk_bf16_f32 v61, v34, v35
    v_cvt_pk_bf16_f32 v62, v36, v37
    v_cvt_pk_bf16_f32 v63, v38, v39
    s_nop 1
    v_mfma_f32_32x32x16_bf16 v[64:79], v[120:123], v[60:63], v[64:79]
    s_waitcnt lgkmcnt(0)
    ds_read_b128 v[108:111], v125 offset:2048
    ds_read_b128 v[116:119], v125 offset:3072
    v_exp_f32 v40, v40
    buffer_load_dwordx4 v129, s[16:19], s13 offen offset:1024 lds
    v_exp_f32 v41, v41
    v_exp_f32 v42, v42
    v_exp_f32 v43, v43
    v_mfma_f32_32x32x16_bf16 v[24:39], v[96:99], v[12:15], 0
    v_exp_f32 v44, v44
    v_exp_f32 v45, v45
    v_exp_f32 v46, v46
    v_exp_f32 v47, v47
    v_mfma_f32_32x32x8_bf16 v[24:39], v[104:105], v[20:21], v[24:39]
    v_cvt_pk_bf16_f32 v56, v40, v41
    v_cvt_pk_bf16_f32 v57, v42, v43
    v_cvt_pk_bf16_f32 v58, v44, v45
    v_cvt_pk_bf16_f32 v59, v46, v47
    v_exp_f32 v48, v48
    v_exp_f32 v49, v49
    v_mfma_f32_32x32x16_bf16 v[80:95], v[112:115], v[56:59], v[80:95]
    v_exp_f32 v50, v50
    v_exp_f32 v51, v51
    v_exp_f32 v52, v52
    v_exp_f32 v53, v53
    v_exp_f32 v54, v54
    v_exp_f32 v55, v55
    v_cvt_pk_bf16_f32 v60, v48, v49
    v_cvt_pk_bf16_f32 v61, v50, v51
    v_cvt_pk_bf16_f32 v62, v52, v53
    v_cvt_pk_bf16_f32 v63, v54, v55
    s_nop 1
    v_mfma_f32_32x32x16_bf16 v[80:95], v[120:123], v[60:63], v[80:95]
    ds_read_b128 v[100:103], v125 offset:4096
    ds_read_b64 v[106:107], v127 offset:5120
    v_exp_f32 v24, v24
    buffer_load_dwordx4 v129, s[16:19], s13 offen offset:2048 lds
    v_exp_f32 v25, v25
    v_exp_f32 v26, v26
    v_exp_f32 v27, v27
    v_mfma_f32_32x32x16_bf16 v[40:55], v[96:99], v[16:19], 0
    v_exp_f32 v28, v28
    v_exp_f32 v29, v29
    v_exp_f32 v30, v30
    v_exp_f32 v31, v31
    v_mfma_f32_32x32x8_bf16 v[40:55], v[104:105], v[22:23], v[40:55]
    v_cvt_pk_bf16_f32 v56, v24, v25
    v_cvt_pk_bf16_f32 v57, v26, v27
    v_cvt_pk_bf16_f32 v58, v28, v29
    v_cvt_pk_bf16_f32 v59, v30, v31
    v_exp_f32 v32, v32
    v_exp_f32 v33, v33
    s_waitcnt lgkmcnt(2)
    v_mfma_f32_32x32x16_bf16 v[64:79], v[108:111], v[56:59], v[64:79]
    v_exp_f32 v34, v34
    v_exp_f32 v35, v35
    v_exp_f32 v36, v36
    v_exp_f32 v37, v37
    v_exp_f32 v38, v38
    v_exp_f32 v39, v39
    v_cvt_pk_bf16_f32 v60, v32, v33
    v_cvt_pk_bf16_f32 v61, v34, v35
    v_cvt_pk_bf16_f32 v62, v36, v37
    v_cvt_pk_bf16_f32 v63, v38, v39
    s_nop 1
    v_mfma_f32_32x32x16_bf16 v[64:79], v[116:119], v[60:63], v[64:79]
    s_waitcnt lgkmcnt(0)
    ds_read_b128 v[112:115], v125 offset:6144
    ds_read_b128 v[120:123], v125 offset:7168
    v_exp_f32 v40, v40
    buffer_load_dwordx4 v129, s[16:19], s13 offen offset:3072 lds
    v_exp_f32 v41, v41
    v_exp_f32 v42, v42
    v_exp_f32 v43, v43
    v_mfma_f32_32x32x16_bf16 v[24:39], v[100:103], v[12:15], 0
    v_exp_f32 v44, v44
    v_exp_f32 v45, v45
    v_exp_f32 v46, v46
    v_exp_f32 v47, v47
    v_mfma_f32_32x32x8_bf16 v[24:39], v[106:107], v[20:21], v[24:39]
    v_cvt_pk_bf16_f32 v56, v40, v41
    v_cvt_pk_bf16_f32 v57, v42, v43
    v_cvt_pk_bf16_f32 v58, v44, v45
    v_cvt_pk_bf16_f32 v59, v46, v47
    v_exp_f32 v48, v48
    v_exp_f32 v49, v49
    v_mfma_f32_32x32x16_bf16 v[80:95], v[108:111], v[56:59], v[80:95]
    v_exp_f32 v50, v50
    v_exp_f32 v51, v51
    v_exp_f32 v52, v52
    v_exp_f32 v53, v53
    v_exp_f32 v54, v54
    v_exp_f32 v55, v55
    v_cvt_pk_bf16_f32 v60, v48, v49
    v_cvt_pk_bf16_f32 v61, v50, v51
    v_cvt_pk_bf16_f32 v62, v52, v53
    v_cvt_pk_bf16_f32 v63, v54, v55
    s_nop 1
    v_mfma_f32_32x32x16_bf16 v[80:95], v[116:119], v[60:63], v[80:95]
    ds_read_b128 v[96:99], v125 offset:8192
    ds_read_b64 v[104:105], v127 offset:9216
    v_exp_f32 v24, v24
    buffer_load_dwordx4 v[132:135], v136, s[36:39], s57 offen
    v_exp_f32 v25, v25
    v_exp_f32 v26, v26
    v_exp_f32 v27, v27
    v_mfma_f32_32x32x16_bf16 v[40:55], v[100:103], v[16:19], 0
    v_exp_f32 v28, v28
    v_exp_f32 v29, v29
    v_exp_f32 v30, v30
    v_exp_f32 v31, v31
    v_mfma_f32_32x32x8_bf16 v[40:55], v[106:107], v[22:23], v[40:55]
    v_cvt_pk_bf16_f32 v56, v24, v25
    v_cvt_pk_bf16_f32 v57, v26, v27
    v_cvt_pk_bf16_f32 v58, v28, v29
    v_cvt_pk_bf16_f32 v59, v30, v31
    v_exp_f32 v32, v32
    v_exp_f32 v33, v33
    s_waitcnt lgkmcnt(2)
    v_mfma_f32_32x32x16_bf16 v[64:79], v[112:115], v[56:59], v[64:79]
    v_exp_f32 v34, v34
    v_exp_f32 v35, v35
    v_exp_f32 v36, v36
    v_exp_f32 v37, v37
    v_exp_f32 v38, v38
    v_exp_f32 v39, v39
    v_cvt_pk_bf16_f32 v60, v32, v33
    v_cvt_pk_bf16_f32 v61, v34, v35
    v_cvt_pk_bf16_f32 v62, v36, v37
    v_cvt_pk_bf16_f32 v63, v38, v39
    s_nop 1
    v_mfma_f32_32x32x16_bf16 v[64:79], v[120:123], v[60:63], v[64:79]
    s_waitcnt lgkmcnt(0)
    ds_read_b128 v[108:111], v125 offset:10240
    ds_read_b128 v[116:119], v125 offset:11264
    v_exp_f32 v40, v40
    v_exp_f32 v41, v41
    v_exp_f32 v42, v42
    v_exp_f32 v43, v43
    v_mfma_f32_32x32x16_bf16 v[24:39], v[96:99], v[12:15], 0
    v_exp_f32 v44, v44
    v_exp_f32 v45, v45
    v_exp_f32 v46, v46
    v_exp_f32 v47, v47
    v_mfma_f32_32x32x8_bf16 v[24:39], v[104:105], v[20:21], v[24:39]
    v_cvt_pk_bf16_f32 v56, v40, v41
    v_cvt_pk_bf16_f32 v57, v42, v43
    v_cvt_pk_bf16_f32 v58, v44, v45
    v_cvt_pk_bf16_f32 v59, v46, v47
    v_exp_f32 v48, v48
    v_exp_f32 v49, v49
    v_mfma_f32_32x32x16_bf16 v[80:95], v[112:115], v[56:59], v[80:95]
    v_exp_f32 v50, v50
    v_exp_f32 v51, v51
    v_exp_f32 v52, v52
    v_exp_f32 v53, v53
    v_exp_f32 v54, v54
    v_exp_f32 v55, v55
    v_cvt_pk_bf16_f32 v60, v48, v49
    v_cvt_pk_bf16_f32 v61, v50, v51
    v_cvt_pk_bf16_f32 v62, v52, v53
    v_cvt_pk_bf16_f32 v63, v54, v55
    s_nop 1
    v_mfma_f32_32x32x16_bf16 v[80:95], v[120:123], v[60:63], v[80:95]
    ds_read_b128 v[100:103], v125 offset:12288
    ds_read_b64 v[106:107], v127 offset:13312
    v_exp_f32 v24, v24
    v_exp_f32 v25, v25
    v_exp_f32 v26, v26
    v_exp_f32 v27, v27
    v_mfma_f32_32x32x16_bf16 v[40:55], v[96:99], v[16:19], 0
    v_exp_f32 v28, v28
    v_exp_f32 v29, v29
    v_exp_f32 v30, v30
    v_exp_f32 v31, v31
    v_mfma_f32_32x32x8_bf16 v[40:55], v[104:105], v[22:23], v[40:55]
    v_cvt_pk_bf16_f32 v56, v24, v25
    v_cvt_pk_bf16_f32 v57, v26, v27
    v_cvt_pk_bf16_f32 v58, v28, v29
    v_cvt_pk_bf16_f32 v59, v30, v31
    v_exp_f32 v32, v32
    v_exp_f32 v33, v33
    s_waitcnt lgkmcnt(2)
    v_mfma_f32_32x32x16_bf16 v[64:79], v[108:111], v[56:59], v[64:79]
    v_exp_f32 v34, v34
    v_exp_f32 v35, v35
    v_exp_f32 v36, v36
    v_exp_f32 v37, v37
    v_exp_f32 v38, v38
    v_exp_f32 v39, v39
    v_cvt_pk_bf16_f32 v60, v32, v33
    v_cvt_pk_bf16_f32 v61, v34, v35
    v_cvt_pk_bf16_f32 v62, v36, v37
    v_cvt_pk_bf16_f32 v63, v38, v39
    s_nop 1
    v_mfma_f32_32x32x16_bf16 v[64:79], v[116:119], v[60:63], v[64:79]
    s_waitcnt lgkmcnt(0)
    ds_read_b128 v[112:115], v125 offset:14336
    ds_read_b128 v[120:123], v125 offset:15360
    v_exp_f32 v40, v40
    v_exp_f32 v41, v41
    v_exp_f32 v42, v42
    v_exp_f32 v43, v43
    v_mfma_f32_32x32x16_bf16 v[24:39], v[100:103], v[12:15], 0
    v_exp_f32 v44, v44
    v_exp_f32 v45, v45
    v_exp_f32 v46, v46
    v_exp_f32 v47, v47
    v_mfma_f32_32x32x8_bf16 v[24:39], v[106:107], v[20:21], v[24:39]
    v_cvt_pk_bf16_f32 v56, v40, v41
    v_cvt_pk_bf16_f32 v57, v42, v43
    v_cvt_pk_bf16_f32 v58, v44, v45
    v_cvt_pk_bf16_f32 v59, v46, v47
    v_exp_f32 v48, v48
    v_exp_f32 v49, v49
    v_mfma_f32_32x32x16_bf16 v[80:95], v[108:111], v[56:59], v[80:95]
    v_exp_f32 v50, v50
    v_exp_f32 v51, v51
    v_exp_f32 v52, v52
    v_exp_f32 v53, v53
    v_exp_f32 v54, v54
    v_exp_f32 v55, v55
    v_cvt_pk_bf16_f32 v60, v48, v49
    v_cvt_pk_bf16_f32 v61, v50, v51
    v_cvt_pk_bf16_f32 v62, v52, v53
    v_cvt_pk_bf16_f32 v63, v54, v55
    s_nop 1
    v_mfma_f32_32x32x16_bf16 v[80:95], v[116:119], v[60:63], v[80:95]
    s_waitcnt vmcnt(1)
    s_barrier
    ds_read_b128 v[96:99], v124 offset:0
    ds_read_b64 v[104:105], v126 offset:1024
    v_exp_f32 v24, v24
    s_add_u32 m0, s12, 32768
    v_exp_f32 v25, v25
    s_mov_b32 s13, 114688
    v_exp_f32 v26, v26
    buffer_load_dwordx4 v129, s[16:19], s13 offen offset:0 lds
    v_exp_f32 v27, v27
    v_mfma_f32_32x32x16_bf16 v[40:55], v[100:103], v[16:19], 0
    v_exp_f32 v28, v28
    v_exp_f32 v29, v29
    v_exp_f32 v30, v30
    v_exp_f32 v31, v31
    v_mfma_f32_32x32x8_bf16 v[40:55], v[106:107], v[22:23], v[40:55]
    v_cvt_pk_bf16_f32 v56, v24, v25
    v_cvt_pk_bf16_f32 v57, v26, v27
    v_cvt_pk_bf16_f32 v58, v28, v29
    v_cvt_pk_bf16_f32 v59, v30, v31
    v_exp_f32 v32, v32
    v_exp_f32 v33, v33
    s_waitcnt lgkmcnt(2)
    v_mfma_f32_32x32x16_bf16 v[64:79], v[112:115], v[56:59], v[64:79]
    v_exp_f32 v34, v34
    v_exp_f32 v35, v35
    v_exp_f32 v36, v36
    v_exp_f32 v37, v37
    v_exp_f32 v38, v38
    v_exp_f32 v39, v39
    v_cvt_pk_bf16_f32 v60, v32, v33
    v_cvt_pk_bf16_f32 v61, v34, v35
    v_cvt_pk_bf16_f32 v62, v36, v37
    v_cvt_pk_bf16_f32 v63, v38, v39
    s_nop 1
    v_mfma_f32_32x32x16_bf16 v[64:79], v[120:123], v[60:63], v[64:79]
    s_waitcnt lgkmcnt(0)
    ds_read_b128 v[108:111], v124 offset:2048
    ds_read_b128 v[116:119], v124 offset:3072
    v_exp_f32 v40, v40
    buffer_load_dwordx4 v129, s[16:19], s13 offen offset:1024 lds
    v_exp_f32 v41, v41
    v_exp_f32 v42, v42
    v_exp_f32 v43, v43
    v_mfma_f32_32x32x16_bf16 v[24:39], v[96:99], v[12:15], 0
    v_exp_f32 v44, v44
    v_exp_f32 v45, v45
    v_exp_f32 v46, v46
    v_exp_f32 v47, v47
    v_mfma_f32_32x32x8_bf16 v[24:39], v[104:105], v[20:21], v[24:39]
    v_cvt_pk_bf16_f32 v56, v40, v41
    v_cvt_pk_bf16_f32 v57, v42, v43
    v_cvt_pk_bf16_f32 v58, v44, v45
    v_cvt_pk_bf16_f32 v59, v46, v47
    v_exp_f32 v48, v48
    v_exp_f32 v49, v49
    v_mfma_f32_32x32x16_bf16 v[80:95], v[112:115], v[56:59], v[80:95]
    v_exp_f32 v50, v50
    v_exp_f32 v51, v51
    v_exp_f32 v52, v52
    v_exp_f32 v53, v53
    v_exp_f32 v54, v54
    v_exp_f32 v55, v55
    v_cvt_pk_bf16_f32 v60, v48, v49
    v_cvt_pk_bf16_f32 v61, v50, v51
    v_cvt_pk_bf16_f32 v62, v52, v53
    v_cvt_pk_bf16_f32 v63, v54, v55
    s_nop 1
    v_mfma_f32_32x32x16_bf16 v[80:95], v[120:123], v[60:63], v[80:95]
    ds_read_b128 v[100:103], v124 offset:4096
    ds_read_b64 v[106:107], v126 offset:5120
    v_exp_f32 v24, v24
    buffer_load_dwordx4 v129, s[16:19], s13 offen offset:2048 lds
    v_exp_f32 v25, v25
    v_exp_f32 v26, v26
    v_exp_f32 v27, v27
    v_mfma_f32_32x32x16_bf16 v[40:55], v[96:99], v[16:19], 0
    v_exp_f32 v28, v28
    v_exp_f32 v29, v29
    v_exp_f32 v30, v30
    v_exp_f32 v31, v31
    v_mfma_f32_32x32x8_bf16 v[40:55], v[104:105], v[22:23], v[40:55]
    v_cvt_pk_bf16_f32 v56, v24, v25
    v_cvt_pk_bf16_f32 v57, v26, v27
    v_cvt_pk_bf16_f32 v58, v28, v29
    v_cvt_pk_bf16_f32 v59, v30, v31
    v_exp_f32 v32, v32
    v_exp_f32 v33, v33
    s_waitcnt lgkmcnt(2)
    v_mfma_f32_32x32x16_bf16 v[64:79], v[108:111], v[56:59], v[64:79]
    v_exp_f32 v34, v34
    v_exp_f32 v35, v35
    v_exp_f32 v36, v36
    v_exp_f32 v37, v37
    v_exp_f32 v38, v38
    v_exp_f32 v39, v39
    v_cvt_pk_bf16_f32 v60, v32, v33
    v_cvt_pk_bf16_f32 v61, v34, v35
    v_cvt_pk_bf16_f32 v62, v36, v37
    v_cvt_pk_bf16_f32 v63, v38, v39
    s_nop 1
    v_mfma_f32_32x32x16_bf16 v[64:79], v[116:119], v[60:63], v[64:79]
    s_waitcnt lgkmcnt(0)
    ds_read_b128 v[112:115], v124 offset:6144
    ds_read_b128 v[120:123], v124 offset:7168
    v_exp_f32 v40, v40
    buffer_load_dwordx4 v129, s[16:19], s13 offen offset:3072 lds
    v_exp_f32 v41, v41
    v_exp_f32 v42, v42
    v_exp_f32 v43, v43
    v_mfma_f32_32x32x16_bf16 v[24:39], v[100:103], v[12:15], 0
    v_exp_f32 v44, v44
    v_exp_f32 v45, v45
    v_exp_f32 v46, v46
    v_exp_f32 v47, v47
    v_mfma_f32_32x32x8_bf16 v[24:39], v[106:107], v[20:21], v[24:39]
    v_cvt_pk_bf16_f32 v56, v40, v41
    v_cvt_pk_bf16_f32 v57, v42, v43
    v_cvt_pk_bf16_f32 v58, v44, v45
    v_cvt_pk_bf16_f32 v59, v46, v47
    v_exp_f32 v48, v48
    v_exp_f32 v49, v49
    v_mfma_f32_32x32x16_bf16 v[80:95], v[108:111], v[56:59], v[80:95]
    v_exp_f32 v50, v50
    v_exp_f32 v51, v51
    v_exp_f32 v52, v52
    v_exp_f32 v53, v53
    v_exp_f32 v54, v54
    v_exp_f32 v55, v55
    v_cvt_pk_bf16_f32 v60, v48, v49
    v_cvt_pk_bf16_f32 v61, v50, v51
    v_cvt_pk_bf16_f32 v62, v52, v53
    v_cvt_pk_bf16_f32 v63, v54, v55
    s_nop 1
    v_mfma_f32_32x32x16_bf16 v[80:95], v[116:119], v[60:63], v[80:95]
    ds_read_b128 v[96:99], v124 offset:8192
    ds_read_b64 v[104:105], v126 offset:9216
    v_exp_f32 v24, v24
    buffer_load_dwordx4 v[132:135], v136, s[36:39], s53 offen
    v_exp_f32 v25, v25
    v_exp_f32 v26, v26
    v_exp_f32 v27, v27
    v_mfma_f32_32x32x16_bf16 v[40:55], v[100:103], v[16:19], 0
    v_exp_f32 v28, v28
    v_exp_f32 v29, v29
    v_exp_f32 v30, v30
    v_exp_f32 v31, v31
    v_mfma_f32_32x32x8_bf16 v[40:55], v[106:107], v[22:23], v[40:55]
    v_cvt_pk_bf16_f32 v56, v24, v25
    v_cvt_pk_bf16_f32 v57, v26, v27
    v_cvt_pk_bf16_f32 v58, v28, v29
    v_cvt_pk_bf16_f32 v59, v30, v31
    v_exp_f32 v32, v32
    v_exp_f32 v33, v33
    s_waitcnt lgkmcnt(2)
    v_mfma_f32_32x32x16_bf16 v[64:79], v[112:115], v[56:59], v[64:79]
    v_exp_f32 v34, v34
    v_exp_f32 v35, v35
    v_exp_f32 v36, v36
    v_exp_f32 v37, v37
    v_exp_f32 v38, v38
    v_exp_f32 v39, v39
    v_cvt_pk_bf16_f32 v60, v32, v33
    v_cvt_pk_bf16_f32 v61, v34, v35
    v_cvt_pk_bf16_f32 v62, v36, v37
    v_cvt_pk_bf16_f32 v63, v38, v39
    s_nop 1
    v_mfma_f32_32x32x16_bf16 v[64:79], v[120:123], v[60:63], v[64:79]
    s_waitcnt lgkmcnt(0)
    ds_read_b128 v[108:111], v124 offset:10240
    ds_read_b128 v[116:119], v124 offset:11264
    v_exp_f32 v40, v40
    v_exp_f32 v41, v41
    v_exp_f32 v42, v42
    v_exp_f32 v43, v43
    v_mfma_f32_32x32x16_bf16 v[24:39], v[96:99], v[12:15], 0
    v_exp_f32 v44, v44
    v_exp_f32 v45, v45
    v_exp_f32 v46, v46
    v_exp_f32 v47, v47
    v_mfma_f32_32x32x8_bf16 v[24:39], v[104:105], v[20:21], v[24:39]
    v_cvt_pk_bf16_f32 v56, v40, v41
    v_cvt_pk_bf16_f32 v57, v42, v43
    v_cvt_pk_bf16_f32 v58, v44, v45
    v_cvt_pk_bf16_f32 v59, v46, v47
    v_exp_f32 v48, v48
    v_exp_f32 v49, v49
    v_mfma_f32_32x32x16_bf16 v[80:95], v[112:115], v[56:59], v[80:95]
    v_exp_f32 v50, v50
    v_exp_f32 v51, v51
    v_exp_f32 v52, v52
    v_exp_f32 v53, v53
    v_exp_f32 v54, v54
    v_exp_f32 v55, v55
    v_cvt_pk_bf16_f32 v60, v48, v49
    v_cvt_pk_bf16_f32 v61, v50, v51
    v_cvt_pk_bf16_f32 v62, v52, v53
    v_cvt_pk_bf16_f32 v63, v54, v55
    s_nop 1
    v_mfma_f32_32x32x16_bf16 v[80:95], v[120:123], v[60:63], v[80:95]
    ds_read_b128 v[100:103], v124 offset:12288
    ds_read_b64 v[106:107], v126 offset:13312
    v_exp_f32 v24, v24
    buffer_load_dwordx4 v[132:135], v4, s[24:27], s3 offen
    v_exp_f32 v25, v25
    v_exp_f32 v26, v26
    v_exp_f32 v27, v27
    v_mfma_f32_32x32x16_bf16 v[40:55], v[96:99], v[16:19], 0
    v_exp_f32 v28, v28
    v_exp_f32 v29, v29
    v_exp_f32 v30, v30
    v_exp_f32 v31, v31
    v_mfma_f32_32x32x8_bf16 v[40:55], v[104:105], v[22:23], v[40:55]
    v_cvt_pk_bf16_f32 v56, v24, v25
    v_cvt_pk_bf16_f32 v57, v26, v27
    v_cvt_pk_bf16_f32 v58, v28, v29
    v_cvt_pk_bf16_f32 v59, v30, v31
    v_exp_f32 v32, v32
    v_exp_f32 v33, v33
    s_waitcnt lgkmcnt(2)
    v_mfma_f32_32x32x16_bf16 v[64:79], v[108:111], v[56:59], v[64:79]
    v_exp_f32 v34, v34
    v_exp_f32 v35, v35
    v_exp_f32 v36, v36
    v_exp_f32 v37, v37
    v_exp_f32 v38, v38
    v_exp_f32 v39, v39
    v_cvt_pk_bf16_f32 v60, v32, v33
    v_cvt_pk_bf16_f32 v61, v34, v35
    v_cvt_pk_bf16_f32 v62, v36, v37
    v_cvt_pk_bf16_f32 v63, v38, v39
    s_nop 1
    v_mfma_f32_32x32x16_bf16 v[64:79], v[116:119], v[60:63], v[64:79]
    s_waitcnt lgkmcnt(0)
    ds_read_b128 v[112:115], v124 offset:14336
    ds_read_b128 v[120:123], v124 offset:15360
    v_exp_f32 v40, v40
    v_exp_f32 v41, v41
    v_exp_f32 v42, v42
    v_exp_f32 v43, v43
    v_mfma_f32_32x32x16_bf16 v[24:39], v[100:103], v[12:15], 0
    v_exp_f32 v44, v44
    v_exp_f32 v45, v45
    v_exp_f32 v46, v46
    v_exp_f32 v47, v47
    v_mfma_f32_32x32x8_bf16 v[24:39], v[106:107], v[20:21], v[24:39]
    v_cvt_pk_bf16_f32 v56, v40, v41
    v_cvt_pk_bf16_f32 v57, v42, v43
    v_cvt_pk_bf16_f32 v58, v44, v45
    v_cvt_pk_bf16_f32 v59, v46, v47
    v_exp_f32 v48, v48
    v_exp_f32 v49, v49
    v_mfma_f32_32x32x16_bf16 v[80:95], v[108:111], v[56:59], v[80:95]
    v_exp_f32 v50, v50
    v_exp_f32 v51, v51
    v_exp_f32 v52, v52
    v_exp_f32 v53, v53
    v_exp_f32 v54, v54
    v_exp_f32 v55, v55
    v_cvt_pk_bf16_f32 v60, v48, v49
    v_cvt_pk_bf16_f32 v61, v50, v51
    v_cvt_pk_bf16_f32 v62, v52, v53
    v_cvt_pk_bf16_f32 v63, v54, v55
    s_nop 1
    v_mfma_f32_32x32x16_bf16 v[80:95], v[116:119], v[60:63], v[80:95]
    s_waitcnt vmcnt(2)
    s_barrier
    ds_read_b128 v[96:99], v124 offset:32768
    ds_read_b64 v[104:105], v126 offset:33792
    v_exp_f32 v24, v24
    s_add_u32 m0, s14, 99584
    v_exp_f32 v25, v25
    s_mov_b32 s13, 0
    v_exp_f32 v26, v26
    buffer_load_dwordx4 v130, s[28:31], s13 offen lds
    v_exp_f32 v27, v27
    v_mfma_f32_32x32x16_bf16 v[40:55], v[100:103], v[16:19], 0
    v_exp_f32 v28, v28
    v_exp_f32 v29, v29
    v_exp_f32 v30, v30
    v_exp_f32 v31, v31
    v_mfma_f32_32x32x8_bf16 v[40:55], v[106:107], v[22:23], v[40:55]
    v_cvt_pk_bf16_f32 v56, v24, v25
    v_cvt_pk_bf16_f32 v57, v26, v27
    v_cvt_pk_bf16_f32 v58, v28, v29
    v_cvt_pk_bf16_f32 v59, v30, v31
    v_exp_f32 v32, v32
    v_exp_f32 v33, v33
    s_waitcnt lgkmcnt(2)
    v_mfma_f32_32x32x16_bf16 v[64:79], v[112:115], v[56:59], v[64:79]
    v_exp_f32 v34, v34
    v_exp_f32 v35, v35
    v_exp_f32 v36, v36
    v_exp_f32 v37, v37
    v_exp_f32 v38, v38
    v_exp_f32 v39, v39
    v_cvt_pk_bf16_f32 v60, v32, v33
    v_cvt_pk_bf16_f32 v61, v34, v35
    v_cvt_pk_bf16_f32 v62, v36, v37
    v_cvt_pk_bf16_f32 v63, v38, v39
    s_nop 1
    v_mfma_f32_32x32x16_bf16 v[64:79], v[120:123], v[60:63], v[64:79]
    s_waitcnt lgkmcnt(0)
    ds_read_b128 v[108:111], v124 offset:34816
    ds_read_b128 v[116:119], v124 offset:35840
    v_exp_f32 v40, v40
    s_add_u32 m0, s14, 107776
    v_exp_f32 v41, v41
    s_mov_b32 s13, 81920
    v_exp_f32 v42, v42
    buffer_load_dwordx4 v130, s[28:31], s13 offen lds
    v_exp_f32 v43, v43
    v_mfma_f32_32x32x16_bf16 v[24:39], v[96:99], v[12:15], 0
    v_exp_f32 v44, v44
    v_exp_f32 v45, v45
    v_exp_f32 v46, v46
    v_exp_f32 v47, v47
    v_mfma_f32_32x32x8_bf16 v[24:39], v[104:105], v[20:21], v[24:39]
    v_cvt_pk_bf16_f32 v56, v40, v41
    v_cvt_pk_bf16_f32 v57, v42, v43
    v_cvt_pk_bf16_f32 v58, v44, v45
    v_cvt_pk_bf16_f32 v59, v46, v47
    v_exp_f32 v48, v48
    v_exp_f32 v49, v49
    v_mfma_f32_32x32x16_bf16 v[80:95], v[112:115], v[56:59], v[80:95]
    v_exp_f32 v50, v50
    v_exp_f32 v51, v51
    v_exp_f32 v52, v52
    v_exp_f32 v53, v53
    v_exp_f32 v54, v54
    v_exp_f32 v55, v55
    v_cvt_pk_bf16_f32 v60, v48, v49
    v_cvt_pk_bf16_f32 v61, v50, v51
    v_cvt_pk_bf16_f32 v62, v52, v53
    v_cvt_pk_bf16_f32 v63, v54, v55
    s_nop 1
    v_mfma_f32_32x32x16_bf16 v[80:95], v[120:123], v[60:63], v[80:95]
    ds_read_b128 v[100:103], v124 offset:36864
    ds_read_b64 v[106:107], v126 offset:37888
    v_exp_f32 v24, v24
    s_add_u32 m0, s14, 115968
    v_exp_f32 v25, v25
    s_mov_b32 s13, 163840
    v_exp_f32 v26, v26
    buffer_load_dwordx4 v130, s[28:31], s13 offen lds
    v_exp_f32 v27, v27
    v_mfma_f32_32x32x16_bf16 v[40:55], v[96:99], v[16:19], 0
    v_exp_f32 v28, v28
    v_exp_f32 v29, v29
    v_exp_f32 v30, v30
    v_exp_f32 v31, v31
    v_mfma_f32_32x32x8_bf16 v[40:55], v[104:105], v[22:23], v[40:55]
    v_cvt_pk_bf16_f32 v56, v24, v25
    v_cvt_pk_bf16_f32 v57, v26, v27
    v_cvt_pk_bf16_f32 v58, v28, v29
    v_cvt_pk_bf16_f32 v59, v30, v31
    v_exp_f32 v32, v32
    v_exp_f32 v33, v33
    s_waitcnt lgkmcnt(2)
    v_mfma_f32_32x32x16_bf16 v[64:79], v[108:111], v[56:59], v[64:79]
    v_exp_f32 v34, v34
    v_exp_f32 v35, v35
    v_exp_f32 v36, v36
    v_exp_f32 v37, v37
    v_exp_f32 v38, v38
    v_exp_f32 v39, v39
    v_cvt_pk_bf16_f32 v60, v32, v33
    v_cvt_pk_bf16_f32 v61, v34, v35
    v_cvt_pk_bf16_f32 v62, v36, v37
    v_cvt_pk_bf16_f32 v63, v38, v39
    s_nop 1
    v_mfma_f32_32x32x16_bf16 v[64:79], v[116:119], v[60:63], v[64:79]
    s_waitcnt lgkmcnt(0)
    ds_read_b128 v[112:115], v124 offset:38912
    ds_read_b128 v[120:123], v124 offset:39936
    v_exp_f32 v40, v40
    s_add_u32 m0, s14, 124160
    v_exp_f32 v41, v41
    s_mov_b32 s13, 245760
    v_exp_f32 v42, v42
    buffer_load_dwordx4 v130, s[28:31], s13 offen lds
    v_exp_f32 v43, v43
    v_mfma_f32_32x32x16_bf16 v[24:39], v[100:103], v[12:15], 0
    v_exp_f32 v44, v44
    v_exp_f32 v45, v45
    v_exp_f32 v46, v46
    v_exp_f32 v47, v47
    v_mfma_f32_32x32x8_bf16 v[24:39], v[106:107], v[20:21], v[24:39]
    v_cvt_pk_bf16_f32 v56, v40, v41
    v_cvt_pk_bf16_f32 v57, v42, v43
    v_cvt_pk_bf16_f32 v58, v44, v45
    v_cvt_pk_bf16_f32 v59, v46, v47
    v_exp_f32 v48, v48
    v_exp_f32 v49, v49
    v_mfma_f32_32x32x16_bf16 v[80:95], v[108:111], v[56:59], v[80:95]
    v_exp_f32 v50, v50
    v_exp_f32 v51, v51
    v_exp_f32 v52, v52
    v_exp_f32 v53, v53
    v_exp_f32 v54, v54
    v_exp_f32 v55, v55
    v_cvt_pk_bf16_f32 v60, v48, v49
    v_cvt_pk_bf16_f32 v61, v50, v51
    v_cvt_pk_bf16_f32 v62, v52, v53
    v_cvt_pk_bf16_f32 v63, v54, v55
    s_nop 1
    v_mfma_f32_32x32x16_bf16 v[80:95], v[116:119], v[60:63], v[80:95]
    ds_read_b128 v[96:99], v124 offset:40960
    ds_read_b64 v[104:105], v126 offset:41984
    v_exp_f32 v24, v24
    s_add_u32 m0, s14, 132352
    v_exp_f32 v25, v25
    s_mov_b32 s13, 327680
    v_exp_f32 v26, v26
    buffer_load_dwordx4 v130, s[28:31], s13 offen lds
    v_exp_f32 v27, v27
    v_mfma_f32_32x32x16_bf16 v[40:55], v[100:103], v[16:19], 0
    v_exp_f32 v28, v28
    v_exp_f32 v29, v29
    v_exp_f32 v30, v30
    v_exp_f32 v31, v31
    v_mfma_f32_32x32x8_bf16 v[40:55], v[106:107], v[22:23], v[40:55]
    v_cvt_pk_bf16_f32 v56, v24, v25
    v_cvt_pk_bf16_f32 v57, v26, v27
    v_cvt_pk_bf16_f32 v58, v28, v29
    v_cvt_pk_bf16_f32 v59, v30, v31
    v_exp_f32 v32, v32
    v_exp_f32 v33, v33
    s_waitcnt lgkmcnt(2)
    v_mfma_f32_32x32x16_bf16 v[64:79], v[112:115], v[56:59], v[64:79]
    v_exp_f32 v34, v34
    v_exp_f32 v35, v35
    v_exp_f32 v36, v36
    v_exp_f32 v37, v37
    v_exp_f32 v38, v38
    v_exp_f32 v39, v39
    v_cvt_pk_bf16_f32 v60, v32, v33
    v_cvt_pk_bf16_f32 v61, v34, v35
    v_cvt_pk_bf16_f32 v62, v36, v37
    v_cvt_pk_bf16_f32 v63, v38, v39
    s_nop 1
    v_mfma_f32_32x32x16_bf16 v[64:79], v[120:123], v[60:63], v[64:79]
    s_waitcnt lgkmcnt(0)
    ds_read_b128 v[108:111], v124 offset:43008
    ds_read_b128 v[116:119], v124 offset:44032
    v_exp_f32 v40, v40
    v_exp_f32 v41, v41
    v_exp_f32 v42, v42
    v_exp_f32 v43, v43
    v_mfma_f32_32x32x16_bf16 v[24:39], v[96:99], v[12:15], 0
    v_exp_f32 v44, v44
    v_exp_f32 v45, v45
    v_exp_f32 v46, v46
    v_exp_f32 v47, v47
    v_mfma_f32_32x32x8_bf16 v[24:39], v[104:105], v[20:21], v[24:39]
    v_cvt_pk_bf16_f32 v56, v40, v41
    v_cvt_pk_bf16_f32 v57, v42, v43
    v_cvt_pk_bf16_f32 v58, v44, v45
    v_cvt_pk_bf16_f32 v59, v46, v47
    v_exp_f32 v48, v48
    v_exp_f32 v49, v49
    v_mfma_f32_32x32x16_bf16 v[80:95], v[112:115], v[56:59], v[80:95]
    v_exp_f32 v50, v50
    v_exp_f32 v51, v51
    v_exp_f32 v52, v52
    v_exp_f32 v53, v53
    v_exp_f32 v54, v54
    v_exp_f32 v55, v55
    v_cvt_pk_bf16_f32 v60, v48, v49
    v_cvt_pk_bf16_f32 v61, v50, v51
    v_cvt_pk_bf16_f32 v62, v52, v53
    v_cvt_pk_bf16_f32 v63, v54, v55
    s_nop 1
    v_mfma_f32_32x32x16_bf16 v[80:95], v[120:123], v[60:63], v[80:95]
    ds_read_b128 v[100:103], v124 offset:45056
    ds_read_b64 v[106:107], v126 offset:46080
    v_exp_f32 v24, v24
    v_exp_f32 v25, v25
    v_exp_f32 v26, v26
    v_exp_f32 v27, v27
    v_mfma_f32_32x32x16_bf16 v[40:55], v[96:99], v[16:19], 0
    v_exp_f32 v28, v28
    v_exp_f32 v29, v29
    v_exp_f32 v30, v30
    v_exp_f32 v31, v31
    v_mfma_f32_32x32x8_bf16 v[40:55], v[104:105], v[22:23], v[40:55]
    v_cvt_pk_bf16_f32 v56, v24, v25
    v_cvt_pk_bf16_f32 v57, v26, v27
    v_cvt_pk_bf16_f32 v58, v28, v29
    v_cvt_pk_bf16_f32 v59, v30, v31
    v_exp_f32 v32, v32
    v_exp_f32 v33, v33
    s_waitcnt lgkmcnt(2)
    v_mfma_f32_32x32x16_bf16 v[64:79], v[108:111], v[56:59], v[64:79]
    v_exp_f32 v34, v34
    v_exp_f32 v35, v35
    v_exp_f32 v36, v36
    v_exp_f32 v37, v37
    v_exp_f32 v38, v38
    v_exp_f32 v39, v39
    v_cvt_pk_bf16_f32 v60, v32, v33
    v_cvt_pk_bf16_f32 v61, v34, v35
    v_cvt_pk_bf16_f32 v62, v36, v37
    v_cvt_pk_bf16_f32 v63, v38, v39
    s_nop 1
    v_mfma_f32_32x32x16_bf16 v[64:79], v[116:119], v[60:63], v[64:79]
    s_waitcnt lgkmcnt(0)
    ds_read_b128 v[112:115], v124 offset:47104
    ds_read_b128 v[120:123], v124 offset:48128
    v_exp_f32 v40, v40
    v_exp_f32 v41, v41
    v_exp_f32 v42, v42
    v_exp_f32 v43, v43
    v_mfma_f32_32x32x16_bf16 v[24:39], v[100:103], v[12:15], 0
    v_exp_f32 v44, v44
    v_exp_f32 v45, v45
    v_exp_f32 v46, v46
    v_exp_f32 v47, v47
    v_mfma_f32_32x32x8_bf16 v[24:39], v[106:107], v[20:21], v[24:39]
    v_cvt_pk_bf16_f32 v56, v40, v41
    v_cvt_pk_bf16_f32 v57, v42, v43
    v_cvt_pk_bf16_f32 v58, v44, v45
    v_cvt_pk_bf16_f32 v59, v46, v47
    v_exp_f32 v48, v48
    v_exp_f32 v49, v49
    v_mfma_f32_32x32x16_bf16 v[80:95], v[108:111], v[56:59], v[80:95]
    v_exp_f32 v50, v50
    v_exp_f32 v51, v51
    v_exp_f32 v52, v52
    v_exp_f32 v53, v53
    v_exp_f32 v54, v54
    v_exp_f32 v55, v55
    v_cvt_pk_bf16_f32 v60, v48, v49
    v_cvt_pk_bf16_f32 v61, v50, v51
    v_cvt_pk_bf16_f32 v62, v52, v53
    v_cvt_pk_bf16_f32 v63, v54, v55
    s_nop 1
    v_mfma_f32_32x32x16_bf16 v[80:95], v[116:119], v[60:63], v[80:95]
    v_exp_f32 v24, v24
    v_exp_f32 v25, v25
    v_exp_f32 v26, v26
    v_exp_f32 v27, v27
    v_mfma_f32_32x32x16_bf16 v[40:55], v[100:103], v[16:19], 0
    v_exp_f32 v28, v28
    v_exp_f32 v29, v29
    v_exp_f32 v30, v30
    v_exp_f32 v31, v31
    v_mfma_f32_32x32x8_bf16 v[40:55], v[106:107], v[22:23], v[40:55]
    v_cvt_pk_bf16_f32 v56, v24, v25
    v_cvt_pk_bf16_f32 v57, v26, v27
    v_cvt_pk_bf16_f32 v58, v28, v29
    v_cvt_pk_bf16_f32 v59, v30, v31
    v_exp_f32 v32, v32
    v_exp_f32 v33, v33
    s_waitcnt lgkmcnt(0)
    v_mfma_f32_32x32x16_bf16 v[64:79], v[112:115], v[56:59], v[64:79]
    v_exp_f32 v34, v34
    v_exp_f32 v35, v35
    v_exp_f32 v36, v36
    v_exp_f32 v37, v37
    v_exp_f32 v38, v38
    v_exp_f32 v39, v39
    v_cvt_pk_bf16_f32 v60, v32, v33
    v_cvt_pk_bf16_f32 v61, v34, v35
    v_cvt_pk_bf16_f32 v62, v36, v37
    v_cvt_pk_bf16_f32 v63, v38, v39
    s_nop 1
    v_mfma_f32_32x32x16_bf16 v[64:79], v[120:123], v[60:63], v[64:79]
    v_exp_f32 v40, v40
    v_exp_f32 v41, v41
    v_exp_f32 v42, v42
    v_exp_f32 v43, v43
    v_exp_f32 v44, v44
    v_exp_f32 v45, v45
    v_exp_f32 v46, v46
    v_exp_f32 v47, v47
    v_cvt_pk_bf16_f32 v56, v40, v41
    v_cvt_pk_bf16_f32 v57, v42, v43
    v_cvt_pk_bf16_f32 v58, v44, v45
    v_cvt_pk_bf16_f32 v59, v46, v47
    v_exp_f32 v48, v48
    ds_write_b128 v138, v[64:67] offset:0
    v_exp_f32 v49, v49
    ds_write_b128 v138, v[68:71] offset:1024
    v_mfma_f32_32x32x16_bf16 v[80:95], v[112:115], v[56:59], v[80:95]
    v_exp_f32 v50, v50
    ds_write_b128 v138, v[72:75] offset:2048
    v_exp_f32 v51, v51
    v_exp_f32 v52, v52
    v_exp_f32 v53, v53
    v_exp_f32 v54, v54
    v_exp_f32 v55, v55
    v_cvt_pk_bf16_f32 v60, v48, v49
    v_cvt_pk_bf16_f32 v61, v50, v51
    v_cvt_pk_bf16_f32 v62, v52, v53
    v_cvt_pk_bf16_f32 v63, v54, v55
    s_nop 1
    v_mfma_f32_32x32x16_bf16 v[80:95], v[120:123], v[60:63], v[80:95]
    s_waitcnt lgkmcnt(0)
    s_barrier
    ds_read_b128 v[48:51], v139 offset:2048
    ds_read_b128 v[40:43], v139 offset:0
    ds_read_b128 v[44:47], v139 offset:1024
    v_mov_b32 v7, 0x5f800000
    v_mov_b32 v8, 0x7b800000
    s_nop 5
    s_waitcnt lgkmcnt(2)
    v_pk_add_f32 v[88:89], v[88:89], v[48:49]
    v_mov_b32 v6, v88
    v_mov_b32 v131, v88
    v_pk_add_f32 v[90:91], v[90:91], v[50:51]
    s_nop 0
    v_permlane32_swap_b32 v6, v131
    s_waitcnt lgkmcnt(1)
    v_pk_add_f32 v[80:81], v[80:81], v[40:41]
    v_pk_add_f32 v[82:83], v[82:83], v[42:43]
    v_rcp_f32 v104, v131
    v_rcp_f32 v105, v131
    s_waitcnt lgkmcnt(0)
    v_pk_add_f32 v[84:85], v[84:85], v[44:45]
    v_pk_add_f32 v[86:87], v[86:87], v[46:47]
    v_pk_mul_f32 v[88:89], v[88:89], v[104:105]
    v_pk_mul_f32 v[90:91], v[90:91], v[104:105]
    v_cvt_pk_bf16_f32 v60, v88, v89
    v_cvt_pk_bf16_f32 v61, v90, v91
    ds_write_b64 v142, v[60:61] offset:1024
    v_pk_mul_f32 v[80:81], v[80:81], v[104:105]
    v_pk_mul_f32 v[82:83], v[82:83], v[104:105]
    v_cvt_pk_bf16_f32 v56, v80, v81
    v_cvt_pk_bf16_f32 v57, v82, v83
    ds_write_b64 v140, v[56:57] offset:0
    v_pk_mul_f32 v[84:85], v[84:85], v[104:105]
    v_pk_mul_f32 v[86:87], v[86:87], v[104:105]
    v_cvt_pk_bf16_f32 v58, v84, v85
    v_cvt_pk_bf16_f32 v59, v86, v87
    ds_write_b64 v140, v[58:59] offset:512
    v_cmp_nlt_f32 s[58:59], v131, v7
    v_pk_add_f32 v[24:25], v[80:81], v[82:83]
    v_pk_add_f32 v[26:27], v[84:85], v[86:87]
    v_pk_add_f32 v[28:29], v[88:89], v[90:91]
    v_pk_add_f32 v[24:25], v[24:25], v[26:27]
    v_pk_add_f32 v[24:25], v[24:25], v[28:29]
    v_add_f32 v6, v24, v25
    v_cmp_nlt_f32 vcc, abs(v6), v8
    v_add_u32 v7, 148736, v143
    s_nop 0
    s_or_b64 s[58:59], s[58:59], vcc
    s_cbranch_scc1 K2_fb
K2_ok:
    s_waitcnt lgkmcnt(0)
    s_barrier
    ds_read_b128 v[96:99], v7
    s_cmp_lt_u32 s40, 6
    s_cbranch_scc1 L_o1_57
    ds_read_b128 v[100:103], v7 offset:2048
    s_waitcnt lgkmcnt(0)
    buffer_store_dwordx4 v[100:103], v143, s[20:23], s48 offen offset:2048 sc1
L_o1_57:
    s_waitcnt lgkmcnt(0)
    buffer_store_dwordx4 v[96:99], v143, s[20:23], s48 offen sc1
    s_waitcnt vmcnt(0)
    s_barrier
    s_cmp_lg_u32 s40, 7
    s_cbranch_scc1 L_nosig_58
    s_waitcnt vmcnt(0)
    v_mov_b32 v8, 1
    s_mov_b64 exec, 1
    buffer_atomic_add v8, off, s[4:7], s49 sc1
    s_mov_b64 exec, -1
L_nosig_58:
    s_cmp_ge_u32 s40, 6
    s_cbranch_scc1 F_end
    s_cmp_ge_u32 s40, 4
    s_cbranch_scc1 F_phase_b
    v_and_b32 v1, 63, v0
    s_and_b32 s3, s2, 7
    s_lshr_b32 s44, s2, 3
    s_mul_i32 s50, s44, 205
    s_lshr_b32 s50, s50, 11
    s_mul_i32 s51, s50, 10
    s_lshl_b32 s43, s50, 3
    s_add_u32 s43, s43, s3
    s_lshl_b32 s61, s44, 1
    s_add_u32 s61, s61, s3
    s_sub_u32 s61, s61, 46
    s_sub_u32 s52, s2, 220
    s_cmp_ge_u32 s2, 240
    s_cselect_b32 s61, s52, s61
    s_sub_u32 s44, s44, s51
    s_cmp_ge_u32 s43, 22
    s_cbranch_scc1 K3_free
    s_lshl_b32 s55, s44, 7
    s_mul_i32 s56, s43, 3
    s_add_u32 s56, s56, s40
    s_waitcnt lgkmcnt(0)
    s_mov_b32 s16, s72
    s_and_b32 s17, s73, 0xffff
    s_mov_b32 s18, 819200
    s_mov_b32 s19, 0x00020000
    s_mul_i32 s50, s56, 40960
    s_add_u32 s50, s50, 2883584
    s_add_u32 s20, s86, s50
    s_addc_u32 s21, s87, 0
    s_and_b32 s21, s21, 0xffff
    s_mov_b32 s22, 40960
    s_mov_b32 s23, 0x00020000
    s_cmp_ge_u32 s56, 64
    s_cselect_b32 s22, 0, s22
    v_lshrrev_b32 v2, 5, v1
    v_lshlrev_b32 v3, 4, v1
    s_lshl_b32 s51, s44, 12
    s_mul_i32 s50, s56, 40960
    s_add_u32 s50, s50, s51
    s_add_u32 s50, s50, 5505024
    s_add_u32 s28, s86, s50
    s_addc_u32 s29, s87, 0
    s_and_b32 s29, s29, 0xffff
    s_mov_b32 s30, 4096
    s_mov_b32 s31, 0x00020000
    s_cmp_ge_u32 s56, 64
    s_cselect_b32 s30, 0, s30
    s_mul_i32 s50, s56, 40960
    s_add_u32 s50, s50, s51
    s_add_u32 s50, s50, 14598144
    s_add_u32 s24, s86, s50
    s_addc_u32 s25, s87, 0
    s_and_b32 s25, s25, 0xffff
    s_mov_b32 s26, 4096
    s_mov_b32 s27, 0x00020000
    s_cmp_ge_u32 s56, 64
    s_cselect_b32 s26, 0, s26
    s_cmp_lt_u32 s40, 3
    s_cbranch_scc1 L_compute_59
    s_mov_b32 s53, 66816
    v_mov_b32 v106, v1
    v_lshrrev_b32 v107, 3, v106
    v_and_b32 v108, 7, v106
    v_bfe_u32 v109, v107, 1, 1
    v_lshlrev_b32 v109, 2, v109
    v_xor_b32 v108, v108, v109
    v_mul_u32_u24 v107, 1280, v107
    v_lshl_add_u32 v107, v108, 4, v107
    v_add_u32 v84, s55, v107
    v_add_u32 v85, 10240, v84
    v_add_u32 v86, 10240, v85
    v_add_u32 v87, 10240, v86
    v_add_u32 v88, 10240, v87
    v_add_u32 v89, 10240, v88
    v_add_u32 v90, 10240, v89
    v_add_u32 v91, 10240, v90
    s_mov_b32 s45, 0
    s_add_u32 s47, s53, 32768
    s_add_u32 s51, s53, 81920
    s_mov_b32 s45, 409600
    s_add_u32 s47, s47, 40960
    s_mov_b32 s49, 5
L_ldn_60:
    s_mov_b32 m0, s47
    s_nop 0
    buffer_load_dwordx4 v84, s[16:19], s45 offen lds
    s_add_u32 m0, s47, 1024
    s_nop 0
    buffer_load_dwordx4 v85, s[16:19], s45 offen lds
    s_add_u32 m0, s47, 2048
    s_nop 0
    buffer_load_dwordx4 v86, s[16:19], s45 offen lds
    s_add_u32 m0, s47, 3072
    s_nop 0
    buffer_load_dwordx4 v87, s[16:19], s45 offen lds
    s_add_u32 m0, s47, 4096
    s_nop 0
    buffer_load_dwordx4 v88, s[16:19], s45 offen lds
    s_add_u32 m0, s47, 5120
    s_nop 0
    buffer_load_dwordx4 v89, s[16:19], s45 offen lds
    s_add_u32 m0, s47, 6144
    s_nop 0
    buffer_load_dwordx4 v90, s[16:19], s45 offen lds
    s_add_u32 m0, s47, 7168
    s_nop 0
    buffer_load_dwordx4 v91, s[16:19], s45 offen lds
    s_add_u32 s45, s45, 81920
    s_add_u32 s47, s47, 8192
    s_cmp_ge_u32 s47, s51
    s_cselect_b32 s47, s53, s47
    s_sub_u32 s49, s49, 1
    s_cmp_lg_u32 s49, 0
    s_cbranch_scc1 L_ldn_60
    s_waitcnt vmcnt(63)
    s_barrier
    s_waitcnt vmcnt(63)
    s_barrier
    s_waitcnt vmcnt(56)
    s_barrier
    s_waitcnt vmcnt(48)
    s_barrier
    s_waitcnt vmcnt(40)
    s_barrier
    s_waitcnt vmcnt(32)
    s_barrier
    s_waitcnt vmcnt(24)
    s_barrier
    s_waitcnt vmcnt(16)
    s_barrier
    s_waitcnt vmcnt(8)
    s_barrier
    s_waitcnt vmcnt(0)
    s_barrier
    s_barrier
    s_branch F_phase_b
L_compute_59:
    v_lshrrev_b32 v106, 5, v1
    v_mul_u32_u24 v100, 1024, v106
    v_bfe_u32 v106, v1, 4, 1
    v_mul_u32_u24 v106, 32, v106
    v_add_u32 v100, v100, v106
    v_bfe_u32 v106, v1, 2, 2
    v_mul_u32_u24 v107, 128, v106
    v_add_u32 v100, v100, v107
    v_and_b32 v107, 3, v1
    v_lshl_add_u32 v100, v107, 3, v100
    v_add_u32 v100, 66816, v100
    v_lshrrev_b32 v106, 1, v106
    v_lshl_add_u32 v100, v106, 6, v100
    v_xor_b32 v101, 64, v100
    v_lshrrev_b32 v121, 5, v1
    v_lshlrev_b32 v121, 3, v121
    v_and_b32 v120, 31, v1
    v_sub_u32 v120, v120, v121
    v_mov_b32 v123, 0x3f80
    v_subrev_u32 v121, 0, v120
    v_cmp_gt_u32 vcc, 2, v121
    v_lshlrev_b32 v122, 4, v121
    v_lshlrev_b32 v122, v122, v123
    v_cndmask_b32 v112, 0, v122, vcc
    v_subrev_u32 v121, 2, v120
    v_cmp_gt_u32 vcc, 2, v121
    v_lshlrev_b32 v122, 4, v121
    v_lshlrev_b32 v122, v122, v123
    v_cndmask_b32 v113, 0, v122, vcc
    v_subrev_u32 v121, 4, v120
    v_cmp_gt_u32 vcc, 2, v121
    v_lshlrev_b32 v122, 4, v121
    v_lshlrev_b32 v122, v122, v123
    v_cndmask_b32 v114, 0, v122, vcc
    v_subrev_u32 v121, 6, v120
    v_cmp_gt_u32 vcc, 2, v121
    v_lshlrev_b32 v122, 4, v121
    v_lshlrev_b32 v122, v122, v123
    v_cndmask_b32 v115, 0, v122, vcc
    v_subrev_u32 v121, 16, v120
    v_cmp_gt_u32 vcc, 2, v121
    v_lshlrev_b32 v122, 4, v121
    v_lshlrev_b32 v122, v122, v123
    v_cndmask_b32 v116, 0, v122, vcc
    v_subrev_u32 v121, 18, v120
    v_cmp_gt_u32 vcc, 2, v121
    v_lshlrev_b32 v122, 4, v121
    v_lshlrev_b32 v122, v122, v123
    v_cndmask_b32 v117, 0, v122, vcc
    v_subrev_u32 v121, 20, v120
    v_cmp_gt_u32 vcc, 2, v121
    v_lshlrev_b32 v122, 4, v121
    v_lshlrev_b32 v122, v122, v123
    v_cndmask_b32 v118, 0, v122, vcc
    v_subrev_u32 v121, 22, v120
    v_cmp_gt_u32 vcc, 2, v121
    v_lshlrev_b32 v122, 4, v121
    v_lshlrev_b32 v122, v122, v123
    v_cndmask_b32 v119, 0, v122, vcc
    s_lshl_b32 s51, s44, 8
    s_mul_i32 s50, s56, 2560
    s_add_u32 s50, s50, s51
    s_add_u32 s50, s50, 8126464
    s_add_u32 s32, s86, s50
    s_addc_u32 s33, s87, 0
    s_and_b32 s33, s33, 0xffff
    s_mov_b32 s34, 256
    s_mov_b32 s35, 0x00020000
    s_cmp_ge_u32 s56, 64
    s_cselect_b32 s34, 0, s34
    v_lshlrev_b32 v20, 3, v1
    s_lshl_b32 s57, s56, 8
    s_add_u32 s57, s57, 16384
    v_add_u32 v102, 32768, v100
    v_add_u32 v103, 32768, v101
    s_mov_b32 s48, 32768
    buffer_load_dwordx4 v[4:7], v3, s[24:27], 0 offen offset:0
    buffer_load_dwordx4 v[8:11], v3, s[24:27], 0 offen offset:1024
    buffer_load_dwordx4 v[12:15], v3, s[24:27], 0 offen offset:2048
    buffer_load_dwordx4 v[16:19], v3, s[24:27], 0 offen offset:3072
    s_cmp_ge_u32 s56, 64
    s_cbranch_scc1 L_nodep_61
    s_lshl_b32 s50, s56, 8
    s_mov_b32 s9, 0
L_poll_62:
    buffer_load_dword v23, off, s[4:7], s50 sc1
    s_waitcnt vmcnt(0)
    v_readfirstlane_b32 s10, v23
    s_cmp_ge_u32 s10, 4
    s_cbranch_scc1 L_polled_63
    s_add_u32 s9, s9, 1
    s_sleep 2
    s_cmp_lt_u32 s9, 50000
    s_cbranch_scc1 L_poll_62
L_polled_63:
L_nodep_61:
    s_mov_b32 s62, 0
    buffer_load_dwordx4 a[0:3], v3, s[20:23], s62 offen offset:0 sc1
    buffer_load_dwordx4 a[4:7], v3, s[20:23], s62 offen offset:1024 sc1
    buffer_load_dwordx4 a[8:11], v3, s[20:23], s62 offen offset:2048 sc1
    buffer_load_dwordx4 a[12:15], v3, s[20:23], s62 offen offset:3072 sc1
    s_mov_b32 s62, 4096
    buffer_load_dwordx4 a[16:19], v3, s[20:23], s62 offen offset:0 sc1
    buffer_load_dwordx4 a[20:23], v3, s[20:23], s62 offen offset:1024 sc1
    buffer_load_dwordx4 a[24:27], v3, s[20:23], s62 offen offset:2048 sc1
    buffer_load_dwordx4 a[28:31], v3, s[20:23], s62 offen offset:3072 sc1
    s_mov_b32 s62, 8192
    buffer_load_dwordx4 a[32:35], v3, s[20:23], s62 offen offset:0 sc1
    buffer_load_dwordx4 a[36:39], v3, s[20:23], s62 offen offset:1024 sc1
    buffer_load_dwordx4 a[40:43], v3, s[20:23], s62 offen offset:2048 sc1
    buffer_load_dwordx4 a[44:47], v3, s[20:23], s62 offen offset:3072 sc1
    s_mov_b32 s62, 12288
    buffer_load_dwordx4 a[48:51], v3, s[20:23], s62 offen offset:0 sc1
    buffer_load_dwordx4 a[52:55], v3, s[20:23], s62 offen offset:1024 sc1
    buffer_load_dwordx4 a[56:59], v3, s[20:23], s62 offen offset:2048 sc1
    buffer_load_dwordx4 a[60:63], v3, s[20:23], s62 offen offset:3072 sc1
    s_mov_b32 s62, 16384
    buffer_load_dwordx4 a[64:67], v3, s[20:23], s62 offen offset:0 sc1
    buffer_load_dwordx4 a[68:71], v3, s[20:23], s62 offen offset:1024 sc1
    buffer_load_dwordx4 a[72:75], v3, s[20:23], s62 offen offset:2048 sc1
    buffer_load_dwordx4 a[76:79], v3, s[20:23], s62 offen offset:3072 sc1
    s_mov_b32 s62, 20480
    buffer_load_dwordx4 a[80:83], v3, s[20:23], s62 offen offset:0 sc1
    buffer_load_dwordx4 v[56:59], v3, s[20:23], s62 offen offset:1024 sc1
    buffer_load_dwordx4 v[60:63], v3, s[20:23], s62 offen offset:2048 sc1
    buffer_load_dwordx4 v[64:67], v3, s[20:23], s62 offen offset:3072 sc1
    s_mov_b32 s62, 24576
    buffer_load_dwordx4 v[68:71], v3, s[20:23], s62 offen offset:0 sc1
    buffer_load_dwordx4 v[72:75], v3, s[20:23], s62 offen offset:1024 sc1
    buffer_load_dwordx4 v[76:79], v3, s[20:23], s62 offen offset:2048 sc1
    buffer_load_dwordx4 v[80:83], v3, s[20:23], s62 offen offset:3072 sc1
    s_waitcnt vmcnt(24)
    s_barrier
    ds_read_b64_tr_b16 v[84:85], v102 offset:0
    ds_read_b64_tr_b16 v[86:87], v102 offset:512
    ds_read_b64_tr_b16 v[88:89], v103 offset:0
    ds_read_b64_tr_b16 v[90:91], v103 offset:512
    v_mfma_f32_32x32x16_bf16 v[24:39], v[112:115], v[4:7], 0
    v_mfma_f32_32x32x16_bf16 v[40:55], v[112:115], v[12:15], 0
    v_mfma_f32_32x32x16_bf16 v[24:39], v[116:119], v[8:11], v[24:39]
    v_mfma_f32_32x32x16_bf16 v[40:55], v[116:119], v[16:19], v[40:55]
    s_waitcnt lgkmcnt(2)
    v_mfma_f32_32x32x16_bf16 v[24:39], v[84:87], a[0:3], v[24:39]
    ds_read_b64_tr_b16 v[92:93], v102 offset:2048
    ds_read_b64_tr_b16 v[94:95], v102 offset:2560
    s_waitcnt lgkmcnt(2)
    v_mfma_f32_32x32x16_bf16 v[40:55], v[88:91], a[0:3], v[40:55]
    ds_read_b64_tr_b16 v[96:97], v103 offset:2048
    ds_read_b64_tr_b16 v[98:99], v103 offset:2560
    s_mov_b32 s62, 28672
    buffer_load_dwordx4 a[0:3], v3, s[20:23], s62 offen offset:0 sc1
    s_waitcnt lgkmcnt(2)
    v_mfma_f32_32x32x16_bf16 v[24:39], v[92:95], a[4:7], v[24:39]
    ds_read_b64_tr_b16 v[84:85], v102 offset:4096
    ds_read_b64_tr_b16 v[86:87], v102 offset:4608
    s_waitcnt lgkmcnt(2)
    v_mfma_f32_32x32x16_bf16 v[40:55], v[96:99], a[4:7], v[40:55]
    ds_read_b64_tr_b16 v[88:89], v103 offset:4096
    ds_read_b64_tr_b16 v[90:91], v103 offset:4608
    buffer_load_dwordx4 a[4:7], v3, s[20:23], s62 offen offset:1024 sc1
    s_waitcnt lgkmcnt(2)
    v_mfma_f32_32x32x16_bf16 v[24:39], v[84:87], a[8:11], v[24:39]
    ds_read_b64_tr_b16 v[92:93], v102 offset:6144
    ds_read_b64_tr_b16 v[94:95], v102 offset:6656
    s_waitcnt lgkmcnt(2)
    v_mfma_f32_32x32x16_bf16 v[40:55], v[88:91], a[8:11], v[40:55]
    ds_read_b64_tr_b16 v[96:97], v103 offset:6144
    ds_read_b64_tr_b16 v[98:99], v103 offset:6656
    buffer_load_dwordx4 a[8:11], v3, s[20:23], s62 offen offset:2048 sc1
    s_waitcnt lgkmcnt(2)
    v_mfma_f32_32x32x16_bf16 v[24:39], v[92:95], a[12:15], v[24:39]
    s_add_u32 s48, s48, 8192
    s_cmp_ge_u32 s48, 81920
    s_cselect_b32 s48, 0, s48
    v_add_u32 v104, s48, v100
    v_add_u32 v105, s48, v101
    s_waitcnt vmcnt(23)
    s_barrier
    ds_read_b64_tr_b16 v[84:85], v104 offset:0
    ds_read_b64_tr_b16 v[86:87], v104 offset:512
    s_waitcnt lgkmcnt(2)
    v_mfma_f32_32x32x16_bf16 v[40:55], v[96:99], a[12:15], v[40:55]
    ds_read_b64_tr_b16 v[88:89], v105 offset:0
    ds_read_b64_tr_b16 v[90:91], v105 offset:512
    buffer_load_dwordx4 a[12:15], v3, s[20:23], s62 offen offset:3072 sc1
    s_waitcnt lgkmcnt(2)
    v_mfma_f32_32x32x16_bf16 v[24:39], v[84:87], a[16:19], v[24:39]
    ds_read_b64_tr_b16 v[92:93], v104 offset:2048
    ds_read_b64_tr_b16 v[94:95], v104 offset:2560
    s_waitcnt lgkmcnt(2)
    v_mfma_f32_32x32x16_bf16 v[40:55], v[88:91], a[16:19], v[40:55]
    ds_read_b64_tr_b16 v[96:97], v105 offset:2048
    ds_read_b64_tr_b16 v[98:99], v105 offset:2560
    s_mov_b32 s62, 32768
    buffer_load_dwordx4 a[16:19], v3, s[20:23], s62 offen offset:0 sc1
    s_waitcnt lgkmcnt(2)
    v_mfma_f32_32x32x16_bf16 v[24:39], v[92:95], a[20:23], v[24:39]
    ds_read_b64_tr_b16 v[84:85], v104 offset:4096
    ds_read_b64_tr_b16 v[86:87], v104 offset:4608
    s_waitcnt lgkmcnt(2)
    v_mfma_f32_32x32x16_bf16 v[40:55], v[96:99], a[20:23], v[40:55]
    ds_read_b64_tr_b16 v[88:89], v105 offset:4096
    ds_read_b64_tr_b16 v[90:91], v105 offset:4608
    buffer_load_dwordx4 a[20:23], v3, s[20:23], s62 offen offset:1024 sc1
    s_waitcnt lgkmcnt(2)
    v_mfma_f32_32x32x16_bf16 v[24:39], v[84:87], a[24:27], v[24:39]
    ds_read_b64_tr_b16 v[92:93], v104 offset:6144
    ds_read_b64_tr_b16 v[94:95], v104 offset:6656
    s_waitcnt lgkmcnt(2)
    v_mfma_f32_32x32x16_bf16 v[40:55], v[88:91], a[24:27], v[40:55]
    ds_read_b64_tr_b16 v[96:97], v105 offset:6144
    ds_read_b64_tr_b16 v[98:99], v105 offset:6656
    buffer_load_dwordx4 a[24:27], v3, s[20:23], s62 offen offset:2048 sc1
    s_waitcnt lgkmcnt(2)
    v_mfma_f32_32x32x16_bf16 v[24:39], v[92:95], a[28:31], v[24:39]
    s_add_u32 s48, s48, 8192
    s_cmp_ge_u32 s48, 81920
    s_cselect_b32 s48, 0, s48
    v_add_u32 v102, s48, v100
    v_add_u32 v103, s48, v101
    s_waitcnt vmcnt(23)
    s_barrier
    ds_read_b64_tr_b16 v[84:85], v102 offset:0
    ds_read_b64_tr_b16 v[86:87], v102 offset:512
    s_waitcnt lgkmcnt(2)
    v_mfma_f32_32x32x16_bf16 v[40:55], v[96:99], a[28:31], v[40:55]
    ds_read_b64_tr_b16 v[88:89], v103 offset:0
    ds_read_b64_tr_b16 v[90:91], v103 offset:512
    buffer_load_dwordx4 a[28:31], v3, s[20:23], s62 offen offset:3072 sc1
    s_waitcnt lgkmcnt(2)
    v_mfma_f32_32x32x16_bf16 v[24:39], v[84:87], a[32:35], v[24:39]
    ds_read_b64_tr_b16 v[92:93], v102 offset:2048
    ds_read_b64_tr_b16 v[94:95], v102 offset:2560
    s_waitcnt lgkmcnt(2)
    v_mfma_f32_32x32x16_bf16 v[40:55], v[88:91], a[32:35], v[40:55]
    ds_read_b64_tr_b16 v[96:97], v103 offset:2048
    ds_read_b64_tr_b16 v[98:99], v103 offset:2560
    s_mov_b32 s62, 36864
    buffer_load_dwordx4 a[32:35], v3, s[20:23], s62 offen offset:0 sc1
    s_waitcnt lgkmcnt(2)
    v_mfma_f32_32x32x16_bf16 v[24:39], v[92:95], a[36:39], v[24:39]
    ds_read_b64_tr_b16 v[84:85], v102 offset:4096
    ds_read_b64_tr_b16 v[86:87], v102 offset:4608
    s_waitcnt lgkmcnt(2)
    v_mfma_f32_32x32x16_bf16 v[40:55], v[96:99], a[36:39], v[40:55]
    ds_read_b64_tr_b16 v[88:89], v103 offset:4096
    ds_read_b64_tr_b16 v[90:91], v103 offset:4608
    buffer_load_dwordx4 a[36:39], v3, s[20:23], s62 offen offset:1024 sc1
    s_waitcnt lgkmcnt(2)
    v_mfma_f32_32x32x16_bf16 v[24:39], v[84:87], a[40:43], v[24:39]
    ds_read_b64_tr_b16 v[92:93], v102 offset:6144
    ds_read_b64_tr_b16 v[94:95], v102 offset:6656
    s_waitcnt lgkmcnt(2)
    v_mfma_f32_32x32x16_bf16 v[40:55], v[88:91], a[40:43], v[40:55]
    ds_read_b64_tr_b16 v[96:97], v103 offset:6144
    ds_read_b64_tr_b16 v[98:99], v103 offset:6656
    buffer_load_dwordx4 a[40:43], v3, s[20:23], s62 offen offset:2048 sc1
    s_waitcnt lgkmcnt(2)
    v_mfma_f32_32x32x16_bf16 v[24:39], v[92:95], a[44:47], v[24:39]
    s_add_u32 s48, s48, 8192
    s_cmp_ge_u32 s48, 81920
    s_cselect_b32 s48, 0, s48
    v_add_u32 v104, s48, v100
    v_add_u32 v105, s48, v101
    s_waitcnt vmcnt(23)
    s_barrier
    ds_read_b64_tr_b16 v[84:85], v104 offset:0
    ds_read_b64_tr_b16 v[86:87], v104 offset:512
    s_waitcnt lgkmcnt(2)
    v_mfma_f32_32x32x16_bf16 v[40:55], v[96:99], a[44:47], v[40:55]
    ds_read_b64_tr_b16 v[88:89], v105 offset:0
    ds_read_b64_tr_b16 v[90:91], v105 offset:512
    buffer_load_dwordx4 a[44:47], v3, s[20:23], s62 offen offset:3072 sc1
    s_waitcnt lgkmcnt(2)
    v_mfma_f32_32x32x16_bf16 v[24:39], v[84:87], a[48:51], v[24:39]
    ds_read_b64_tr_b16 v[92:93], v104 offset:2048
    ds_read_b64_tr_b16 v[94:95], v104 offset:2560
    s_waitcnt lgkmcnt(2)
    v_mfma_f32_32x32x16_bf16 v[40:55], v[88:91], a[48:51], v[40:55]
    ds_read_b64_tr_b16 v[96:97], v105 offset:2048
    ds_read_b64_tr_b16 v[98:99], v105 offset:2560
    s_waitcnt lgkmcnt(2)
    v_mfma_f32_32x32x16_bf16 v[24:39], v[92:95], a[52:55], v[24:39]
    ds_read_b64_tr_b16 v[84:85], v104 offset:4096
    ds_read_b64_tr_b16 v[86:87], v104 offset:4608
    s_waitcnt lgkmcnt(2)
    v_mfma_f32_32x32x16_bf16 v[40:55], v[96:99], a[52:55], v[40:55]
    ds_read_b64_tr_b16 v[88:89], v105 offset:4096
    ds_read_b64_tr_b16 v[90:91], v105 offset:4608
    s_waitcnt lgkmcnt(2)
    v_mfma_f32_32x32x16_bf16 v[24:39], v[84:87], a[56:59], v[24:39]
    ds_read_b64_tr_b16 v[92:93], v104 offset:6144
    ds_read_b64_tr_b16 v[94:95], v104 offset:6656
    s_waitcnt lgkmcnt(2)
    v_mfma_f32_32x32x16_bf16 v[40:55], v[88:91], a[56:59], v[40:55]
    ds_read_b64_tr_b16 v[96:97], v105 offset:6144
    ds_read_b64_tr_b16 v[98:99], v105 offset:6656
    s_waitcnt lgkmcnt(2)
    v_mfma_f32_32x32x16_bf16 v[24:39], v[92:95], a[60:63], v[24:39]
    s_add_u32 s48, s48, 8192
    s_cmp_ge_u32 s48, 81920
    s_cselect_b32 s48, 0, s48
    v_add_u32 v102, s48, v100
    v_add_u32 v103, s48, v101
    s_waitcnt vmcnt(20)
    s_barrier
    ds_read_b64_tr_b16 v[84:85], v102 offset:0
    ds_read_b64_tr_b16 v[86:87], v102 offset:512
    s_waitcnt lgkmcnt(2)
    v_mfma_f32_32x32x16_bf16 v[40:55], v[96:99], a[60:63], v[40:55]
    ds_read_b64_tr_b16 v[88:89], v103 offset:0
    ds_read_b64_tr_b16 v[90:91], v103 offset:512
    s_waitcnt lgkmcnt(2)
    v_mfma_f32_32x32x16_bf16 v[24:39], v[84:87], a[64:67], v[24:39]
    ds_read_b64_tr_b16 v[92:93], v102 offset:2048
    ds_read_b64_tr_b16 v[94:95], v102 offset:2560
    s_waitcnt lgkmcnt(2)
    v_mfma_f32_32x32x16_bf16 v[40:55], v[88:91], a[64:67], v[40:55]
    ds_read_b64_tr_b16 v[96:97], v103 offset:2048
    ds_read_b64_tr_b16 v[98:99], v103 offset:2560
    s_waitcnt lgkmcnt(2)
    v_mfma_f32_32x32x16_bf16 v[24:39], v[92:95], a[68:71], v[24:39]
    ds_read_b64_tr_b16 v[84:85], v102 offset:4096
    ds_read_b64_tr_b16 v[86:87], v102 offset:4608
    s_waitcnt lgkmcnt(2)
    v_mfma_f32_32x32x16_bf16 v[40:55], v[96:99], a[68:71], v[40:55]
    ds_read_b64_tr_b16 v[88:89], v103 offset:4096
    ds_read_b64_tr_b16 v[90:91], v103 offset:4608
    s_waitcnt lgkmcnt(2)
    v_mfma_f32_32x32x16_bf16 v[24:39], v[84:87], a[72:75], v[24:39]
    ds_read_b64_tr_b16 v[92:93], v102 offset:6144
    ds_read_b64_tr_b16 v[94:95], v102 offset:6656
    s_waitcnt lgkmcnt(2)
    v_mfma_f32_32x32x16_bf16 v[40:55], v[88:91], a[72:75], v[40:55]
    ds_read_b64_tr_b16 v[96:97], v103 offset:6144
    ds_read_b64_tr_b16 v[98:99], v103 offset:6656
    s_waitcnt lgkmcnt(2)
    v_mfma_f32_32x32x16_bf16 v[24:39], v[92:95], a[76:79], v[24:39]
    s_add_u32 s48, s48, 8192
    s_cmp_ge_u32 s48, 81920
    s_cselect_b32 s48, 0, s48
    v_add_u32 v104, s48, v100
    v_add_u32 v105, s48, v101
    s_waitcnt vmcnt(16)
    s_barrier
    ds_read_b64_tr_b16 v[84:85], v104 offset:0
    ds_read_b64_tr_b16 v[86:87], v104 offset:512
    s_waitcnt lgkmcnt(2)
    v_mfma_f32_32x32x16_bf16 v[40:55], v[96:99], a[76:79], v[40:55]
    ds_read_b64_tr_b16 v[88:89], v105 offset:0
    ds_read_b64_tr_b16 v[90:91], v105 offset:512
    s_waitcnt lgkmcnt(2)
    v_mfma_f32_32x32x16_bf16 v[24:39], v[84:87], a[80:83], v[24:39]
    ds_read_b64_tr_b16 v[92:93], v104 offset:2048
    ds_read_b64_tr_b16 v[94:95], v104 offset:2560
    s_waitcnt lgkmcnt(2)
    v_mfma_f32_32x32x16_bf16 v[40:55], v[88:91], a[80:83], v[40:55]
    ds_read_b64_tr_b16 v[96:97], v105 offset:2048
    ds_read_b64_tr_b16 v[98:99], v105 offset:2560
    s_waitcnt lgkmcnt(2)
    v_mfma_f32_32x32x16_bf16 v[24:39], v[92:95], v[56:59], v[24:39]
    ds_read_b64_tr_b16 v[84:85], v104 offset:4096
    ds_read_b64_tr_b16 v[86:87], v104 offset:4608
    s_waitcnt lgkmcnt(2)
    v_mfma_f32_32x32x16_bf16 v[40:55], v[96:99], v[56:59], v[40:55]
    ds_read_b64_tr_b16 v[88:89], v105 offset:4096
    ds_read_b64_tr_b16 v[90:91], v105 offset:4608
    s_waitcnt lgkmcnt(2)
    v_mfma_f32_32x32x16_bf16 v[24:39], v[84:87], v[60:63], v[24:39]
    ds_read_b64_tr_b16 v[92:93], v104 offset:6144
    ds_read_b64_tr_b16 v[94:95], v104 offset:6656
    s_waitcnt lgkmcnt(2)
    v_mfma_f32_32x32x16_bf16 v[40:55], v[88:91], v[60:63], v[40:55]
    ds_read_b64_tr_b16 v[96:97], v105 offset:6144
    ds_read_b64_tr_b16 v[98:99], v105 offset:6656
    s_waitcnt lgkmcnt(2)
    v_mfma_f32_32x32x16_bf16 v[24:39], v[92:95], v[64:67], v[24:39]
    s_add_u32 s48, s48, 8192
    s_cmp_ge_u32 s48, 81920
    s_cselect_b32 s48, 0, s48
    v_add_u32 v102, s48, v100
    v_add_u32 v103, s48, v101
    s_waitcnt vmcnt(12)
    s_barrier
    ds_read_b64_tr_b16 v[84:85], v102 offset:0
    ds_read_b64_tr_b16 v[86:87], v102 offset:512
    s_waitcnt lgkmcnt(2)
    v_mfma_f32_32x32x16_bf16 v[40:55], v[96:99], v[64:67], v[40:55]
    ds_read_b64_tr_b16 v[88:89], v103 offset:0
    ds_read_b64_tr_b16 v[90:91], v103 offset:512
    s_waitcnt lgkmcnt(2)
    v_mfma_f32_32x32x16_bf16 v[24:39], v[84:87], v[68:71], v[24:39]
    ds_read_b64_tr_b16 v[92:93], v102 offset:2048
    ds_read_b64_tr_b16 v[94:95], v102 offset:2560
    s_waitcnt lgkmcnt(2)
    v_mfma_f32_32x32x16_bf16 v[40:55], v[88:91], v[68:71], v[40:55]
    ds_read_b64_tr_b16 v[96:97], v103 offset:2048
    ds_read_b64_tr_b16 v[98:99], v103 offset:2560
    s_waitcnt lgkmcnt(2)
    v_mfma_f32_32x32x16_bf16 v[24:39], v[92:95], v[72:75], v[24:39]
    ds_read_b64_tr_b16 v[84:85], v102 offset:4096
    ds_read_b64_tr_b16 v[86:87], v102 offset:4608
    s_waitcnt lgkmcnt(2)
    v_mfma_f32_32x32x16_bf16 v[40:55], v[96:99], v[72:75], v[40:55]
    ds_read_b64_tr_b16 v[88:89], v103 offset:4096
    ds_read_b64_tr_b16 v[90:91], v103 offset:4608
    s_waitcnt lgkmcnt(2)
    v_mfma_f32_32x32x16_bf16 v[24:39], v[84:87], v[76:79], v[24:39]
    ds_read_b64_tr_b16 v[92:93], v102 offset:6144
    ds_read_b64_tr_b16 v[94:95], v102 offset:6656
    s_waitcnt lgkmcnt(2)
    v_mfma_f32_32x32x16_bf16 v[40:55], v[88:91], v[76:79], v[40:55]
    ds_read_b64_tr_b16 v[96:97], v103 offset:6144
    ds_read_b64_tr_b16 v[98:99], v103 offset:6656
    s_waitcnt lgkmcnt(2)
    v_mfma_f32_32x32x16_bf16 v[24:39], v[92:95], v[80:83], v[24:39]
    s_add_u32 s48, s48, 8192
    s_cmp_ge_u32 s48, 81920
    s_cselect_b32 s48, 0, s48
    v_add_u32 v104, s48, v100
    v_add_u32 v105, s48, v101
    s_waitcnt vmcnt(8)
    s_barrier
    ds_read_b64_tr_b16 v[84:85], v104 offset:0
    ds_read_b64_tr_b16 v[86:87], v104 offset:512
    s_waitcnt lgkmcnt(2)
    v_mfma_f32_32x32x16_bf16 v[40:55], v[96:99], v[80:83], v[40:55]
    ds_read_b64_tr_b16 v[88:89], v105 offset:0
    ds_read_b64_tr_b16 v[90:91], v105 offset:512
    s_waitcnt lgkmcnt(2)
    v_mfma_f32_32x32x16_bf16 v[24:39], v[84:87], a[0:3], v[24:39]
    ds_read_b64_tr_b16 v[92:93], v104 offset:2048
    ds_read_b64_tr_b16 v[94:95], v104 offset:2560
    s_waitcnt lgkmcnt(2)
    v_mfma_f32_32x32x16_bf16 v[40:55], v[88:91], a[0:3], v[40:55]
    ds_read_b64_tr_b16 v[96:97], v105 offset:2048
    ds_read_b64_tr_b16 v[98:99], v105 offset:2560
    s_waitcnt lgkmcnt(2)
    v_mfma_f32_32x32x16_bf16 v[24:39], v[92:95], a[4:7], v[24:39]
    ds_read_b64_tr_b16 v[84:85], v104 offset:4096
    ds_read_b64_tr_b16 v[86:87], v104 offset:4608
    s_waitcnt lgkmcnt(2)
    v_mfma_f32_32x32x16_bf16 v[40:55], v[96:99], a[4:7], v[40:55]
    ds_read_b64_tr_b16 v[88:89], v105 offset:4096
    ds_read_b64_tr_b16 v[90:91], v105 offset:4608
    s_waitcnt lgkmcnt(2)
    v_mfma_f32_32x32x16_bf16 v[24:39], v[84:87], a[8:11], v[24:39]
    ds_read_b64_tr_b16 v[92:93], v104 offset:6144
    ds_read_b64_tr_b16 v[94:95], v104 offset:6656
    s_waitcnt lgkmcnt(2)
    v_mfma_f32_32x32x16_bf16 v[40:55], v[88:91], a[8:11], v[40:55]
    ds_read_b64_tr_b16 v[96:97], v105 offset:6144
    ds_read_b64_tr_b16 v[98:99], v105 offset:6656
    s_waitcnt lgkmcnt(2)
    v_mfma_f32_32x32x16_bf16 v[24:39], v[92:95], a[12:15], v[24:39]
    s_add_u32 s48, s48, 8192
    s_cmp_ge_u32 s48, 81920
    s_cselect_b32 s48, 0, s48
    v_add_u32 v102, s48, v100
    v_add_u32 v103, s48, v101
    s_waitcnt vmcnt(4)
    s_barrier
    ds_read_b64_tr_b16 v[84:85], v102 offset:0
    ds_read_b64_tr_b16 v[86:87], v102 offset:512
    s_waitcnt lgkmcnt(2)
    v_mfma_f32_32x32x16_bf16 v[40:55], v[96:99], a[12:15], v[40:55]
    ds_read_b64_tr_b16 v[88:89], v103 offset:0
    ds_read_b64_tr_b16 v[90:91], v103 offset:512
    s_waitcnt lgkmcnt(2)
    v_mfma_f32_32x32x16_bf16 v[24:39], v[84:87], a[16:19], v[24:39]
    ds_read_b64_tr_b16 v[92:93], v102 offset:2048
    ds_read_b64_tr_b16 v[94:95], v102 offset:2560
    s_waitcnt lgkmcnt(2)
    v_mfma_f32_32x32x16_bf16 v[40:55], v[88:91], a[16:19], v[40:55]
    ds_read_b64_tr_b16 v[96:97], v103 offset:2048
    ds_read_b64_tr_b16 v[98:99], v103 offset:2560
    s_waitcnt lgkmcnt(2)
    v_mfma_f32_32x32x16_bf16 v[24:39], v[92:95], a[20:23], v[24:39]
    ds_read_b64_tr_b16 v[84:85], v102 offset:4096
    ds_read_b64_tr_b16 v[86:87], v102 offset:4608
    s_waitcnt lgkmcnt(2)
    v_mfma_f32_32x32x16_bf16 v[40:55], v[96:99], a[20:23], v[40:55]
    ds_read_b64_tr_b16 v[88:89], v103 offset:4096
    ds_read_b64_tr_b16 v[90:91], v103 offset:4608
    s_waitcnt lgkmcnt(2)
    v_mfma_f32_32x32x16_bf16 v[24:39], v[84:87], a[24:27], v[24:39]
    ds_read_b64_tr_b16 v[92:93], v102 offset:6144
    ds_read_b64_tr_b16 v[94:95], v102 offset:6656
    s_waitcnt lgkmcnt(2)
    v_mfma_f32_32x32x16_bf16 v[40:55], v[88:91], a[24:27], v[40:55]
    ds_read_b64_tr_b16 v[96:97], v103 offset:6144
    ds_read_b64_tr_b16 v[98:99], v103 offset:6656
    s_waitcnt lgkmcnt(2)
    v_mfma_f32_32x32x16_bf16 v[24:39], v[92:95], a[28:31], v[24:39]
    s_add_u32 s48, s48, 8192
    s_cmp_ge_u32 s48, 81920
    s_cselect_b32 s48, 0, s48
    v_add_u32 v104, s48, v100
    v_add_u32 v105, s48, v101
    s_waitcnt vmcnt(0)
    s_barrier
    ds_read_b64_tr_b16 v[84:85], v104 offset:0
    ds_read_b64_tr_b16 v[86:87], v104 offset:512
    s_waitcnt lgkmcnt(2)
    v_mfma_f32_32x32x16_bf16 v[40:55], v[96:99], a[28:31], v[40:55]
    ds_read_b64_tr_b16 v[88:89], v105 offset:0
    ds_read_b64_tr_b16 v[90:91], v105 offset:512
    s_waitcnt lgkmcnt(2)
    v_mfma_f32_32x32x16_bf16 v[24:39], v[84:87], a[32:35], v[24:39]
    ds_read_b64_tr_b16 v[92:93], v104 offset:2048
    ds_read_b64_tr_b16 v[94:95], v104 offset:2560
    s_waitcnt lgkmcnt(2)
    v_mfma_f32_32x32x16_bf16 v[40:55], v[88:91], a[32:35], v[40:55]
    ds_read_b64_tr_b16 v[96:97], v105 offset:2048
    ds_read_b64_tr_b16 v[98:99], v105 offset:2560
    s_waitcnt lgkmcnt(2)
    v_mfma_f32_32x32x16_bf16 v[24:39], v[92:95], a[36:39], v[24:39]
    ds_read_b64_tr_b16 v[84:85], v104 offset:4096
    ds_read_b64_tr_b16 v[86:87], v104 offset:4608
    s_waitcnt lgkmcnt(2)
    v_mfma_f32_32x32x16_bf16 v[40:55], v[96:99], a[36:39], v[40:55]
    ds_read_b64_tr_b16 v[88:89], v105 offset:4096
    ds_read_b64_tr_b16 v[90:91], v105 offset:4608
    s_waitcnt lgkmcnt(2)
    v_mfma_f32_32x32x16_bf16 v[24:39], v[84:87], a[40:43], v[24:39]
    ds_read_b64_tr_b16 v[92:93], v104 offset:6144
    ds_read_b64_tr_b16 v[94:95], v104 offset:6656
    s_waitcnt lgkmcnt(2)
    v_mfma_f32_32x32x16_bf16 v[40:55], v[88:91], a[40:43], v[40:55]
    ds_read_b64_tr_b16 v[96:97], v105 offset:6144
    ds_read_b64_tr_b16 v[98:99], v105 offset:6656
    s_waitcnt lgkmcnt(2)
    v_mfma_f32_32x32x16_bf16 v[24:39], v[92:95], a[44:47], v[24:39]
    s_waitcnt lgkmcnt(0)
    v_mfma_f32_32x32x16_bf16 v[40:55], v[96:99], a[44:47], v[40:55]
    s_waitcnt vmcnt(0) lgkmcnt(0)
    s_nop 11
    v_cvt_pk_bf16_f32 v124, v24, v25
    v_cvt_pk_bf16_f32 v125, v26, v27
    v_cvt_pk_bf16_f32 v126, v28, v29
    v_cvt_pk_bf16_f32 v127, v30, v31
    buffer_store_dwordx4 v[124:127], v3, s[28:31], 0 offen offset:0 sc1
    v_cvt_pk_bf16_f32 v128, v32, v33
    v_cvt_pk_bf16_f32 v129, v34, v35
    v_cvt_pk_bf16_f32 v130, v36, v37
    v_cvt_pk_bf16_f32 v131, v38, v39
    buffer_store_dwordx4 v[128:131], v3, s[28:31], 0 offen offset:1024 sc1
    v_cvt_pk_bf16_f32 v132, v40, v41
    v_cvt_pk_bf16_f32 v133, v42, v43
    v_cvt_pk_bf16_f32 v134, v44, v45
    v_cvt_pk_bf16_f32 v135, v46, v47
    buffer_store_dwordx4 v[132:135], v3, s[28:31], 0 offen offset:2048 sc1
    v_cvt_pk_bf16_f32 v136, v48, v49
    v_cvt_pk_bf16_f32 v137, v50, v51
    v_cvt_pk_bf16_f32 v138, v52, v53
    v_cvt_pk_bf16_f32 v139, v54, v55
    buffer_store_dwordx4 v[136:139], v3, s[28:31], 0 offen offset:3072 sc1
    v_pk_add_f32 v[4:5], v[24:25], v[28:29]
    v_pk_mul_f32 v[8:9], v[24:25], v[24:25]
    v_pk_add_f32 v[6:7], v[26:27], v[30:31]
    v_pk_mul_f32 v[10:11], v[26:27], v[26:27]
    v_pk_fma_f32 v[8:9], v[28:29], v[28:29], v[8:9]
    v_pk_fma_f32 v[10:11], v[30:31], v[30:31], v[10:11]
    v_pk_add_f32 v[4:5], v[4:5], v[32:33]
    v_pk_fma_f32 v[8:9], v[32:33], v[32:33], v[8:9]
    v_pk_add_f32 v[6:7], v[6:7], v[34:35]
    v_pk_fma_f32 v[10:11], v[34:35], v[34:35], v[10:11]
    v_pk_add_f32 v[4:5], v[4:5], v[36:37]
    v_pk_fma_f32 v[8:9], v[36:37], v[36:37], v[8:9]
    v_pk_add_f32 v[6:7], v[6:7], v[38:39]
    v_pk_fma_f32 v[10:11], v[38:39], v[38:39], v[10:11]
    v_pk_add_f32 v[4:5], v[4:5], v[40:41]
    v_pk_fma_f32 v[8:9], v[40:41], v[40:41], v[8:9]
    v_pk_add_f32 v[6:7], v[6:7], v[42:43]
    v_pk_fma_f32 v[10:11], v[42:43], v[42:43], v[10:11]
    v_pk_add_f32 v[4:5], v[4:5], v[44:45]
    v_pk_fma_f32 v[8:9], v[44:45], v[44:45], v[8:9]
    v_pk_add_f32 v[6:7], v[6:7], v[46:47]
    v_pk_fma_f32 v[10:11], v[46:47], v[46:47], v[10:11]
    v_pk_add_f32 v[4:5], v[4:5], v[48:49]
    v_pk_fma_f32 v[8:9], v[48:49], v[48:49], v[8:9]
    v_pk_add_f32 v[6:7], v[6:7], v[50:51]
    v_pk_fma_f32 v[10:11], v[50:51], v[50:51], v[10:11]
    v_pk_add_f32 v[4:5], v[4:5], v[52:53]
    v_pk_fma_f32 v[8:9], v[52:53], v[52:53], v[8:9]
    v_pk_add_f32 v[6:7], v[6:7], v[54:55]
    v_pk_fma_f32 v[10:11], v[54:55], v[54:55], v[10:11]
    v_pk_add_f32 v[4:5], v[4:5], v[6:7]
    v_pk_add_f32 v[8:9], v[8:9], v[10:11]
    v_add_f32 v140, v4, v5
    v_add_f32 v141, v8, v9
    v_mov_b32 v142, v140
    v_mov_b32 v143, v141
    s_nop 0
    v_permlane32_swap_b32 v140, v142
    v_permlane32_swap_b32 v141, v143
    s_nop 0
    v_add_f32 v140, v140, v142
    v_add_f32 v141, v141, v143
    buffer_store_dwordx2 v[140:141], v20, s[32:35], 0 offen sc1
    s_lshl_b32 s50, s56, 8
    s_add_u32 s50, s50, 16384
    s_waitcnt vmcnt(0)
    v_mov_b32 v143, 1
    s_mov_b64 exec, 1
    buffer_atomic_add v143, off, s[4:7], s50 sc1
    s_mov_b64 exec, -1
    s_barrier
    s_branch F_phase_b
K3_free:
    v_and_b32 v1, 63, v0
    s_cmp_ge_u32 s61, 24
    s_cbranch_scc1 F_phase_b
    s_cmp_ge_u32 s61, 12
    s_cselect_b32 s50, 12, 0
    s_cselect_b32 s52, 6144, 0
    s_sub_u32 s44, s61, s50
    s_waitcnt lgkmcnt(0)
    s_cmp_ge_u32 s61, 12
    s_cselect_b32 s16, s78, s76
    s_cselect_b32 s17, s79, s77
    s_and_b32 s17, s17, 0xffff
    s_mov_b32 s18, 1966080
    s_mov_b32 s19, 0x00020000
    v_lshrrev_b32 v3, 4, v1
    s_lshl_b32 s50, s40, 2
    v_add_u32 v3, s50, v3
    v_mul_u32_u24 v2, 3072, v3
    v_and_b32 v4, 15, v1
    v_lshl_add_u32 v2, v4, 4, v2
    s_lshl_b32 s50, s44, 8
    v_add_u32 v2, s50, v2
    v_mov_b32 v5, 0x00003f80
    v_mov_b32 v6, 0x3f800000
    v_mov_b32 v8, 0
    v_mov_b32 v9, 0
    v_mov_b32 v10, 0
    v_mov_b32 v11, 0
    v_mov_b32 v12, 0
    v_mov_b32 v13, 0
    v_mov_b32 v14, 0
    v_mov_b32 v15, 0
    s_mov_b32 s51, 0
    buffer_load_dwordx4 v[16:19], v2, s[16:19], s51 offen
    s_add_u32 s51, s51, 49152
    buffer_load_dwordx4 v[20:23], v2, s[16:19], s51 offen
    s_add_u32 s51, s51, 49152
    buffer_load_dwordx4 v[24:27], v2, s[16:19], s51 offen
    s_add_u32 s51, s51, 49152
    buffer_load_dwordx4 v[28:31], v2, s[16:19], s51 offen
    s_add_u32 s51, s51, 49152
    buffer_load_dwordx4 v[32:35], v2, s[16:19], s51 offen
    s_add_u32 s51, s51, 49152
    buffer_load_dwordx4 v[36:39], v2, s[16:19], s51 offen
    s_add_u32 s51, s51, 49152
    buffer_load_dwordx4 v[40:43], v2, s[16:19], s51 offen
    s_add_u32 s51, s51, 49152
    buffer_load_dwordx4 v[44:47], v2, s[16:19], s51 offen
    s_add_u32 s51, s51, 49152
    buffer_load_dwordx4 v[48:51], v2, s[16:19], s51 offen
    s_add_u32 s51, s51, 49152
    buffer_load_dwordx4 v[52:55], v2, s[16:19], s51 offen
    s_add_u32 s51, s51, 49152
    buffer_load_dwordx4 v[56:59], v2, s[16:19], s51 offen
    s_add_u32 s51, s51, 49152
    buffer_load_dwordx4 v[60:63], v2, s[16:19], s51 offen
    s_add_u32 s51, s51, 49152
    buffer_load_dwordx4 v[64:67], v2, s[16:19], s51 offen
    s_add_u32 s51, s51, 49152
    buffer_load_dwordx4 v[68:71], v2, s[16:19], s51 offen
    s_add_u32 s51, s51, 49152
    buffer_load_dwordx4 v[72:75], v2, s[16:19], s51 offen
    s_add_u32 s51, s51, 49152
    buffer_load_dwordx4 v[76:79], v2, s[16:19], s51 offen
    s_add_u32 s51, s51, 49152
    buffer_load_dwordx4 v[80:83], v2, s[16:19], s51 offen
    s_add_u32 s51, s51, 49152
    buffer_load_dwordx4 v[84:87], v2, s[16:19], s51 offen
    s_add_u32 s51, s51, 49152
    buffer_load_dwordx4 v[88:91], v2, s[16:19], s51 offen
    s_add_u32 s51, s51, 49152
    buffer_load_dwordx4 v[92:95], v2, s[16:19], s51 offen
    s_add_u32 s51, s51, 49152
    buffer_load_dwordx4 v[96:99], v2, s[16:19], s51 offen
    s_add_u32 s51, s51, 49152
    buffer_load_dwordx4 v[100:103], v2, s[16:19], s51 offen
    s_add_u32 s51, s51, 49152
    buffer_load_dwordx4 v[104:107], v2, s[16:19], s51 offen
    s_add_u32 s51, s51, 49152
    buffer_load_dwordx4 v[108:111], v2, s[16:19], s51 offen
    s_add_u32 s51, s51, 49152
    buffer_load_dwordx4 v[112:115], v2, s[16:19], s51 offen
    s_add_u32 s51, s51, 49152
    buffer_load_dwordx4 v[116:119], v2, s[16:19], s51 offen
    s_add_u32 s51, s51, 49152
    buffer_load_dwordx4 v[120:123], v2, s[16:19], s51 offen
    s_add_u32 s51, s51, 49152
    buffer_load_dwordx4 v[124:127], v2, s[16:19], s51 offen
    s_add_u32 s51, s51, 49152
    buffer_load_dwordx4 v[128:131], v2, s[16:19], s51 offen
    s_add_u32 s51, s51, 49152
    buffer_load_dwordx4 v[132:135], v2, s[16:19], s51 offen
    s_add_u32 s51, s51, 49152
    buffer_load_dwordx4 v[136:139], v2, s[16:19], s51 offen
    s_add_u32 s51, s51, 49152
    buffer_load_dwordx4 v[140:143], v2, s[16:19], s51 offen
    s_add_u32 s51, s51, 49152
    buffer_load_dwordx4 v[144:147], v2, s[16:19], s51 offen
    s_add_u32 s51, s51, 49152
    buffer_load_dwordx4 v[148:151], v2, s[16:19], s51 offen
    s_add_u32 s51, s51, 49152
    buffer_load_dwordx4 v[152:155], v2, s[16:19], s51 offen
    s_add_u32 s51, s51, 49152
    buffer_load_dwordx4 v[156:159], v2, s[16:19], s51 offen
    s_add_u32 s51, s51, 49152
    s_waitcnt vmcnt(35)
    v_dot2_f32_bf16 v8, v16, v5, v8
    v_dot2_f32_bf16 v9, v16, v6, v9
    v_dot2_f32_bf16 v10, v17, v5, v10
    v_dot2_f32_bf16 v11, v17, v6, v11
    v_dot2_f32_bf16 v12, v18, v5, v12
    v_dot2_f32_bf16 v13, v18, v6, v13
    v_dot2_f32_bf16 v14, v19, v5, v14
    v_dot2_f32_bf16 v15, v19, v6, v15
    s_waitcnt vmcnt(34)
    v_dot2_f32_bf16 v8, v20, v5, v8
    v_dot2_f32_bf16 v9, v20, v6, v9
    v_dot2_f32_bf16 v10, v21, v5, v10
    v_dot2_f32_bf16 v11, v21, v6, v11
    v_dot2_f32_bf16 v12, v22, v5, v12
    v_dot2_f32_bf16 v13, v22, v6, v13
    v_dot2_f32_bf16 v14, v23, v5, v14
    v_dot2_f32_bf16 v15, v23, v6, v15
    buffer_load_dwordx4 v[16:19], v2, s[16:19], s51 offen
    s_add_u32 s51, s51, 49152
    s_waitcnt vmcnt(34)
    v_dot2_f32_bf16 v8, v24, v5, v8
    v_dot2_f32_bf16 v9, v24, v6, v9
    v_dot2_f32_bf16 v10, v25, v5, v10
    v_dot2_f32_bf16 v11, v25, v6, v11
    v_dot2_f32_bf16 v12, v26, v5, v12
    v_dot2_f32_bf16 v13, v26, v6, v13
    v_dot2_f32_bf16 v14, v27, v5, v14
    v_dot2_f32_bf16 v15, v27, v6, v15
    buffer_load_dwordx4 v[20:23], v2, s[16:19], s51 offen
    s_add_u32 s51, s51, 49152
    s_waitcnt vmcnt(34)
    v_dot2_f32_bf16 v8, v28, v5, v8
    v_dot2_f32_bf16 v9, v28, v6, v9
    v_dot2_f32_bf16 v10, v29, v5, v10
    v_dot2_f32_bf16 v11, v29, v6, v11
    v_dot2_f32_bf16 v12, v30, v5, v12
    v_dot2_f32_bf16 v13, v30, v6, v13
    v_dot2_f32_bf16 v14, v31, v5, v14
    v_dot2_f32_bf16 v15, v31, v6, v15
    buffer_load_dwordx4 v[24:27], v2, s[16:19], s51 offen
    s_add_u32 s51, s51, 49152
    s_waitcnt vmcnt(34)
    v_dot2_f32_bf16 v8, v32, v5, v8
    v_dot2_f32_bf16 v9, v32, v6, v9
    v_dot2_f32_bf16 v10, v33, v5, v10
    v_dot2_f32_bf16 v11, v33, v6, v11
    v_dot2_f32_bf16 v12, v34, v5, v12
    v_dot2_f32_bf16 v13, v34, v6, v13
    v_dot2_f32_bf16 v14, v35, v5, v14
    v_dot2_f32_bf16 v15, v35, v6, v15
    buffer_load_dwordx4 v[28:31], v2, s[16:19], s51 offen
    s_add_u32 s51, s51, 49152
    s_waitcnt vmcnt(34)
    v_dot2_f32_bf16 v8, v36, v5, v8
    v_dot2_f32_bf16 v9, v36, v6, v9
    v_dot2_f32_bf16 v10, v37, v5, v10
    v_dot2_f32_bf16 v11, v37, v6, v11
    v_dot2_f32_bf16 v12, v38, v5, v12
    v_dot2_f32_bf16 v13, v38, v6, v13
    v_dot2_f32_bf16 v14, v39, v5, v14
    v_dot2_f32_bf16 v15, v39, v6, v15
    s_waitcnt vmcnt(33)
    v_dot2_f32_bf16 v8, v40, v5, v8
    v_dot2_f32_bf16 v9, v40, v6, v9
    v_dot2_f32_bf16 v10, v41, v5, v10
    v_dot2_f32_bf16 v11, v41, v6, v11
    v_dot2_f32_bf16 v12, v42, v5, v12
    v_dot2_f32_bf16 v13, v42, v6, v13
    v_dot2_f32_bf16 v14, v43, v5, v14
    v_dot2_f32_bf16 v15, v43, v6, v15
    s_waitcnt vmcnt(32)
    v_dot2_f32_bf16 v8, v44, v5, v8
    v_dot2_f32_bf16 v9, v44, v6, v9
    v_dot2_f32_bf16 v10, v45, v5, v10
    v_dot2_f32_bf16 v11, v45, v6, v11
    v_dot2_f32_bf16 v12, v46, v5, v12
    v_dot2_f32_bf16 v13, v46, v6, v13
    v_dot2_f32_bf16 v14, v47, v5, v14
    v_dot2_f32_bf16 v15, v47, v6, v15
    s_waitcnt vmcnt(31)
    v_dot2_f32_bf16 v8, v48, v5, v8
    v_dot2_f32_bf16 v9, v48, v6, v9
    v_dot2_f32_bf16 v10, v49, v5, v10
    v_dot2_f32_bf16 v11, v49, v6, v11
    v_dot2_f32_bf16 v12, v50, v5, v12
    v_dot2_f32_bf16 v13, v50, v6, v13
    v_dot2_f32_bf16 v14, v51, v5, v14
    v_dot2_f32_bf16 v15, v51, v6, v15
    s_waitcnt vmcnt(30)
    v_dot2_f32_bf16 v8, v52, v5, v8
    v_dot2_f32_bf16 v9, v52, v6, v9
    v_dot2_f32_bf16 v10, v53, v5, v10
    v_dot2_f32_bf16 v11, v53, v6, v11
    v_dot2_f32_bf16 v12, v54, v5, v12
    v_dot2_f32_bf16 v13, v54, v6, v13
    v_dot2_f32_bf16 v14, v55, v5, v14
    v_dot2_f32_bf16 v15, v55, v6, v15
    s_waitcnt vmcnt(29)
    v_dot2_f32_bf16 v8, v56, v5, v8
    v_dot2_f32_bf16 v9, v56, v6, v9
    v_dot2_f32_bf16 v10, v57, v5, v10
    v_dot2_f32_bf16 v11, v57, v6, v11
    v_dot2_f32_bf16 v12, v58, v5, v12
    v_dot2_f32_bf16 v13, v58, v6, v13
    v_dot2_f32_bf16 v14, v59, v5, v14
    v_dot2_f32_bf16 v15, v59, v6, v15
    s_waitcnt vmcnt(28)
    v_dot2_f32_bf16 v8, v60, v5, v8
    v_dot2_f32_bf16 v9, v60, v6, v9
    v_dot2_f32_bf16 v10, v61, v5, v10
    v_dot2_f32_bf16 v11, v61, v6, v11
    v_dot2_f32_bf16 v12, v62, v5, v12
    v_dot2_f32_bf16 v13, v62, v6, v13
    v_dot2_f32_bf16 v14, v63, v5, v14
    v_dot2_f32_bf16 v15, v63, v6, v15
    s_waitcnt vmcnt(27)
    v_dot2_f32_bf16 v8, v64, v5, v8
    v_dot2_f32_bf16 v9, v64, v6, v9
    v_dot2_f32_bf16 v10, v65, v5, v10
    v_dot2_f32_bf16 v11, v65, v6, v11
    v_dot2_f32_bf16 v12, v66, v5, v12
    v_dot2_f32_bf16 v13, v66, v6, v13
    v_dot2_f32_bf16 v14, v67, v5, v14
    v_dot2_f32_bf16 v15, v67, v6, v15
    s_waitcnt vmcnt(26)
    v_dot2_f32_bf16 v8, v68, v5, v8
    v_dot2_f32_bf16 v9, v68, v6, v9
    v_dot2_f32_bf16 v10, v69, v5, v10
    v_dot2_f32_bf16 v11, v69, v6, v11
    v_dot2_f32_bf16 v12, v70, v5, v12
    v_dot2_f32_bf16 v13, v70, v6, v13
    v_dot2_f32_bf16 v14, v71, v5, v14
    v_dot2_f32_bf16 v15, v71, v6, v15
    s_waitcnt vmcnt(25)
    v_dot2_f32_bf16 v8, v72, v5, v8
    v_dot2_f32_bf16 v9, v72, v6, v9
    v_dot2_f32_bf16 v10, v73, v5, v10
    v_dot2_f32_bf16 v11, v73, v6, v11
    v_dot2_f32_bf16 v12, v74, v5, v12
    v_dot2_f32_bf16 v13, v74, v6, v13
    v_dot2_f32_bf16 v14, v75, v5, v14
    v_dot2_f32_bf16 v15, v75, v6, v15
    s_waitcnt vmcnt(24)
    v_dot2_f32_bf16 v8, v76, v5, v8
    v_dot2_f32_bf16 v9, v76, v6, v9
    v_dot2_f32_bf16 v10, v77, v5, v10
    v_dot2_f32_bf16 v11, v77, v6, v11
    v_dot2_f32_bf16 v12, v78, v5, v12
    v_dot2_f32_bf16 v13, v78, v6, v13
    v_dot2_f32_bf16 v14, v79, v5, v14
    v_dot2_f32_bf16 v15, v79, v6, v15
    s_waitcnt vmcnt(23)
    v_dot2_f32_bf16 v8, v80, v5, v8
    v_dot2_f32_bf16 v9, v80, v6, v9
    v_dot2_f32_bf16 v10, v81, v5, v10
    v_dot2_f32_bf16 v11, v81, v6, v11
    v_dot2_f32_bf16 v12, v82, v5, v12
    v_dot2_f32_bf16 v13, v82, v6, v13
    v_dot2_f32_bf16 v14, v83, v5, v14
    v_dot2_f32_bf16 v15, v83, v6, v15
    s_waitcnt vmcnt(22)
    v_dot2_f32_bf16 v8, v84, v5, v8
    v_dot2_f32_bf16 v9, v84, v6, v9
    v_dot2_f32_bf16 v10, v85, v5, v10
    v_dot2_f32_bf16 v11, v85, v6, v11
    v_dot2_f32_bf16 v12, v86, v5, v12
    v_dot2_f32_bf16 v13, v86, v6, v13
    v_dot2_f32_bf16 v14, v87, v5, v14
    v_dot2_f32_bf16 v15, v87, v6, v15
    s_waitcnt vmcnt(21)
    v_dot2_f32_bf16 v8, v88, v5, v8
    v_dot2_f32_bf16 v9, v88, v6, v9
    v_dot2_f32_bf16 v10, v89, v5, v10
    v_dot2_f32_bf16 v11, v89, v6, v11
    v_dot2_f32_bf16 v12, v90, v5, v12
    v_dot2_f32_bf16 v13, v90, v6, v13
    v_dot2_f32_bf16 v14, v91, v5, v14
    v_dot2_f32_bf16 v15, v91, v6, v15
    s_waitcnt vmcnt(20)
    v_dot2_f32_bf16 v8, v92, v5, v8
    v_dot2_f32_bf16 v9, v92, v6, v9
    v_dot2_f32_bf16 v10, v93, v5, v10
    v_dot2_f32_bf16 v11, v93, v6, v11
    v_dot2_f32_bf16 v12, v94, v5, v12
    v_dot2_f32_bf16 v13, v94, v6, v13
    v_dot2_f32_bf16 v14, v95, v5, v14
    v_dot2_f32_bf16 v15, v95, v6, v15
    s_waitcnt vmcnt(19)
    v_dot2_f32_bf16 v8, v96, v5, v8
    v_dot2_f32_bf16 v9, v96, v6, v9
    v_dot2_f32_bf16 v10, v97, v5, v10
    v_dot2_f32_bf16 v11, v97, v6, v11
    v_dot2_f32_bf16 v12, v98, v5, v12
    v_dot2_f32_bf16 v13, v98, v6, v13
    v_dot2_f32_bf16 v14, v99, v5, v14
    v_dot2_f32_bf16 v15, v99, v6, v15
    s_waitcnt vmcnt(18)
    v_dot2_f32_bf16 v8, v100, v5, v8
    v_dot2_f32_bf16 v9, v100, v6, v9
    v_dot2_f32_bf16 v10, v101, v5, v10
    v_dot2_f32_bf16 v11, v101, v6, v11
    v_dot2_f32_bf16 v12, v102, v5, v12
    v_dot2_f32_bf16 v13, v102, v6, v13
    v_dot2_f32_bf16 v14, v103, v5, v14
    v_dot2_f32_bf16 v15, v103, v6, v15
    s_waitcnt vmcnt(17)
    v_dot2_f32_bf16 v8, v104, v5, v8
    v_dot2_f32_bf16 v9, v104, v6, v9
    v_dot2_f32_bf16 v10, v105, v5, v10
    v_dot2_f32_bf16 v11, v105, v6, v11
    v_dot2_f32_bf16 v12, v106, v5, v12
    v_dot2_f32_bf16 v13, v106, v6, v13
    v_dot2_f32_bf16 v14, v107, v5, v14
    v_dot2_f32_bf16 v15, v107, v6, v15
    s_waitcnt vmcnt(16)
    v_dot2_f32_bf16 v8, v108, v5, v8
    v_dot2_f32_bf16 v9, v108, v6, v9
    v_dot2_f32_bf16 v10, v109, v5, v10
    v_dot2_f32_bf16 v11, v109, v6, v11
    v_dot2_f32_bf16 v12, v110, v5, v12
    v_dot2_f32_bf16 v13, v110, v6, v13
    v_dot2_f32_bf16 v14, v111, v5, v14
    v_dot2_f32_bf16 v15, v111, v6, v15
    s_waitcnt vmcnt(15)
    v_dot2_f32_bf16 v8, v112, v5, v8
    v_dot2_f32_bf16 v9, v112, v6, v9
    v_dot2_f32_bf16 v10, v113, v5, v10
    v_dot2_f32_bf16 v11, v113, v6, v11
    v_dot2_f32_bf16 v12, v114, v5, v12
    v_dot2_f32_bf16 v13, v114, v6, v13
    v_dot2_f32_bf16 v14, v115, v5, v14
    v_dot2_f32_bf16 v15, v115, v6, v15
    s_waitcnt vmcnt(14)
    v_dot2_f32_bf16 v8, v116, v5, v8
    v_dot2_f32_bf16 v9, v116, v6, v9
    v_dot2_f32_bf16 v10, v117, v5, v10
    v_dot2_f32_bf16 v11, v117, v6, v11
    v_dot2_f32_bf16 v12, v118, v5, v12
    v_dot2_f32_bf16 v13, v118, v6, v13
    v_dot2_f32_bf16 v14, v119, v5, v14
    v_dot2_f32_bf16 v15, v119, v6, v15
    s_waitcnt vmcnt(13)
    v_dot2_f32_bf16 v8, v120, v5, v8
    v_dot2_f32_bf16 v9, v120, v6, v9
    v_dot2_f32_bf16 v10, v121, v5, v10
    v_dot2_f32_bf16 v11, v121, v6, v11
    v_dot2_f32_bf16 v12, v122, v5, v12
    v_dot2_f32_bf16 v13, v122, v6, v13
    v_dot2_f32_bf16 v14, v123, v5, v14
    v_dot2_f32_bf16 v15, v123, v6, v15
    s_waitcnt vmcnt(12)
    v_dot2_f32_bf16 v8, v124, v5, v8
    v_dot2_f32_bf16 v9, v124, v6, v9
    v_dot2_f32_bf16 v10, v125, v5, v10
    v_dot2_f32_bf16 v11, v125, v6, v11
    v_dot2_f32_bf16 v12, v126, v5, v12
    v_dot2_f32_bf16 v13, v126, v6, v13
    v_dot2_f32_bf16 v14, v127, v5, v14
    v_dot2_f32_bf16 v15, v127, v6, v15
    s_waitcnt vmcnt(11)
    v_dot2_f32_bf16 v8, v128, v5, v8
    v_dot2_f32_bf16 v9, v128, v6, v9
    v_dot2_f32_bf16 v10, v129, v5, v10
    v_dot2_f32_bf16 v11, v129, v6, v11
    v_dot2_f32_bf16 v12, v130, v5, v12
    v_dot2_f32_bf16 v13, v130, v6, v13
    v_dot2_f32_bf16 v14, v131, v5, v14
    v_dot2_f32_bf16 v15, v131, v6, v15
    s_waitcnt vmcnt(10)
    v_dot2_f32_bf16 v8, v132, v5, v8
    v_dot2_f32_bf16 v9, v132, v6, v9
    v_dot2_f32_bf16 v10, v133, v5, v10
    v_dot2_f32_bf16 v11, v133, v6, v11
    v_dot2_f32_bf16 v12, v134, v5, v12
    v_dot2_f32_bf16 v13, v134, v6, v13
    v_dot2_f32_bf16 v14, v135, v5, v14
    v_dot2_f32_bf16 v15, v135, v6, v15
    s_waitcnt vmcnt(9)
    v_dot2_f32_bf16 v8, v136, v5, v8
    v_dot2_f32_bf16 v9, v136, v6, v9
    v_dot2_f32_bf16 v10, v137, v5, v10
    v_dot2_f32_bf16 v11, v137, v6, v11
    v_dot2_f32_bf16 v12, v138, v5, v12
    v_dot2_f32_bf16 v13, v138, v6, v13
    v_dot2_f32_bf16 v14, v139, v5, v14
    v_dot2_f32_bf16 v15, v139, v6, v15
    s_waitcnt vmcnt(8)
    v_dot2_f32_bf16 v8, v140, v5, v8
    v_dot2_f32_bf16 v9, v140, v6, v9
    v_dot2_f32_bf16 v10, v141, v5, v10
    v_dot2_f32_bf16 v11, v141, v6, v11
    v_dot2_f32_bf16 v12, v142, v5, v12
    v_dot2_f32_bf16 v13, v142, v6, v13
    v_dot2_f32_bf16 v14, v143, v5, v14
    v_dot2_f32_bf16 v15, v143, v6, v15
    s_waitcnt vmcnt(7)
    v_dot2_f32_bf16 v8, v144, v5, v8
    v_dot2_f32_bf16 v9, v144, v6, v9
    v_dot2_f32_bf16 v10, v145, v5, v10
    v_dot2_f32_bf16 v11, v145, v6, v11
    v_dot2_f32_bf16 v12, v146, v5, v12
    v_dot2_f32_bf16 v13, v146, v6, v13
    v_dot2_f32_bf16 v14, v147, v5, v14
    v_dot2_f32_bf16 v15, v147, v6, v15
    s_waitcnt vmcnt(6)
    v_dot2_f32_bf16 v8, v148, v5, v8
    v_dot2_f32_bf16 v9, v148, v6, v9
    v_dot2_f32_bf16 v10, v149, v5, v10
    v_dot2_f32_bf16 v11, v149, v6, v11
    v_dot2_f32_bf16 v12, v150, v5, v12
    v_dot2_f32_bf16 v13, v150, v6, v13
    v_dot2_f32_bf16 v14, v151, v5, v14
    v_dot2_f32_bf16 v15, v151, v6, v15
    s_waitcnt vmcnt(5)
    v_dot2_f32_bf16 v8, v152, v5, v8
    v_dot2_f32_bf16 v9, v152, v6, v9
    v_dot2_f32_bf16 v10, v153, v5, v10
    v_dot2_f32_bf16 v11, v153, v6, v11
    v_dot2_f32_bf16 v12, v154, v5, v12
    v_dot2_f32_bf16 v13, v154, v6, v13
    v_dot2_f32_bf16 v14, v155, v5, v14
    v_dot2_f32_bf16 v15, v155, v6, v15
    s_waitcnt vmcnt(4)
    v_dot2_f32_bf16 v8, v156, v5, v8
    v_dot2_f32_bf16 v9, v156, v6, v9
    v_dot2_f32_bf16 v10, v157, v5, v10
    v_dot2_f32_bf16 v11, v157, v6, v11
    v_dot2_f32_bf16 v12, v158, v5, v12
    v_dot2_f32_bf16 v13, v158, v6, v13
    v_dot2_f32_bf16 v14, v159, v5, v14
    v_dot2_f32_bf16 v15, v159, v6, v15
    s_waitcnt vmcnt(3)
    v_dot2_f32_bf16 v8, v16, v5, v8
    v_dot2_f32_bf16 v9, v16, v6, v9
    v_dot2_f32_bf16 v10, v17, v5, v10
    v_dot2_f32_bf16 v11, v17, v6, v11
    v_dot2_f32_bf16 v12, v18, v5, v12
    v_dot2_f32_bf16 v13, v18, v6, v13
    v_dot2_f32_bf16 v14, v19, v5, v14
    v_dot2_f32_bf16 v15, v19, v6, v15
    s_waitcnt vmcnt(2)
    v_dot2_f32_bf16 v8, v20, v5, v8
    v_dot2_f32_bf16 v9, v20, v6, v9
    v_dot2_f32_bf16 v10, v21, v5, v10
    v_dot2_f32_bf16 v11, v21, v6, v11
    v_dot2_f32_bf16 v12, v22, v5, v12
    v_dot2_f32_bf16 v13, v22, v6, v13
    v_dot2_f32_bf16 v14, v23, v5, v14
    v_dot2_f32_bf16 v15, v23, v6, v15
    s_waitcnt vmcnt(1)
    v_dot2_f32_bf16 v8, v24, v5, v8
    v_dot2_f32_bf16 v9, v24, v6, v9
    v_dot2_f32_bf16 v10, v25, v5, v10
    v_dot2_f32_bf16 v11, v25, v6, v11
    v_dot2_f32_bf16 v12, v26, v5, v12
    v_dot2_f32_bf16 v13, v26, v6, v13
    v_dot2_f32_bf16 v14, v27, v5, v14
    v_dot2_f32_bf16 v15, v27, v6, v15
    s_waitcnt vmcnt(0)
    v_dot2_f32_bf16 v8, v28, v5, v8
    v_dot2_f32_bf16 v9, v28, v6, v9
    v_dot2_f32_bf16 v10, v29, v5, v10
    v_dot2_f32_bf16 v11, v29, v6, v11
    v_dot2_f32_bf16 v12, v30, v5, v12
    v_dot2_f32_bf16 v13, v30, v6, v13
    v_dot2_f32_bf16 v14, v31, v5, v14
    v_dot2_f32_bf16 v15, v31, v6, v15
    s_nop 3
    v_lshlrev_b32 v3, 9, v3
    v_lshl_add_u32 v3, v4, 5, v3
    v_add_u32 v3, 99584, v3
    ds_write_b128 v3, v[8:11] offset:0
    ds_write_b128 v3, v[12:15] offset:16
    s_waitcnt lgkmcnt(0)
    s_barrier
    s_cmp_ge_u32 s40, 2
    s_cbranch_scc1 F_phase_b
    v_lshlrev_b32 v3, 2, v0
    v_add_u32 v4, 99584, v3
    ds_read_b32 v16, v4 offset:0
    ds_read_b32 v17, v4 offset:512
    ds_read_b32 v18, v4 offset:1024
    ds_read_b32 v19, v4 offset:1536
    ds_read_b32 v20, v4 offset:2048
    ds_read_b32 v21, v4 offset:2560
    ds_read_b32 v22, v4 offset:3072
    ds_read_b32 v23, v4 offset:3584
    ds_read_b32 v24, v4 offset:4096
    ds_read_b32 v25, v4 offset:4608
    ds_read_b32 v26, v4 offset:5120
    ds_read_b32 v27, v4 offset:5632
    ds_read_b32 v28, v4 offset:6144
    ds_read_b32 v29, v4 offset:6656
    ds_read_b32 v30, v4 offset:7168
    ds_read_b32 v31, v4 offset:7680
    s_waitcnt lgkmcnt(0)
    v_add_f32 v16, v16, v17
    v_add_f32 v16, v16, v18
    v_add_f32 v16, v16, v19
    v_add_f32 v16, v16, v20
    v_add_f32 v16, v16, v21
    v_add_f32 v16, v16, v22
    v_add_f32 v16, v16, v23
    v_add_f32 v16, v16, v24
    v_add_f32 v16, v16, v25
    v_add_f32 v16, v16, v26
    v_add_f32 v16, v16, v27
    v_add_f32 v16, v16, v28
    v_add_f32 v16, v16, v29
    v_add_f32 v16, v16, v30
    v_add_f32 v16, v16, v31
    s_lshl_b32 s50, s44, 9
    s_add_u32 s50, s50, s52
    s_add_u32 s50, s50, 8290304
    s_add_u32 s24, s86, s50
    s_addc_u32 s25, s87, 0
    s_and_b32 s25, s25, 0xffff
    s_mov_b32 s26, 512
    s_mov_b32 s27, 0x00020000
    buffer_store_dword v16, v3, s[24:27], 0 offen sc1
    s_mov_b32 s50, 61440
    s_waitcnt vmcnt(0)
    v_mov_b32 v4, 1
    s_mov_b64 exec, 1
    buffer_atomic_add v4, off, s[4:7], s50 sc1
    s_mov_b64 exec, -1
F_phase_b:
    v_and_b32 v1, 63, v0
    s_and_b32 s3, s2, 7
    s_lshr_b32 s50, s2, 3
    s_lshr_b32 s51, s3, 2
    s_lshl_b32 s51, s51, 3
    s_lshr_b32 s43, s50, 2
    s_add_u32 s43, s43, s51
    s_and_b32 s51, s3, 3
    s_lshl_b32 s51, s51, 2
    s_and_b32 s44, s50, 3
    s_add_u32 s44, s44, s51
    s_mul_i32 s55, s44, 192
    s_lshl_b32 s50, s43, 2
    s_add_u32 s56, s50, s41
    s_waitcnt lgkmcnt(0)
    s_cmp_ge_u32 s40, 5
    s_cselect_b32 s16, s78, s76
    s_cselect_b32 s17, s79, s77
    s_and_b32 s17, s17, 0xffff
    s_mov_b32 s18, 1966080
    s_mov_b32 s19, 0x00020000
    s_mul_i32 s50, s56, 40960
    s_add_u32 s50, s50, 5505024
    s_add_u32 s20, s86, s50
    s_addc_u32 s21, s87, 0
    s_and_b32 s21, s21, 0xffff
    s_mov_b32 s22, 40960
    s_mov_b32 s23, 0x00020000
    v_lshrrev_b32 v3, 5, v1
    v_lshlrev_b32 v4, 4, v1
    s_mul_i32 s50, s56, 2560
    s_add_u32 s50, s50, 8126464
    s_add_u32 s32, s86, s50
    s_addc_u32 s33, s87, 0
    s_and_b32 s33, s33, 0xffff
    s_mov_b32 s34, 2560
    s_mov_b32 s35, 0x00020000
    v_and_b32 v18, 31, v1
    v_lshlrev_b32 v18, 3, v18
    v_mul_u32_u24 v19, 1280, v3
    v_add_u32 v2, v18, v19
    s_nop 0
    s_cmp_lt_u32 s40, 4
    s_cbranch_scc1 L_compute_64
    s_sub_u32 s50, s40, 4
    s_mul_i32 s53, s50, 12320
    v_mov_b32 v167, v1
    v_mul_u32_u24 v168, 5462, v167
    v_lshrrev_b32 v168, 16, v168
    v_mul_u32_u24 v170, 12, v168
    v_sub_u32 v169, v167, v170
    v_mul_u32_u24 v168, 3072, v168
    v_lshl_add_u32 v168, v169, 4, v168
    v_add_u32 v116, s55, v168
    v_add_u32 v167, 64, v1
    v_mul_u32_u24 v168, 5462, v167
    v_lshrrev_b32 v168, 16, v168
    v_mul_u32_u24 v170, 12, v168
    v_sub_u32 v169, v167, v170
    v_mul_u32_u24 v168, 3072, v168
    v_lshl_add_u32 v168, v169, 4, v168
    v_add_u32 v117, s55, v168
    v_add_u32 v167, 128, v1
    v_mul_u32_u24 v168, 5462, v167
    v_lshrrev_b32 v168, 16, v168
    v_mul_u32_u24 v170, 12, v168
    v_sub_u32 v169, v167, v170
    v_mul_u32_u24 v168, 3072, v168
    v_lshl_add_u32 v168, v169, 4, v168
    v_add_u32 v118, s55, v168
    v_add_u32 v167, 192, v1
    v_mul_u32_u24 v168, 5462, v167
    v_lshrrev_b32 v168, 16, v168
    v_mul_u32_u24 v170, 12, v168
    v_sub_u32 v169, v167, v170
    v_mul_u32_u24 v168, 3072, v168
    v_lshl_add_u32 v168, v169, 4, v168
    v_add_u32 v119, s55, v168
    v_add_u32 v167, 256, v1
    v_mul_u32_u24 v168, 5462, v167
    v_lshrrev_b32 v168, 16, v168
    v_mul_u32_u24 v170, 12, v168
    v_sub_u32 v169, v167, v170
    v_mul_u32_u24 v168, 3072, v168
    v_lshl_add_u32 v168, v169, 4, v168
    v_add_u32 v120, s55, v168
    v_add_u32 v167, 320, v1
    v_mul_u32_u24 v168, 5462, v167
    v_lshrrev_b32 v168, 16, v168
    v_mul_u32_u24 v170, 12, v168
    v_sub_u32 v169, v167, v170
    v_mul_u32_u24 v168, 3072, v168
    v_lshl_add_u32 v168, v169, 4, v168
    v_add_u32 v121, s55, v168
    v_add_u32 v167, 384, v1
    v_mul_u32_u24 v168, 5462, v167
    v_lshrrev_b32 v168, 16, v168
    v_mul_u32_u24 v170, 12, v168
    v_sub_u32 v169, v167, v170
    v_mul_u32_u24 v168, 3072, v168
    v_lshl_add_u32 v168, v169, 4, v168
    v_add_u32 v122, s55, v168
    v_add_u32 v167, 448, v1
    v_mul_u32_u24 v168, 5462, v167
    v_lshrrev_b32 v168, 16, v168
    v_mul_u32_u24 v170, 12, v168
    v_sub_u32 v169, v167, v170
    v_mul_u32_u24 v168, 3072, v168
    v_lshl_add_u32 v168, v169, 4, v168
    v_add_u32 v123, s55, v168
    v_add_u32 v167, 512, v1
    v_mul_u32_u24 v168, 5462, v167
    v_lshrrev_b32 v168, 16, v168
    v_mul_u32_u24 v170, 12, v168
    v_sub_u32 v169, v167, v170
    v_mul_u32_u24 v168, 3072, v168
    v_lshl_add_u32 v168, v169, 4, v168
    v_add_u32 v124, s55, v168
    v_add_u32 v167, 576, v1
    v_mul_u32_u24 v168, 5462, v167
    v_lshrrev_b32 v168, 16, v168
    v_mul_u32_u24 v170, 12, v168
    v_sub_u32 v169, v167, v170
    v_mul_u32_u24 v168, 3072, v168
    v_lshl_add_u32 v168, v169, 4, v168
    v_add_u32 v125, s55, v168
    v_add_u32 v167, 640, v1
    v_mul_u32_u24 v168, 5462, v167
    v_lshrrev_b32 v168, 16, v168
    v_mul_u32_u24 v170, 12, v168
    v_sub_u32 v169, v167, v170
    v_mul_u32_u24 v168, 3072, v168
    v_lshl_add_u32 v168, v169, 4, v168
    v_add_u32 v126, s55, v168
    v_add_u32 v167, 704, v1
    v_mul_u32_u24 v168, 5462, v167
    v_lshrrev_b32 v168, 16, v168
    v_mul_u32_u24 v170, 12, v168
    v_sub_u32 v169, v167, v170
    v_mul_u32_u24 v168, 3072, v168
    v_lshl_add_u32 v168, v169, 4, v168
    v_add_u32 v127, s55, v168
    s_mov_b32 s45, 0
    s_add_u32 s47, s53, 0
    s_add_u32 s51, s53, 98560
    s_cmp_lg_u32 s8, 10
    s_cbranch_scc1 L_rfree_65
    s_barrier
    s_barrier
    s_barrier
    s_barrier
    s_barrier
    s_barrier
    s_barrier
    s_barrier
    s_barrier
    s_mov_b32 s8, 1
L_ramp_69:
    s_mov_b32 m0, s47
    s_nop 0
    buffer_load_dwordx4 v116, s[16:19], s45 offen lds
    s_add_u32 m0, s47, 1024
    s_nop 0
    buffer_load_dwordx4 v117, s[16:19], s45 offen lds
    s_add_u32 m0, s47, 2048
    s_nop 0
    buffer_load_dwordx4 v118, s[16:19], s45 offen lds
    s_add_u32 m0, s47, 3072
    s_nop 0
    buffer_load_dwordx4 v119, s[16:19], s45 offen lds
    s_add_u32 m0, s47, 4096
    s_nop 0
    buffer_load_dwordx4 v120, s[16:19], s45 offen lds
    s_add_u32 m0, s47, 5120
    s_nop 0
    buffer_load_dwordx4 v121, s[16:19], s45 offen lds
    s_add_u32 m0, s47, 6144
    s_nop 0
    buffer_load_dwordx4 v122, s[16:19], s45 offen lds
    s_add_u32 m0, s47, 7168
    s_nop 0
    buffer_load_dwordx4 v123, s[16:19], s45 offen lds
    s_add_u32 m0, s47, 8192
    s_nop 0
    buffer_load_dwordx4 v124, s[16:19], s45 offen lds
    s_add_u32 m0, s47, 9216
    s_nop 0
    buffer_load_dwordx4 v125, s[16:19], s45 offen lds
    s_add_u32 m0, s47, 10240
    s_nop 0
    buffer_load_dwordx4 v126, s[16:19], s45 offen lds
    s_add_u32 m0, s47, 11264
    s_nop 0
    buffer_load_dwordx4 v127, s[16:19], s45 offen lds
    s_add_u32 s45, s45, 196608
    s_add_u32 s47, s47, 24640
    s_cmp_ge_u32 s47, s51
    s_cselect_b32 s47, s53, s47
    s_barrier
    s_sub_u32 s8, s8, 1
    s_cmp_lg_u32 s8, 0
    s_cbranch_scc1 L_ramp_69
    s_barrier
    s_mov_b32 s49, 2
L_ldn_70:
    s_mov_b32 m0, s47
    s_nop 0
    buffer_load_dwordx4 v116, s[16:19], s45 offen lds
    s_add_u32 m0, s47, 1024
    s_nop 0
    buffer_load_dwordx4 v117, s[16:19], s45 offen lds
    s_add_u32 m0, s47, 2048
    s_nop 0
    buffer_load_dwordx4 v118, s[16:19], s45 offen lds
    s_add_u32 m0, s47, 3072
    s_nop 0
    buffer_load_dwordx4 v119, s[16:19], s45 offen lds
    s_add_u32 m0, s47, 4096
    s_nop 0
    buffer_load_dwordx4 v120, s[16:19], s45 offen lds
    s_add_u32 m0, s47, 5120
    s_nop 0
    buffer_load_dwordx4 v121, s[16:19], s45 offen lds
    s_add_u32 m0, s47, 6144
    s_nop 0
    buffer_load_dwordx4 v122, s[16:19], s45 offen lds
    s_add_u32 m0, s47, 7168
    s_nop 0
    buffer_load_dwordx4 v123, s[16:19], s45 offen lds
    s_add_u32 m0, s47, 8192
    s_nop 0
    buffer_load_dwordx4 v124, s[16:19], s45 offen lds
    s_add_u32 m0, s47, 9216
    s_nop 0
    buffer_load_dwordx4 v125, s[16:19], s45 offen lds
    s_add_u32 m0, s47, 10240
    s_nop 0
    buffer_load_dwordx4 v126, s[16:19], s45 offen lds
    s_add_u32 m0, s47, 11264
    s_nop 0
    buffer_load_dwordx4 v127, s[16:19], s45 offen lds
    s_add_u32 s45, s45, 196608
    s_add_u32 s47, s47, 24640
    s_cmp_ge_u32 s47, s51
    s_cselect_b32 s47, s53, s47
    s_sub_u32 s49, s49, 1
    s_cmp_lg_u32 s49, 0
    s_cbranch_scc1 L_ldn_70
    s_branch L_ramped_68
L_rfree_65:
    s_cmp_eq_u32 s8, 0
    s_cbranch_scc1 L_prebar_done_67
    s_barrier
L_prebar_done_67:
    s_mov_b32 s49, 3
L_ldn_71:
    s_mov_b32 m0, s47
    s_nop 0
    buffer_load_dwordx4 v116, s[16:19], s45 offen lds
    s_add_u32 m0, s47, 1024
    s_nop 0
    buffer_load_dwordx4 v117, s[16:19], s45 offen lds
    s_add_u32 m0, s47, 2048
    s_nop 0
    buffer_load_dwordx4 v118, s[16:19], s45 offen lds
    s_add_u32 m0, s47, 3072
    s_nop 0
    buffer_load_dwordx4 v119, s[16:19], s45 offen lds
    s_add_u32 m0, s47, 4096
    s_nop 0
    buffer_load_dwordx4 v120, s[16:19], s45 offen lds
    s_add_u32 m0, s47, 5120
    s_nop 0
    buffer_load_dwordx4 v121, s[16:19], s45 offen lds
    s_add_u32 m0, s47, 6144
    s_nop 0
    buffer_load_dwordx4 v122, s[16:19], s45 offen lds
    s_add_u32 m0, s47, 7168
    s_nop 0
    buffer_load_dwordx4 v123, s[16:19], s45 offen lds
    s_add_u32 m0, s47, 8192
    s_nop 0
    buffer_load_dwordx4 v124, s[16:19], s45 offen lds
    s_add_u32 m0, s47, 9216
    s_nop 0
    buffer_load_dwordx4 v125, s[16:19], s45 offen lds
    s_add_u32 m0, s47, 10240
    s_nop 0
    buffer_load_dwordx4 v126, s[16:19], s45 offen lds
    s_add_u32 m0, s47, 11264
    s_nop 0
    buffer_load_dwordx4 v127, s[16:19], s45 offen lds
    s_add_u32 s45, s45, 196608
    s_add_u32 s47, s47, 24640
    s_cmp_ge_u32 s47, s51
    s_cselect_b32 s47, s53, s47
    s_sub_u32 s49, s49, 1
    s_cmp_lg_u32 s49, 0
    s_cbranch_scc1 L_ldn_71
L_ramped_68:
    s_waitcnt vmcnt(24)
    s_barrier
    s_mov_b32 s46, 7
L_ldloop_72:
    s_waitcnt vmcnt(12)
    s_barrier
    s_mov_b32 m0, s47
    s_nop 0
    buffer_load_dwordx4 v116, s[16:19], s45 offen lds
    s_add_u32 m0, s47, 1024
    s_nop 0
    buffer_load_dwordx4 v117, s[16:19], s45 offen lds
    s_add_u32 m0, s47, 2048
    s_nop 0
    buffer_load_dwordx4 v118, s[16:19], s45 offen lds
    s_add_u32 m0, s47, 3072
    s_nop 0
    buffer_load_dwordx4 v119, s[16:19], s45 offen lds
    s_add_u32 m0, s47, 4096
    s_nop 0
    buffer_load_dwordx4 v120, s[16:19], s45 offen lds
    s_add_u32 m0, s47, 5120
    s_nop 0
    buffer_load_dwordx4 v121, s[16:19], s45 offen lds
    s_add_u32 m0, s47, 6144
    s_nop 0
    buffer_load_dwordx4 v122, s[16:19], s45 offen lds
    s_add_u32 m0, s47, 7168
    s_nop 0
    buffer_load_dwordx4 v123, s[16:19], s45 offen lds
    s_add_u32 m0, s47, 8192
    s_nop 0
    buffer_load_dwordx4 v124, s[16:19], s45 offen lds
    s_add_u32 m0, s47, 9216
    s_nop 0
    buffer_load_dwordx4 v125, s[16:19], s45 offen lds
    s_add_u32 m0, s47, 10240
    s_nop 0
    buffer_load_dwordx4 v126, s[16:19], s45 offen lds
    s_add_u32 m0, s47, 11264
    s_nop 0
    buffer_load_dwordx4 v127, s[16:19], s45 offen lds
    s_add_u32 s45, s45, 196608
    s_add_u32 s47, s47, 24640
    s_cmp_ge_u32 s47, s51
    s_cselect_b32 s47, s53, s47
    s_sub_u32 s46, s46, 1
    s_cmp_lg_u32 s46, 0
    s_cbranch_scc1 L_ldloop_72
    s_mov_b32 s50, 61440
    buffer_load_dword v18, off, s[4:7], s50 sc1
    s_waitcnt vmcnt(13)
    s_barrier
    s_waitcnt vmcnt(0)
    s_barrier
    s_cmp_eq_u32 s40, 4
    s_cbranch_scc1 F_phase_c
    v_readfirstlane_b32 s10, v18
    s_cmp_ge_u32 s10, 48
    s_cbranch_scc1 L_csok_73
    s_mov_b32 s50, 61440
    s_mov_b32 s9, 0
L_poll_74:
    buffer_load_dword v18, off, s[4:7], s50 sc1
    s_waitcnt vmcnt(0)
    v_readfirstlane_b32 s10, v18
    s_cmp_ge_u32 s10, 48
    s_cbranch_scc1 L_polled_75
    s_add_u32 s9, s9, 1
    s_sleep 2
    s_cmp_lt_u32 s9, 50000
    s_cbranch_scc1 L_poll_74
L_polled_75:
L_csok_73:
    s_add_u32 s36, s86, 8290304
    s_addc_u32 s37, s87, 0
    s_and_b32 s37, s37, 0xffff
    s_mov_b32 s38, 12288
    s_mov_b32 s39, 0x00020000
    v_cmp_le_u32 vcc, 24, v1
    v_add_u32 v19, 5760, v4
    s_nop 0
    v_cndmask_b32 v18, v4, v19, vcc
    v_cmp_le_u32 vcc, 48, v1
    v_mov_b32 v19, 0x40000000
    s_nop 0
    v_cndmask_b32 v18, v18, v19, vcc
    s_mul_i32 s50, s44, 384
    s_mov_b32 m0, 148736
    s_nop 0
    buffer_load_dwordx4 v18, s[36:39], s50 offen sc1 lds
    s_waitcnt vmcnt(0)
    s_barrier
    s_mov_b32 s28, s80
    s_and_b32 s29, s81, 0xffff
    s_mov_b32 s30, 1966080
    s_mov_b32 s31, 0x00020000
    s_lshr_b32 s50, s2, 3
    s_mul_i32 s50, s50, 61440
    s_endpgm
L_compute_64:
    v_lshrrev_b32 v167, 5, v1
    v_mul_u32_u24 v164, 768, v167
    v_bfe_u32 v167, v1, 4, 1
    v_mul_u32_u24 v167, 12320, v167
    v_add_u32 v164, v164, v167
    v_bfe_u32 v167, v1, 2, 2
    v_mul_u32_u24 v168, 192, v167
    v_add_u32 v164, v164, v168
    v_and_b32 v168, 3, v1
    v_lshl_add_u32 v164, v168, 3, v164
    v_mov_b32 v20, 0
    v_mov_b32 v21, 0
    v_mov_b32 v22, 0
    v_mov_b32 v23, 0
    v_mov_b32 v24, 0
    v_mov_b32 v25, 0
    v_mov_b32 v26, 0
    v_mov_b32 v27, 0
    v_mov_b32 v28, 0
    v_mov_b32 v29, 0
    v_mov_b32 v30, 0
    v_mov_b32 v31, 0
    v_mov_b32 v32, 0
    v_mov_b32 v33, 0
    v_mov_b32 v34, 0
    v_mov_b32 v35, 0
    v_mov_b32 v36, 0
    v_mov_b32 v37, 0
    v_mov_b32 v38, 0
    v_mov_b32 v39, 0
    v_mov_b32 v40, 0
    v_mov_b32 v41, 0
    v_mov_b32 v42, 0
    v_mov_b32 v43, 0
    v_mov_b32 v44, 0
    v_mov_b32 v45, 0
    v_mov_b32 v46, 0
    v_mov_b32 v47, 0
    v_mov_b32 v48, 0
    v_mov_b32 v49, 0
    v_mov_b32 v50, 0
    v_mov_b32 v51, 0
    v_mov_b32 v52, 0
    v_mov_b32 v53, 0
    v_mov_b32 v54, 0
    v_mov_b32 v55, 0
    v_mov_b32 v56, 0
    v_mov_b32 v57, 0
    v_mov_b32 v58, 0
    v_mov_b32 v59, 0
    v_mov_b32 v60, 0
    v_mov_b32 v61, 0
    v_mov_b32 v62, 0
    v_mov_b32 v63, 0
    v_mov_b32 v64, 0
    v_mov_b32 v65, 0
    v_mov_b32 v66, 0
    v_mov_b32 v67, 0
    v_mov_b32 v68, 0
    v_mov_b32 v69, 0
    v_mov_b32 v70, 0
    v_mov_b32 v71, 0
    v_mov_b32 v72, 0
    v_mov_b32 v73, 0
    v_mov_b32 v74, 0
    v_mov_b32 v75, 0
    v_mov_b32 v76, 0
    v_mov_b32 v77, 0
    v_mov_b32 v78, 0
    v_mov_b32 v79, 0
    v_mov_b32 v80, 0
    v_mov_b32 v81, 0
    v_mov_b32 v82, 0
    v_mov_b32 v83, 0
    v_mov_b32 v84, 0
    v_mov_b32 v85, 0
    v_mov_b32 v86, 0
    v_mov_b32 v87, 0
    v_mov_b32 v88, 0
    v_mov_b32 v89, 0
    v_mov_b32 v90, 0
    v_mov_b32 v91, 0
    v_mov_b32 v92, 0
    v_mov_b32 v93, 0
    v_mov_b32 v94, 0
    v_mov_b32 v95, 0
    v_mov_b32 v96, 0
    v_mov_b32 v97, 0
    v_mov_b32 v98, 0
    v_mov_b32 v99, 0
    v_mov_b32 v100, 0
    v_mov_b32 v101, 0
    v_mov_b32 v102, 0
    v_mov_b32 v103, 0
    v_mov_b32 v104, 0
    v_mov_b32 v105, 0
    v_mov_b32 v106, 0
    v_mov_b32 v107, 0
    v_mov_b32 v108, 0
    v_mov_b32 v109, 0
    v_mov_b32 v110, 0
    v_mov_b32 v111, 0
    v_mov_b32 v112, 0
    v_mov_b32 v113, 0
    v_mov_b32 v114, 0
    v_mov_b32 v115, 0
    v_add_u32 v165, 0, v164
    s_mov_b32 s48, 0
    s_lshl_b32 s50, s56, 8
    s_add_u32 s50, s50, 16384
    s_mov_b32 s9, 0
L_poll_76:
    buffer_load_dword v18, off, s[4:7], s50 sc1
    s_waitcnt vmcnt(0)
    v_readfirstlane_b32 s10, v18
    s_cmp_ge_u32 s10, 10
    s_cbranch_scc1 L_polled_77
    s_add_u32 s9, s9, 1
    s_sleep 2
    s_cmp_lt_u32 s9, 50000
    s_cbranch_scc1 L_poll_76
L_polled_77:
    buffer_load_dwordx2 v[8:9], v2, s[32:35], 0 offen offset:0 sc1
    buffer_load_dwordx2 v[10:11], v2, s[32:35], 0 offen offset:256 sc1
    buffer_load_dwordx2 v[12:13], v2, s[32:35], 0 offen offset:512 sc1
    buffer_load_dwordx2 v[14:15], v2, s[32:35], 0 offen offset:768 sc1
    buffer_load_dwordx2 v[16:17], v2, s[32:35], 0 offen offset:1024 sc1
    s_mov_b32 s62, 0
    buffer_load_dwordx4 a[0:3], v4, s[20:23], s62 offen offset:0 sc1
    buffer_load_dwordx4 a[4:7], v4, s[20:23], s62 offen offset:1024 sc1
    buffer_load_dwordx4 a[8:11], v4, s[20:23], s62 offen offset:2048 sc1
    buffer_load_dwordx4 a[12:15], v4, s[20:23], s62 offen offset:3072 sc1
    s_mov_b32 s62, 4096
    buffer_load_dwordx4 a[16:19], v4, s[20:23], s62 offen offset:0 sc1
    buffer_load_dwordx4 a[20:23], v4, s[20:23], s62 offen offset:1024 sc1
    buffer_load_dwordx4 a[24:27], v4, s[20:23], s62 offen offset:2048 sc1
    buffer_load_dwordx4 a[28:31], v4, s[20:23], s62 offen offset:3072 sc1
    s_mov_b32 s62, 8192
    buffer_load_dwordx4 a[32:35], v4, s[20:23], s62 offen offset:0 sc1
    buffer_load_dwordx4 a[36:39], v4, s[20:23], s62 offen offset:1024 sc1
    buffer_load_dwordx4 a[40:43], v4, s[20:23], s62 offen offset:2048 sc1
    buffer_load_dwordx4 a[44:47], v4, s[20:23], s62 offen offset:3072 sc1
    s_mov_b32 s62, 12288
    buffer_load_dwordx4 a[48:51], v4, s[20:23], s62 offen offset:0 sc1
    buffer_load_dwordx4 a[52:55], v4, s[20:23], s62 offen offset:1024 sc1
    buffer_load_dwordx4 a[56:59], v4, s[20:23], s62 offen offset:2048 sc1
    buffer_load_dwordx4 a[60:63], v4, s[20:23], s62 offen offset:3072 sc1
    s_waitcnt vmcnt(12)
    s_barrier
    ds_read_b64_tr_b16 v[116:117], v165 offset:0
    ds_read_b64_tr_b16 v[118:119], v165 offset:1536
    ds_read_b64_tr_b16 v[120:121], v165 offset:32
    ds_read_b64_tr_b16 v[122:123], v165 offset:1568
    ds_read_b64_tr_b16 v[124:125], v165 offset:64
    ds_read_b64_tr_b16 v[126:127], v165 offset:1600
    ds_read_b64_tr_b16 v[128:129], v165 offset:96
    ds_read_b64_tr_b16 v[130:131], v165 offset:1632
    ds_read_b64_tr_b16 v[132:133], v165 offset:128
    ds_read_b64_tr_b16 v[134:135], v165 offset:1664
    ds_read_b64_tr_b16 v[136:137], v165 offset:160
    ds_read_b64_tr_b16 v[138:139], v165 offset:1696
    s_waitcnt lgkmcnt(10)
    v_mfma_f32_32x32x16_bf16 v[20:35], v[116:119], a[0:3], v[20:35]
    ds_read_b64_tr_b16 v[140:141], v165 offset:3072
    ds_read_b64_tr_b16 v[142:143], v165 offset:4608
    s_waitcnt lgkmcnt(10)
    v_mfma_f32_32x32x16_bf16 v[36:51], v[120:123], a[0:3], v[36:51]
    ds_read_b64_tr_b16 v[144:145], v165 offset:3104
    ds_read_b64_tr_b16 v[146:147], v165 offset:4640
    s_waitcnt lgkmcnt(10)
    v_mfma_f32_32x32x16_bf16 v[52:67], v[124:127], a[0:3], v[52:67]
    ds_read_b64_tr_b16 v[148:149], v165 offset:3136
    ds_read_b64_tr_b16 v[150:151], v165 offset:4672
    s_waitcnt lgkmcnt(10)
    v_mfma_f32_32x32x16_bf16 v[68:83], v[128:131], a[0:3], v[68:83]
    ds_read_b64_tr_b16 v[152:153], v165 offset:3168
    ds_read_b64_tr_b16 v[154:155], v165 offset:4704
    s_waitcnt lgkmcnt(10)
    v_mfma_f32_32x32x16_bf16 v[84:99], v[132:135], a[0:3], v[84:99]
    ds_read_b64_tr_b16 v[156:157], v165 offset:3200
    ds_read_b64_tr_b16 v[158:159], v165 offset:4736
    s_waitcnt lgkmcnt(10)
    v_mfma_f32_32x32x16_bf16 v[100:115], v[136:139], a[0:3], v[100:115]
    ds_read_b64_tr_b16 v[160:161], v165 offset:3232
    ds_read_b64_tr_b16 v[162:163], v165 offset:4768
    s_mov_b32 s62, 16384
    buffer_load_dwordx4 a[0:3], v4, s[20:23], s62 offen offset:0 sc1
    s_waitcnt lgkmcnt(10)
    v_mfma_f32_32x32x16_bf16 v[20:35], v[140:143], a[4:7], v[20:35]
    ds_read_b64_tr_b16 v[116:117], v165 offset:6144
    ds_read_b64_tr_b16 v[118:119], v165 offset:7680
    s_waitcnt lgkmcnt(10)
    v_mfma_f32_32x32x16_bf16 v[36:51], v[144:147], a[4:7], v[36:51]
    ds_read_b64_tr_b16 v[120:121], v165 offset:6176
    ds_read_b64_tr_b16 v[122:123], v165 offset:7712
    s_waitcnt lgkmcnt(10)
    v_mfma_f32_32x32x16_bf16 v[52:67], v[148:151], a[4:7], v[52:67]
    ds_read_b64_tr_b16 v[124:125], v165 offset:6208
    ds_read_b64_tr_b16 v[126:127], v165 offset:7744
    s_waitcnt lgkmcnt(10)
    v_mfma_f32_32x32x16_bf16 v[68:83], v[152:155], a[4:7], v[68:83]
    ds_read_b64_tr_b16 v[128:129], v165 offset:6240
    ds_read_b64_tr_b16 v[130:131], v165 offset:7776
    s_waitcnt lgkmcnt(10)
    v_mfma_f32_32x32x16_bf16 v[84:99], v[156:159], a[4:7], v[84:99]
    ds_read_b64_tr_b16 v[132:133], v165 offset:6272
    ds_read_b64_tr_b16 v[134:135], v165 offset:7808
    s_waitcnt lgkmcnt(10)
    v_mfma_f32_32x32x16_bf16 v[100:115], v[160:163], a[4:7], v[100:115]
    ds_read_b64_tr_b16 v[136:137], v165 offset:6304
    ds_read_b64_tr_b16 v[138:139], v165 offset:7840
    buffer_load_dwordx4 a[4:7], v4, s[20:23], s62 offen offset:1024 sc1
    s_waitcnt lgkmcnt(10)
    v_mfma_f32_32x32x16_bf16 v[20:35], v[116:119], a[8:11], v[20:35]
    ds_read_b64_tr_b16 v[140:141], v165 offset:9216
    ds_read_b64_tr_b16 v[142:143], v165 offset:10752
    s_waitcnt lgkmcnt(10)
    v_mfma_f32_32x32x16_bf16 v[36:51], v[120:123], a[8:11], v[36:51]
    ds_read_b64_tr_b16 v[144:145], v165 offset:9248
    ds_read_b64_tr_b16 v[146:147], v165 offset:10784
    s_waitcnt lgkmcnt(10)
    v_mfma_f32_32x32x16_bf16 v[52:67], v[124:127], a[8:11], v[52:67]
    ds_read_b64_tr_b16 v[148:149], v165 offset:9280
    ds_read_b64_tr_b16 v[150:151], v165 offset:10816
    s_waitcnt lgkmcnt(10)
    v_mfma_f32_32x32x16_bf16 v[68:83], v[128:131], a[8:11], v[68:83]
    ds_read_b64_tr_b16 v[152:153], v165 offset:9312
    ds_read_b64_tr_b16 v[154:155], v165 offset:10848
    s_waitcnt lgkmcnt(10)
    v_mfma_f32_32x32x16_bf16 v[84:99], v[132:135], a[8:11], v[84:99]
    ds_read_b64_tr_b16 v[156:157], v165 offset:9344
    ds_read_b64_tr_b16 v[158:159], v165 offset:10880
    s_waitcnt lgkmcnt(10)
    v_mfma_f32_32x32x16_bf16 v[100:115], v[136:139], a[8:11], v[100:115]
    ds_read_b64_tr_b16 v[160:161], v165 offset:9376
    ds_read_b64_tr_b16 v[162:163], v165 offset:10912
    buffer_load_dwordx4 a[8:11], v4, s[20:23], s62 offen offset:2048 sc1
    s_waitcnt lgkmcnt(10)
    v_mfma_f32_32x32x16_bf16 v[20:35], v[140:143], a[12:15], v[20:35]
    s_add_u32 s48, s48, 24640
    s_cmp_ge_u32 s48, 98560
    s_cselect_b32 s48, 0, s48
    v_add_u32 v166, s48, v164
    s_waitcnt vmcnt(11)
    s_barrier
    ds_read_b64_tr_b16 v[116:117], v166 offset:0
    ds_read_b64_tr_b16 v[118:119], v166 offset:1536
    s_waitcnt lgkmcnt(10)
    v_mfma_f32_32x32x16_bf16 v[36:51], v[144:147], a[12:15], v[36:51]
    ds_read_b64_tr_b16 v[120:121], v166 offset:32
    ds_read_b64_tr_b16 v[122:123], v166 offset:1568
    s_waitcnt lgkmcnt(10)
    v_mfma_f32_32x32x16_bf16 v[52:67], v[148:151], a[12:15], v[52:67]
    ds_read_b64_tr_b16 v[124:125], v166 offset:64
    ds_read_b64_tr_b16 v[126:127], v166 offset:1600
    s_waitcnt lgkmcnt(10)
    v_mfma_f32_32x32x16_bf16 v[68:83], v[152:155], a[12:15], v[68:83]
    ds_read_b64_tr_b16 v[128:129], v166 offset:96
    ds_read_b64_tr_b16 v[130:131], v166 offset:1632
    s_waitcnt lgkmcnt(10)
    v_mfma_f32_32x32x16_bf16 v[84:99], v[156:159], a[12:15], v[84:99]
    ds_read_b64_tr_b16 v[132:133], v166 offset:128
    ds_read_b64_tr_b16 v[134:135], v166 offset:1664
    s_waitcnt lgkmcnt(10)
    v_mfma_f32_32x32x16_bf16 v[100:115], v[160:163], a[12:15], v[100:115]
    ds_read_b64_tr_b16 v[136:137], v166 offset:160
    ds_read_b64_tr_b16 v[138:139], v166 offset:1696
    buffer_load_dwordx4 a[12:15], v4, s[20:23], s62 offen offset:3072 sc1
    s_waitcnt lgkmcnt(10)
    v_mfma_f32_32x32x16_bf16 v[20:35], v[116:119], a[16:19], v[20:35]
    ds_read_b64_tr_b16 v[140:141], v166 offset:3072
    ds_read_b64_tr_b16 v[142:143], v166 offset:4608
    s_waitcnt lgkmcnt(10)
    v_mfma_f32_32x32x16_bf16 v[36:51], v[120:123], a[16:19], v[36:51]
    ds_read_b64_tr_b16 v[144:145], v166 offset:3104
    ds_read_b64_tr_b16 v[146:147], v166 offset:4640
    s_waitcnt lgkmcnt(10)
    v_mfma_f32_32x32x16_bf16 v[52:67], v[124:127], a[16:19], v[52:67]
    ds_read_b64_tr_b16 v[148:149], v166 offset:3136
    ds_read_b64_tr_b16 v[150:151], v166 offset:4672
    s_waitcnt lgkmcnt(10)
    v_mfma_f32_32x32x16_bf16 v[68:83], v[128:131], a[16:19], v[68:83]
    ds_read_b64_tr_b16 v[152:153], v166 offset:3168
    ds_read_b64_tr_b16 v[154:155], v166 offset:4704
    s_waitcnt lgkmcnt(10)
    v_mfma_f32_32x32x16_bf16 v[84:99], v[132:135], a[16:19], v[84:99]
    ds_read_b64_tr_b16 v[156:157], v166 offset:3200
    ds_read_b64_tr_b16 v[158:159], v166 offset:4736
    s_waitcnt lgkmcnt(10)
    v_mfma_f32_32x32x16_bf16 v[100:115], v[136:139], a[16:19], v[100:115]
    ds_read_b64_tr_b16 v[160:161], v166 offset:3232
    ds_read_b64_tr_b16 v[162:163], v166 offset:4768
    s_mov_b32 s62, 20480
    buffer_load_dwordx4 a[16:19], v4, s[20:23], s62 offen offset:0 sc1
    s_waitcnt lgkmcnt(10)
    v_mfma_f32_32x32x16_bf16 v[20:35], v[140:143], a[20:23], v[20:35]
    ds_read_b64_tr_b16 v[116:117], v166 offset:6144
    ds_read_b64_tr_b16 v[118:119], v166 offset:7680
    s_waitcnt lgkmcnt(10)
    v_mfma_f32_32x32x16_bf16 v[36:51], v[144:147], a[20:23], v[36:51]
    ds_read_b64_tr_b16 v[120:121], v166 offset:6176
    ds_read_b64_tr_b16 v[122:123], v166 offset:7712
    s_waitcnt lgkmcnt(10)
    v_mfma_f32_32x32x16_bf16 v[52:67], v[148:151], a[20:23], v[52:67]
    ds_read_b64_tr_b16 v[124:125], v166 offset:6208
    ds_read_b64_tr_b16 v[126:127], v166 offset:7744
    s_waitcnt lgkmcnt(10)
    v_mfma_f32_32x32x16_bf16 v[68:83], v[152:155], a[20:23], v[68:83]
    ds_read_b64_tr_b16 v[128:129], v166 offset:6240
    ds_read_b64_tr_b16 v[130:131], v166 offset:7776
    s_waitcnt lgkmcnt(10)
    v_mfma_f32_32x32x16_bf16 v[84:99], v[156:159], a[20:23], v[84:99]
    ds_read_b64_tr_b16 v[132:133], v166 offset:6272
    ds_read_b64_tr_b16 v[134:135], v166 offset:7808
    s_waitcnt lgkmcnt(10)
    v_mfma_f32_32x32x16_bf16 v[100:115], v[160:163], a[20:23], v[100:115]
    ds_read_b64_tr_b16 v[136:137], v166 offset:6304
    ds_read_b64_tr_b16 v[138:139], v166 offset:7840
    buffer_load_dwordx4 a[20:23], v4, s[20:23], s62 offen offset:1024 sc1
    s_waitcnt lgkmcnt(10)
    v_mfma_f32_32x32x16_bf16 v[20:35], v[116:119], a[24:27], v[20:35]
    ds_read_b64_tr_b16 v[140:141], v166 offset:9216
    ds_read_b64_tr_b16 v[142:143], v166 offset:10752
    s_waitcnt lgkmcnt(10)
    v_mfma_f32_32x32x16_bf16 v[36:51], v[120:123], a[24:27], v[36:51]
    ds_read_b64_tr_b16 v[144:145], v166 offset:9248
    ds_read_b64_tr_b16 v[146:147], v166 offset:10784
    s_waitcnt lgkmcnt(10)
    v_mfma_f32_32x32x16_bf16 v[52:67], v[124:127], a[24:27], v[52:67]
    ds_read_b64_tr_b16 v[148:149], v166 offset:9280
    ds_read_b64_tr_b16 v[150:151], v166 offset:10816
    s_waitcnt lgkmcnt(10)
    v_mfma_f32_32x32x16_bf16 v[68:83], v[128:131], a[24:27], v[68:83]
    ds_read_b64_tr_b16 v[152:153], v166 offset:9312
    ds_read_b64_tr_b16 v[154:155], v166 offset:10848
    s_waitcnt lgkmcnt(10)
    v_mfma_f32_32x32x16_bf16 v[84:99], v[132:135], a[24:27], v[84:99]
    ds_read_b64_tr_b16 v[156:157], v166 offset:9344
    ds_read_b64_tr_b16 v[158:159], v166 offset:10880
    s_waitcnt lgkmcnt(10)
    v_mfma_f32_32x32x16_bf16 v[100:115], v[136:139], a[24:27], v[100:115]
    ds_read_b64_tr_b16 v[160:161], v166 offset:9376
    ds_read_b64_tr_b16 v[162:163], v166 offset:10912
    buffer_load_dwordx4 a[24:27], v4, s[20:23], s62 offen offset:2048 sc1
    s_waitcnt lgkmcnt(10)
    v_mfma_f32_32x32x16_bf16 v[20:35], v[140:143], a[28:31], v[20:35]
    s_add_u32 s48, s48, 24640
    s_cmp_ge_u32 s48, 98560
    s_cselect_b32 s48, 0, s48
    v_add_u32 v165, s48, v164
    s_waitcnt vmcnt(11)
    s_barrier
    ds_read_b64_tr_b16 v[116:117], v165 offset:0
    ds_read_b64_tr_b16 v[118:119], v165 offset:1536
    s_waitcnt lgkmcnt(10)
    v_mfma_f32_32x32x16_bf16 v[36:51], v[144:147], a[28:31], v[36:51]
    ds_read_b64_tr_b16 v[120:121], v165 offset:32
    ds_read_b64_tr_b16 v[122:123], v165 offset:1568
    s_waitcnt lgkmcnt(10)
    v_mfma_f32_32x32x16_bf16 v[52:67], v[148:151], a[28:31], v[52:67]
    ds_read_b64_tr_b16 v[124:125], v165 offset:64
    ds_read_b64_tr_b16 v[126:127], v165 offset:1600
    s_waitcnt lgkmcnt(10)
    v_mfma_f32_32x32x16_bf16 v[68:83], v[152:155], a[28:31], v[68:83]
    ds_read_b64_tr_b16 v[128:129], v165 offset:96
    ds_read_b64_tr_b16 v[130:131], v165 offset:1632
    s_waitcnt lgkmcnt(10)
    v_mfma_f32_32x32x16_bf16 v[84:99], v[156:159], a[28:31], v[84:99]
    ds_read_b64_tr_b16 v[132:133], v165 offset:128
    ds_read_b64_tr_b16 v[134:135], v165 offset:1664
    s_waitcnt lgkmcnt(10)
    v_mfma_f32_32x32x16_bf16 v[100:115], v[160:163], a[28:31], v[100:115]
    ds_read_b64_tr_b16 v[136:137], v165 offset:160
    ds_read_b64_tr_b16 v[138:139], v165 offset:1696
    buffer_load_dwordx4 a[28:31], v4, s[20:23], s62 offen offset:3072 sc1
    s_waitcnt lgkmcnt(10)
    v_mfma_f32_32x32x16_bf16 v[20:35], v[116:119], a[32:35], v[20:35]
    ds_read_b64_tr_b16 v[140:141], v165 offset:3072
    ds_read_b64_tr_b16 v[142:143], v165 offset:4608
    s_waitcnt lgkmcnt(10)
    v_mfma_f32_32x32x16_bf16 v[36:51], v[120:123], a[32:35], v[36:51]
    ds_read_b64_tr_b16 v[144:145], v165 offset:3104
    ds_read_b64_tr_b16 v[146:147], v165 offset:4640
    s_waitcnt lgkmcnt(10)
    v_mfma_f32_32x32x16_bf16 v[52:67], v[124:127], a[32:35], v[52:67]
    ds_read_b64_tr_b16 v[148:149], v165 offset:3136
    ds_read_b64_tr_b16 v[150:151], v165 offset:4672
    s_waitcnt lgkmcnt(10)
    v_mfma_f32_32x32x16_bf16 v[68:83], v[128:131], a[32:35], v[68:83]
    ds_read_b64_tr_b16 v[152:153], v165 offset:3168
    ds_read_b64_tr_b16 v[154:155], v165 offset:4704
    s_waitcnt lgkmcnt(10)
    v_mfma_f32_32x32x16_bf16 v[84:99], v[132:135], a[32:35], v[84:99]
    ds_read_b64_tr_b16 v[156:157], v165 offset:3200
    ds_read_b64_tr_b16 v[158:159], v165 offset:4736
    s_waitcnt lgkmcnt(10)
    v_mfma_f32_32x32x16_bf16 v[100:115], v[136:139], a[32:35], v[100:115]
    ds_read_b64_tr_b16 v[160:161], v165 offset:3232
    ds_read_b64_tr_b16 v[162:163], v165 offset:4768
    s_mov_b32 s62, 24576
    buffer_load_dwordx4 a[32:35], v4, s[20:23], s62 offen offset:0 sc1
    s_waitcnt lgkmcnt(10)
    v_mfma_f32_32x32x16_bf16 v[20:35], v[140:143], a[36:39], v[20:35]
    ds_read_b64_tr_b16 v[116:117], v165 offset:6144
    ds_read_b64_tr_b16 v[118:119], v165 offset:7680
    s_waitcnt lgkmcnt(10)
    v_mfma_f32_32x32x16_bf16 v[36:51], v[144:147], a[36:39], v[36:51]
    ds_read_b64_tr_b16 v[120:121], v165 offset:6176
    ds_read_b64_tr_b16 v[122:123], v165 offset:7712
    s_waitcnt lgkmcnt(10)
    v_mfma_f32_32x32x16_bf16 v[52:67], v[148:151], a[36:39], v[52:67]
    ds_read_b64_tr_b16 v[124:125], v165 offset:6208
    ds_read_b64_tr_b16 v[126:127], v165 offset:7744
    s_waitcnt lgkmcnt(10)
    v_mfma_f32_32x32x16_bf16 v[68:83], v[152:155], a[36:39], v[68:83]
    ds_read_b64_tr_b16 v[128:129], v165 offset:6240
    ds_read_b64_tr_b16 v[130:131], v165 offset:7776
    s_waitcnt lgkmcnt(10)
    v_mfma_f32_32x32x16_bf16 v[84:99], v[156:159], a[36:39], v[84:99]
    ds_read_b64_tr_b16 v[132:133], v165 offset:6272
    ds_read_b64_tr_b16 v[134:135], v165 offset:7808
    s_waitcnt lgkmcnt(10)
    v_mfma_f32_32x32x16_bf16 v[100:115], v[160:163], a[36:39], v[100:115]
    ds_read_b64_tr_b16 v[136:137], v165 offset:6304
    ds_read_b64_tr_b16 v[138:139], v165 offset:7840
    buffer_load_dwordx4 a[36:39], v4, s[20:23], s62 offen offset:1024 sc1
    s_waitcnt lgkmcnt(10)
    v_mfma_f32_32x32x16_bf16 v[20:35], v[116:119], a[40:43], v[20:35]
    ds_read_b64_tr_b16 v[140:141], v165 offset:9216
    ds_read_b64_tr_b16 v[142:143], v165 offset:10752
    s_waitcnt lgkmcnt(10)
    v_mfma_f32_32x32x16_bf16 v[36:51], v[120:123], a[40:43], v[36:51]
    ds_read_b64_tr_b16 v[144:145], v165 offset:9248
    ds_read_b64_tr_b16 v[146:147], v165 offset:10784
    s_waitcnt lgkmcnt(10)
    v_mfma_f32_32x32x16_bf16 v[52:67], v[124:127], a[40:43], v[52:67]
    ds_read_b64_tr_b16 v[148:149], v165 offset:9280
    ds_read_b64_tr_b16 v[150:151], v165 offset:10816
    s_waitcnt lgkmcnt(10)
    v_mfma_f32_32x32x16_bf16 v[68:83], v[128:131], a[40:43], v[68:83]
    ds_read_b64_tr_b16 v[152:153], v165 offset:9312
    ds_read_b64_tr_b16 v[154:155], v165 offset:10848
    s_waitcnt lgkmcnt(10)
    v_mfma_f32_32x32x16_bf16 v[84:99], v[132:135], a[40:43], v[84:99]
    ds_read_b64_tr_b16 v[156:157], v165 offset:9344
    ds_read_b64_tr_b16 v[158:159], v165 offset:10880
    s_waitcnt lgkmcnt(10)
    v_mfma_f32_32x32x16_bf16 v[100:115], v[136:139], a[40:43], v[100:115]
    ds_read_b64_tr_b16 v[160:161], v165 offset:9376
    ds_read_b64_tr_b16 v[162:163], v165 offset:10912
    buffer_load_dwordx4 a[40:43], v4, s[20:23], s62 offen offset:2048 sc1
    s_waitcnt lgkmcnt(10)
    v_mfma_f32_32x32x16_bf16 v[20:35], v[140:143], a[44:47], v[20:35]
    s_add_u32 s48, s48, 24640
    s_cmp_ge_u32 s48, 98560
    s_cselect_b32 s48, 0, s48
    v_add_u32 v166, s48, v164
    s_waitcnt vmcnt(11)
    s_barrier
    ds_read_b64_tr_b16 v[116:117], v166 offset:0
    ds_read_b64_tr_b16 v[118:119], v166 offset:1536
    s_waitcnt lgkmcnt(10)
    v_mfma_f32_32x32x16_bf16 v[36:51], v[144:147], a[44:47], v[36:51]
    ds_read_b64_tr_b16 v[120:121], v166 offset:32
    ds_read_b64_tr_b16 v[122:123], v166 offset:1568
    s_waitcnt lgkmcnt(10)
    v_mfma_f32_32x32x16_bf16 v[52:67], v[148:151], a[44:47], v[52:67]
    ds_read_b64_tr_b16 v[124:125], v166 offset:64
    ds_read_b64_tr_b16 v[126:127], v166 offset:1600
    s_waitcnt lgkmcnt(10)
    v_mfma_f32_32x32x16_bf16 v[68:83], v[152:155], a[44:47], v[68:83]
    ds_read_b64_tr_b16 v[128:129], v166 offset:96
    ds_read_b64_tr_b16 v[130:131], v166 offset:1632
    s_waitcnt lgkmcnt(10)
    v_mfma_f32_32x32x16_bf16 v[84:99], v[156:159], a[44:47], v[84:99]
    ds_read_b64_tr_b16 v[132:133], v166 offset:128
    ds_read_b64_tr_b16 v[134:135], v166 offset:1664
    s_waitcnt lgkmcnt(10)
    v_mfma_f32_32x32x16_bf16 v[100:115], v[160:163], a[44:47], v[100:115]
    ds_read_b64_tr_b16 v[136:137], v166 offset:160
    ds_read_b64_tr_b16 v[138:139], v166 offset:1696
    buffer_load_dwordx4 a[44:47], v4, s[20:23], s62 offen offset:3072 sc1
    s_waitcnt lgkmcnt(10)
    v_mfma_f32_32x32x16_bf16 v[20:35], v[116:119], a[48:51], v[20:35]
    ds_read_b64_tr_b16 v[140:141], v166 offset:3072
    ds_read_b64_tr_b16 v[142:143], v166 offset:4608
    s_waitcnt lgkmcnt(10)
    v_mfma_f32_32x32x16_bf16 v[36:51], v[120:123], a[48:51], v[36:51]
    ds_read_b64_tr_b16 v[144:145], v166 offset:3104
    ds_read_b64_tr_b16 v[146:147], v166 offset:4640
    s_waitcnt lgkmcnt(10)
    v_mfma_f32_32x32x16_bf16 v[52:67], v[124:127], a[48:51], v[52:67]
    ds_read_b64_tr_b16 v[148:149], v166 offset:3136
    ds_read_b64_tr_b16 v[150:151], v166 offset:4672
    s_waitcnt lgkmcnt(10)
    v_mfma_f32_32x32x16_bf16 v[68:83], v[128:131], a[48:51], v[68:83]
    ds_read_b64_tr_b16 v[152:153], v166 offset:3168
    ds_read_b64_tr_b16 v[154:155], v166 offset:4704
    s_waitcnt lgkmcnt(10)
    v_mfma_f32_32x32x16_bf16 v[84:99], v[132:135], a[48:51], v[84:99]
    ds_read_b64_tr_b16 v[156:157], v166 offset:3200
    ds_read_b64_tr_b16 v[158:159], v166 offset:4736
    s_waitcnt lgkmcnt(10)
    v_mfma_f32_32x32x16_bf16 v[100:115], v[136:139], a[48:51], v[100:115]
    ds_read_b64_tr_b16 v[160:161], v166 offset:3232
    ds_read_b64_tr_b16 v[162:163], v166 offset:4768
    s_mov_b32 s62, 28672
    buffer_load_dwordx4 a[48:51], v4, s[20:23], s62 offen offset:0 sc1
    s_waitcnt lgkmcnt(10)
    v_mfma_f32_32x32x16_bf16 v[20:35], v[140:143], a[52:55], v[20:35]
    ds_read_b64_tr_b16 v[116:117], v166 offset:6144
    ds_read_b64_tr_b16 v[118:119], v166 offset:7680
    s_waitcnt lgkmcnt(10)
    v_mfma_f32_32x32x16_bf16 v[36:51], v[144:147], a[52:55], v[36:51]
    ds_read_b64_tr_b16 v[120:121], v166 offset:6176
    ds_read_b64_tr_b16 v[122:123], v166 offset:7712
    s_waitcnt lgkmcnt(10)
    v_mfma_f32_32x32x16_bf16 v[52:67], v[148:151], a[52:55], v[52:67]
    ds_read_b64_tr_b16 v[124:125], v166 offset:6208
    ds_read_b64_tr_b16 v[126:127], v166 offset:7744
    s_waitcnt lgkmcnt(10)
    v_mfma_f32_32x32x16_bf16 v[68:83], v[152:155], a[52:55], v[68:83]
    ds_read_b64_tr_b16 v[128:129], v166 offset:6240
    ds_read_b64_tr_b16 v[130:131], v166 offset:7776
    s_waitcnt lgkmcnt(10)
    v_mfma_f32_32x32x16_bf16 v[84:99], v[156:159], a[52:55], v[84:99]
    ds_read_b64_tr_b16 v[132:133], v166 offset:6272
    ds_read_b64_tr_b16 v[134:135], v166 offset:7808
    s_waitcnt lgkmcnt(10)
    v_mfma_f32_32x32x16_bf16 v[100:115], v[160:163], a[52:55], v[100:115]
    ds_read_b64_tr_b16 v[136:137], v166 offset:6304
    ds_read_b64_tr_b16 v[138:139], v166 offset:7840
    buffer_load_dwordx4 a[52:55], v4, s[20:23], s62 offen offset:1024 sc1
    s_waitcnt lgkmcnt(10)
    v_mfma_f32_32x32x16_bf16 v[20:35], v[116:119], a[56:59], v[20:35]
    ds_read_b64_tr_b16 v[140:141], v166 offset:9216
    ds_read_b64_tr_b16 v[142:143], v166 offset:10752
    s_waitcnt lgkmcnt(10)
    v_mfma_f32_32x32x16_bf16 v[36:51], v[120:123], a[56:59], v[36:51]
    ds_read_b64_tr_b16 v[144:145], v166 offset:9248
    ds_read_b64_tr_b16 v[146:147], v166 offset:10784
    s_waitcnt lgkmcnt(10)
    v_mfma_f32_32x32x16_bf16 v[52:67], v[124:127], a[56:59], v[52:67]
    ds_read_b64_tr_b16 v[148:149], v166 offset:9280
    ds_read_b64_tr_b16 v[150:151], v166 offset:10816
    s_waitcnt lgkmcnt(10)
    v_mfma_f32_32x32x16_bf16 v[68:83], v[128:131], a[56:59], v[68:83]
    ds_read_b64_tr_b16 v[152:153], v166 offset:9312
    ds_read_b64_tr_b16 v[154:155], v166 offset:10848
    s_waitcnt lgkmcnt(10)
    v_mfma_f32_32x32x16_bf16 v[84:99], v[132:135], a[56:59], v[84:99]
    ds_read_b64_tr_b16 v[156:157], v166 offset:9344
    ds_read_b64_tr_b16 v[158:159], v166 offset:10880
    s_waitcnt lgkmcnt(10)
    v_mfma_f32_32x32x16_bf16 v[100:115], v[136:139], a[56:59], v[100:115]
    ds_read_b64_tr_b16 v[160:161], v166 offset:9376
    ds_read_b64_tr_b16 v[162:163], v166 offset:10912
    buffer_load_dwordx4 a[56:59], v4, s[20:23], s62 offen offset:2048 sc1
    s_waitcnt lgkmcnt(10)
    v_mfma_f32_32x32x16_bf16 v[20:35], v[140:143], a[60:63], v[20:35]
    s_add_u32 s48, s48, 24640
    s_cmp_ge_u32 s48, 98560
    s_cselect_b32 s48, 0, s48
    v_add_u32 v165, s48, v164
    s_waitcnt vmcnt(11)
    s_barrier
    ds_read_b64_tr_b16 v[116:117], v165 offset:0
    ds_read_b64_tr_b16 v[118:119], v165 offset:1536
    s_waitcnt lgkmcnt(10)
    v_mfma_f32_32x32x16_bf16 v[36:51], v[144:147], a[60:63], v[36:51]
    ds_read_b64_tr_b16 v[120:121], v165 offset:32
    ds_read_b64_tr_b16 v[122:123], v165 offset:1568
    s_waitcnt lgkmcnt(10)
    v_mfma_f32_32x32x16_bf16 v[52:67], v[148:151], a[60:63], v[52:67]
    ds_read_b64_tr_b16 v[124:125], v165 offset:64
    ds_read_b64_tr_b16 v[126:127], v165 offset:1600
    s_waitcnt lgkmcnt(10)
    v_mfma_f32_32x32x16_bf16 v[68:83], v[152:155], a[60:63], v[68:83]
    ds_read_b64_tr_b16 v[128:129], v165 offset:96
    ds_read_b64_tr_b16 v[130:131], v165 offset:1632
    s_waitcnt lgkmcnt(10)
    v_mfma_f32_32x32x16_bf16 v[84:99], v[156:159], a[60:63], v[84:99]
    ds_read_b64_tr_b16 v[132:133], v165 offset:128
    ds_read_b64_tr_b16 v[134:135], v165 offset:1664
    s_waitcnt lgkmcnt(10)
    v_mfma_f32_32x32x16_bf16 v[100:115], v[160:163], a[60:63], v[100:115]
    ds_read_b64_tr_b16 v[136:137], v165 offset:160
    ds_read_b64_tr_b16 v[138:139], v165 offset:1696
    buffer_load_dwordx4 a[60:63], v4, s[20:23], s62 offen offset:3072 sc1
    s_waitcnt lgkmcnt(10)
    v_mfma_f32_32x32x16_bf16 v[20:35], v[116:119], a[0:3], v[20:35]
    ds_read_b64_tr_b16 v[140:141], v165 offset:3072
    ds_read_b64_tr_b16 v[142:143], v165 offset:4608
    s_waitcnt lgkmcnt(10)
    v_mfma_f32_32x32x16_bf16 v[36:51], v[120:123], a[0:3], v[36:51]
    ds_read_b64_tr_b16 v[144:145], v165 offset:3104
    ds_read_b64_tr_b16 v[146:147], v165 offset:4640
    s_waitcnt lgkmcnt(10)
    v_mfma_f32_32x32x16_bf16 v[52:67], v[124:127], a[0:3], v[52:67]
    ds_read_b64_tr_b16 v[148:149], v165 offset:3136
    ds_read_b64_tr_b16 v[150:151], v165 offset:4672
    s_waitcnt lgkmcnt(10)
    v_mfma_f32_32x32x16_bf16 v[68:83], v[128:131], a[0:3], v[68:83]
    ds_read_b64_tr_b16 v[152:153], v165 offset:3168
    ds_read_b64_tr_b16 v[154:155], v165 offset:4704
    s_waitcnt lgkmcnt(10)
    v_mfma_f32_32x32x16_bf16 v[84:99], v[132:135], a[0:3], v[84:99]
    ds_read_b64_tr_b16 v[156:157], v165 offset:3200
    ds_read_b64_tr_b16 v[158:159], v165 offset:4736
    s_waitcnt lgkmcnt(10)
    v_mfma_f32_32x32x16_bf16 v[100:115], v[136:139], a[0:3], v[100:115]
    ds_read_b64_tr_b16 v[160:161], v165 offset:3232
    ds_read_b64_tr_b16 v[162:163], v165 offset:4768
    s_mov_b32 s62, 32768
    buffer_load_dwordx4 a[0:3], v4, s[20:23], s62 offen offset:0 sc1
    s_waitcnt lgkmcnt(10)
    v_mfma_f32_32x32x16_bf16 v[20:35], v[140:143], a[4:7], v[20:35]
    ds_read_b64_tr_b16 v[116:117], v165 offset:6144
    ds_read_b64_tr_b16 v[118:119], v165 offset:7680
    s_waitcnt lgkmcnt(10)
    v_mfma_f32_32x32x16_bf16 v[36:51], v[144:147], a[4:7], v[36:51]
    ds_read_b64_tr_b16 v[120:121], v165 offset:6176
    ds_read_b64_tr_b16 v[122:123], v165 offset:7712
    s_waitcnt lgkmcnt(10)
    v_mfma_f32_32x32x16_bf16 v[52:67], v[148:151], a[4:7], v[52:67]
    ds_read_b64_tr_b16 v[124:125], v165 offset:6208
    ds_read_b64_tr_b16 v[126:127], v165 offset:7744
    s_waitcnt lgkmcnt(10)
    v_mfma_f32_32x32x16_bf16 v[68:83], v[152:155], a[4:7], v[68:83]
    ds_read_b64_tr_b16 v[128:129], v165 offset:6240
    ds_read_b64_tr_b16 v[130:131], v165 offset:7776
    s_waitcnt lgkmcnt(10)
    v_mfma_f32_32x32x16_bf16 v[84:99], v[156:159], a[4:7], v[84:99]
    ds_read_b64_tr_b16 v[132:133], v165 offset:6272
    ds_read_b64_tr_b16 v[134:135], v165 offset:7808
    s_waitcnt lgkmcnt(10)
    v_mfma_f32_32x32x16_bf16 v[100:115], v[160:163], a[4:7], v[100:115]
    ds_read_b64_tr_b16 v[136:137], v165 offset:6304
    ds_read_b64_tr_b16 v[138:139], v165 offset:7840
    buffer_load_dwordx4 a[4:7], v4, s[20:23], s62 offen offset:1024 sc1
    s_waitcnt lgkmcnt(10)
    v_mfma_f32_32x32x16_bf16 v[20:35], v[116:119], a[8:11], v[20:35]
    ds_read_b64_tr_b16 v[140:141], v165 offset:9216
    ds_read_b64_tr_b16 v[142:143], v165 offset:10752
    s_waitcnt lgkmcnt(10)
    v_mfma_f32_32x32x16_bf16 v[36:51], v[120:123], a[8:11], v[36:51]
    ds_read_b64_tr_b16 v[144:145], v165 offset:9248
    ds_read_b64_tr_b16 v[146:147], v165 offset:10784
    s_waitcnt lgkmcnt(10)
    v_mfma_f32_32x32x16_bf16 v[52:67], v[124:127], a[8:11], v[52:67]
    ds_read_b64_tr_b16 v[148:149], v165 offset:9280
    ds_read_b64_tr_b16 v[150:151], v165 offset:10816
    s_waitcnt lgkmcnt(10)
    v_mfma_f32_32x32x16_bf16 v[68:83], v[128:131], a[8:11], v[68:83]
    ds_read_b64_tr_b16 v[152:153], v165 offset:9312
    ds_read_b64_tr_b16 v[154:155], v165 offset:10848
    s_waitcnt lgkmcnt(10)
    v_mfma_f32_32x32x16_bf16 v[84:99], v[132:135], a[8:11], v[84:99]
    ds_read_b64_tr_b16 v[156:157], v165 offset:9344
    ds_read_b64_tr_b16 v[158:159], v165 offset:10880
    s_waitcnt lgkmcnt(10)
    v_mfma_f32_32x32x16_bf16 v[100:115], v[136:139], a[8:11], v[100:115]
    ds_read_b64_tr_b16 v[160:161], v165 offset:9376
    ds_read_b64_tr_b16 v[162:163], v165 offset:10912
    buffer_load_dwordx4 a[8:11], v4, s[20:23], s62 offen offset:2048 sc1
    s_waitcnt lgkmcnt(10)
    v_mfma_f32_32x32x16_bf16 v[20:35], v[140:143], a[12:15], v[20:35]
    s_add_u32 s48, s48, 24640
    s_cmp_ge_u32 s48, 98560
    s_cselect_b32 s48, 0, s48
    v_add_u32 v166, s48, v164
    s_waitcnt vmcnt(11)
    s_barrier
    ds_read_b64_tr_b16 v[116:117], v166 offset:0
    ds_read_b64_tr_b16 v[118:119], v166 offset:1536
    s_waitcnt lgkmcnt(10)
    v_mfma_f32_32x32x16_bf16 v[36:51], v[144:147], a[12:15], v[36:51]
    ds_read_b64_tr_b16 v[120:121], v166 offset:32
    ds_read_b64_tr_b16 v[122:123], v166 offset:1568
    s_waitcnt lgkmcnt(10)
    v_mfma_f32_32x32x16_bf16 v[52:67], v[148:151], a[12:15], v[52:67]
    ds_read_b64_tr_b16 v[124:125], v166 offset:64
    ds_read_b64_tr_b16 v[126:127], v166 offset:1600
    s_waitcnt lgkmcnt(10)
    v_mfma_f32_32x32x16_bf16 v[68:83], v[152:155], a[12:15], v[68:83]
    ds_read_b64_tr_b16 v[128:129], v166 offset:96
    ds_read_b64_tr_b16 v[130:131], v166 offset:1632
    s_waitcnt lgkmcnt(10)
    v_mfma_f32_32x32x16_bf16 v[84:99], v[156:159], a[12:15], v[84:99]
    ds_read_b64_tr_b16 v[132:133], v166 offset:128
    ds_read_b64_tr_b16 v[134:135], v166 offset:1664
    s_waitcnt lgkmcnt(10)
    v_mfma_f32_32x32x16_bf16 v[100:115], v[160:163], a[12:15], v[100:115]
    ds_read_b64_tr_b16 v[136:137], v166 offset:160
    ds_read_b64_tr_b16 v[138:139], v166 offset:1696
    buffer_load_dwordx4 a[12:15], v4, s[20:23], s62 offen offset:3072 sc1
    s_waitcnt lgkmcnt(10)
    v_mfma_f32_32x32x16_bf16 v[20:35], v[116:119], a[16:19], v[20:35]
    ds_read_b64_tr_b16 v[140:141], v166 offset:3072
    ds_read_b64_tr_b16 v[142:143], v166 offset:4608
    s_waitcnt lgkmcnt(10)
    v_mfma_f32_32x32x16_bf16 v[36:51], v[120:123], a[16:19], v[36:51]
    ds_read_b64_tr_b16 v[144:145], v166 offset:3104
    ds_read_b64_tr_b16 v[146:147], v166 offset:4640
    s_waitcnt lgkmcnt(10)
    v_mfma_f32_32x32x16_bf16 v[52:67], v[124:127], a[16:19], v[52:67]
    ds_read_b64_tr_b16 v[148:149], v166 offset:3136
    ds_read_b64_tr_b16 v[150:151], v166 offset:4672
    s_waitcnt lgkmcnt(10)
    v_mfma_f32_32x32x16_bf16 v[68:83], v[128:131], a[16:19], v[68:83]
    ds_read_b64_tr_b16 v[152:153], v166 offset:3168
    ds_read_b64_tr_b16 v[154:155], v166 offset:4704
    s_waitcnt lgkmcnt(10)
    v_mfma_f32_32x32x16_bf16 v[84:99], v[132:135], a[16:19], v[84:99]
    ds_read_b64_tr_b16 v[156:157], v166 offset:3200
    ds_read_b64_tr_b16 v[158:159], v166 offset:4736
    s_waitcnt lgkmcnt(10)
    v_mfma_f32_32x32x16_bf16 v[100:115], v[136:139], a[16:19], v[100:115]
    ds_read_b64_tr_b16 v[160:161], v166 offset:3232
    ds_read_b64_tr_b16 v[162:163], v166 offset:4768
    s_mov_b32 s62, 36864
    buffer_load_dwordx4 a[16:19], v4, s[20:23], s62 offen offset:0 sc1
    s_waitcnt lgkmcnt(10)
    v_mfma_f32_32x32x16_bf16 v[20:35], v[140:143], a[20:23], v[20:35]
    ds_read_b64_tr_b16 v[116:117], v166 offset:6144
    ds_read_b64_tr_b16 v[118:119], v166 offset:7680
    s_waitcnt lgkmcnt(10)
    v_mfma_f32_32x32x16_bf16 v[36:51], v[144:147], a[20:23], v[36:51]
    ds_read_b64_tr_b16 v[120:121], v166 offset:6176
    ds_read_b64_tr_b16 v[122:123], v166 offset:7712
    s_waitcnt lgkmcnt(10)
    v_mfma_f32_32x32x16_bf16 v[52:67], v[148:151], a[20:23], v[52:67]
    ds_read_b64_tr_b16 v[124:125], v166 offset:6208
    ds_read_b64_tr_b16 v[126:127], v166 offset:7744
    s_waitcnt lgkmcnt(10)
    v_mfma_f32_32x32x16_bf16 v[68:83], v[152:155], a[20:23], v[68:83]
    ds_read_b64_tr_b16 v[128:129], v166 offset:6240
    ds_read_b64_tr_b16 v[130:131], v166 offset:7776
    s_waitcnt lgkmcnt(10)
    v_mfma_f32_32x32x16_bf16 v[84:99], v[156:159], a[20:23], v[84:99]
    ds_read_b64_tr_b16 v[132:133], v166 offset:6272
    ds_read_b64_tr_b16 v[134:135], v166 offset:7808
    s_waitcnt lgkmcnt(10)
    v_mfma_f32_32x32x16_bf16 v[100:115], v[160:163], a[20:23], v[100:115]
    ds_read_b64_tr_b16 v[136:137], v166 offset:6304
    ds_read_b64_tr_b16 v[138:139], v166 offset:7840
    buffer_load_dwordx4 a[20:23], v4, s[20:23], s62 offen offset:1024 sc1
    s_waitcnt lgkmcnt(10)
    v_mfma_f32_32x32x16_bf16 v[20:35], v[116:119], a[24:27], v[20:35]
    ds_read_b64_tr_b16 v[140:141], v166 offset:9216
    ds_read_b64_tr_b16 v[142:143], v166 offset:10752
    s_waitcnt lgkmcnt(10)
    v_mfma_f32_32x32x16_bf16 v[36:51], v[120:123], a[24:27], v[36:51]
    ds_read_b64_tr_b16 v[144:145], v166 offset:9248
    ds_read_b64_tr_b16 v[146:147], v166 offset:10784
    s_waitcnt lgkmcnt(10)
    v_mfma_f32_32x32x16_bf16 v[52:67], v[124:127], a[24:27], v[52:67]
    ds_read_b64_tr_b16 v[148:149], v166 offset:9280
    ds_read_b64_tr_b16 v[150:151], v166 offset:10816
    s_waitcnt lgkmcnt(10)
    v_mfma_f32_32x32x16_bf16 v[68:83], v[128:131], a[24:27], v[68:83]
    ds_read_b64_tr_b16 v[152:153], v166 offset:9312
    ds_read_b64_tr_b16 v[154:155], v166 offset:10848
    s_waitcnt lgkmcnt(10)
    v_mfma_f32_32x32x16_bf16 v[84:99], v[132:135], a[24:27], v[84:99]
    ds_read_b64_tr_b16 v[156:157], v166 offset:9344
    ds_read_b64_tr_b16 v[158:159], v166 offset:10880
    s_waitcnt lgkmcnt(10)
    v_mfma_f32_32x32x16_bf16 v[100:115], v[136:139], a[24:27], v[100:115]
    ds_read_b64_tr_b16 v[160:161], v166 offset:9376
    ds_read_b64_tr_b16 v[162:163], v166 offset:10912
    buffer_load_dwordx4 a[24:27], v4, s[20:23], s62 offen offset:2048 sc1
    s_waitcnt lgkmcnt(10)
    v_mfma_f32_32x32x16_bf16 v[20:35], v[140:143], a[28:31], v[20:35]
    s_add_u32 s48, s48, 24640
    s_cmp_ge_u32 s48, 98560
    s_cselect_b32 s48, 0, s48
    v_add_u32 v165, s48, v164
    s_waitcnt vmcnt(11)
    s_barrier
    ds_read_b64_tr_b16 v[116:117], v165 offset:0
    ds_read_b64_tr_b16 v[118:119], v165 offset:1536
    s_waitcnt lgkmcnt(10)
    v_mfma_f32_32x32x16_bf16 v[36:51], v[144:147], a[28:31], v[36:51]
    ds_read_b64_tr_b16 v[120:121], v165 offset:32
    ds_read_b64_tr_b16 v[122:123], v165 offset:1568
    s_waitcnt lgkmcnt(10)
    v_mfma_f32_32x32x16_bf16 v[52:67], v[148:151], a[28:31], v[52:67]
    ds_read_b64_tr_b16 v[124:125], v165 offset:64
    ds_read_b64_tr_b16 v[126:127], v165 offset:1600
    s_waitcnt lgkmcnt(10)
    v_mfma_f32_32x32x16_bf16 v[68:83], v[152:155], a[28:31], v[68:83]
    ds_read_b64_tr_b16 v[128:129], v165 offset:96
    ds_read_b64_tr_b16 v[130:131], v165 offset:1632
    s_waitcnt lgkmcnt(10)
    v_mfma_f32_32x32x16_bf16 v[84:99], v[156:159], a[28:31], v[84:99]
    ds_read_b64_tr_b16 v[132:133], v165 offset:128
    ds_read_b64_tr_b16 v[134:135], v165 offset:1664
    s_waitcnt lgkmcnt(10)
    v_mfma_f32_32x32x16_bf16 v[100:115], v[160:163], a[28:31], v[100:115]
    ds_read_b64_tr_b16 v[136:137], v165 offset:160
    ds_read_b64_tr_b16 v[138:139], v165 offset:1696
    buffer_load_dwordx4 a[28:31], v4, s[20:23], s62 offen offset:3072 sc1
    s_waitcnt lgkmcnt(10)
    v_mfma_f32_32x32x16_bf16 v[20:35], v[116:119], a[32:35], v[20:35]
    ds_read_b64_tr_b16 v[140:141], v165 offset:3072
    ds_read_b64_tr_b16 v[142:143], v165 offset:4608
    s_waitcnt lgkmcnt(10)
    v_mfma_f32_32x32x16_bf16 v[36:51], v[120:123], a[32:35], v[36:51]
    ds_read_b64_tr_b16 v[144:145], v165 offset:3104
    ds_read_b64_tr_b16 v[146:147], v165 offset:4640
    s_waitcnt lgkmcnt(10)
    v_mfma_f32_32x32x16_bf16 v[52:67], v[124:127], a[32:35], v[52:67]
    ds_read_b64_tr_b16 v[148:149], v165 offset:3136
    ds_read_b64_tr_b16 v[150:151], v165 offset:4672
    s_waitcnt lgkmcnt(10)
    v_mfma_f32_32x32x16_bf16 v[68:83], v[128:131], a[32:35], v[68:83]
    ds_read_b64_tr_b16 v[152:153], v165 offset:3168
    ds_read_b64_tr_b16 v[154:155], v165 offset:4704
    s_waitcnt lgkmcnt(10)
    v_mfma_f32_32x32x16_bf16 v[84:99], v[132:135], a[32:35], v[84:99]
    ds_read_b64_tr_b16 v[156:157], v165 offset:3200
    ds_read_b64_tr_b16 v[158:159], v165 offset:4736
    s_waitcnt lgkmcnt(10)
    v_mfma_f32_32x32x16_bf16 v[100:115], v[136:139], a[32:35], v[100:115]
    ds_read_b64_tr_b16 v[160:161], v165 offset:3232
    ds_read_b64_tr_b16 v[162:163], v165 offset:4768
    s_waitcnt lgkmcnt(10)
    v_mfma_f32_32x32x16_bf16 v[20:35], v[140:143], a[36:39], v[20:35]
    ds_read_b64_tr_b16 v[116:117], v165 offset:6144
    ds_read_b64_tr_b16 v[118:119], v165 offset:7680
    s_waitcnt lgkmcnt(10)
    v_mfma_f32_32x32x16_bf16 v[36:51], v[144:147], a[36:39], v[36:51]
    ds_read_b64_tr_b16 v[120:121], v165 offset:6176
    ds_read_b64_tr_b16 v[122:123], v165 offset:7712
    s_waitcnt lgkmcnt(10)
    v_mfma_f32_32x32x16_bf16 v[52:67], v[148:151], a[36:39], v[52:67]
    ds_read_b64_tr_b16 v[124:125], v165 offset:6208
    ds_read_b64_tr_b16 v[126:127], v165 offset:7744
    s_waitcnt lgkmcnt(10)
    v_mfma_f32_32x32x16_bf16 v[68:83], v[152:155], a[36:39], v[68:83]
    ds_read_b64_tr_b16 v[128:129], v165 offset:6240
    ds_read_b64_tr_b16 v[130:131], v165 offset:7776
    s_waitcnt lgkmcnt(10)
    v_mfma_f32_32x32x16_bf16 v[84:99], v[156:159], a[36:39], v[84:99]
    ds_read_b64_tr_b16 v[132:133], v165 offset:6272
    ds_read_b64_tr_b16 v[134:135], v165 offset:7808
    s_waitcnt lgkmcnt(10)
    v_mfma_f32_32x32x16_bf16 v[100:115], v[160:163], a[36:39], v[100:115]
    ds_read_b64_tr_b16 v[136:137], v165 offset:6304
    ds_read_b64_tr_b16 v[138:139], v165 offset:7840
    s_waitcnt lgkmcnt(10)
    v_mfma_f32_32x32x16_bf16 v[20:35], v[116:119], a[40:43], v[20:35]
    ds_read_b64_tr_b16 v[140:141], v165 offset:9216
    ds_read_b64_tr_b16 v[142:143], v165 offset:10752
    s_waitcnt lgkmcnt(10)
    v_mfma_f32_32x32x16_bf16 v[36:51], v[120:123], a[40:43], v[36:51]
    ds_read_b64_tr_b16 v[144:145], v165 offset:9248
    ds_read_b64_tr_b16 v[146:147], v165 offset:10784
    s_waitcnt lgkmcnt(10)
    v_mfma_f32_32x32x16_bf16 v[52:67], v[124:127], a[40:43], v[52:67]
    ds_read_b64_tr_b16 v[148:149], v165 offset:9280
    ds_read_b64_tr_b16 v[150:151], v165 offset:10816
    s_waitcnt lgkmcnt(10)
    v_mfma_f32_32x32x16_bf16 v[68:83], v[128:131], a[40:43], v[68:83]
    ds_read_b64_tr_b16 v[152:153], v165 offset:9312
    ds_read_b64_tr_b16 v[154:155], v165 offset:10848
    s_waitcnt lgkmcnt(10)
    v_mfma_f32_32x32x16_bf16 v[84:99], v[132:135], a[40:43], v[84:99]
    ds_read_b64_tr_b16 v[156:157], v165 offset:9344
    ds_read_b64_tr_b16 v[158:159], v165 offset:10880
    s_waitcnt lgkmcnt(10)
    v_mfma_f32_32x32x16_bf16 v[100:115], v[136:139], a[40:43], v[100:115]
    ds_read_b64_tr_b16 v[160:161], v165 offset:9376
    ds_read_b64_tr_b16 v[162:163], v165 offset:10912
    s_waitcnt lgkmcnt(10)
    v_mfma_f32_32x32x16_bf16 v[20:35], v[140:143], a[44:47], v[20:35]
    s_add_u32 s48, s48, 24640
    s_cmp_ge_u32 s48, 98560
    s_cselect_b32 s48, 0, s48
    v_add_u32 v166, s48, v164
    s_waitcnt vmcnt(8)
    s_barrier
    ds_read_b64_tr_b16 v[116:117], v166 offset:0
    ds_read_b64_tr_b16 v[118:119], v166 offset:1536
    s_waitcnt lgkmcnt(10)
    v_mfma_f32_32x32x16_bf16 v[36:51], v[144:147], a[44:47], v[36:51]
    ds_read_b64_tr_b16 v[120:121], v166 offset:32
    ds_read_b64_tr_b16 v[122:123], v166 offset:1568
    s_waitcnt lgkmcnt(10)
    v_mfma_f32_32x32x16_bf16 v[52:67], v[148:151], a[44:47], v[52:67]
    ds_read_b64_tr_b16 v[124:125], v166 offset:64
    ds_read_b64_tr_b16 v[126:127], v166 offset:1600
    s_waitcnt lgkmcnt(10)
    v_mfma_f32_32x32x16_bf16 v[68:83], v[152:155], a[44:47], v[68:83]
    ds_read_b64_tr_b16 v[128:129], v166 offset:96
    ds_read_b64_tr_b16 v[130:131], v166 offset:1632
    s_waitcnt lgkmcnt(10)
    v_mfma_f32_32x32x16_bf16 v[84:99], v[156:159], a[44:47], v[84:99]
    ds_read_b64_tr_b16 v[132:133], v166 offset:128
    ds_read_b64_tr_b16 v[134:135], v166 offset:1664
    s_waitcnt lgkmcnt(10)
    v_mfma_f32_32x32x16_bf16 v[100:115], v[160:163], a[44:47], v[100:115]
    ds_read_b64_tr_b16 v[136:137], v166 offset:160
    ds_read_b64_tr_b16 v[138:139], v166 offset:1696
    s_waitcnt lgkmcnt(10)
    v_mfma_f32_32x32x16_bf16 v[20:35], v[116:119], a[48:51], v[20:35]
    ds_read_b64_tr_b16 v[140:141], v166 offset:3072
    ds_read_b64_tr_b16 v[142:143], v166 offset:4608
    s_waitcnt lgkmcnt(10)
    v_mfma_f32_32x32x16_bf16 v[36:51], v[120:123], a[48:51], v[36:51]
    ds_read_b64_tr_b16 v[144:145], v166 offset:3104
    ds_read_b64_tr_b16 v[146:147], v166 offset:4640
    s_waitcnt lgkmcnt(10)
    v_mfma_f32_32x32x16_bf16 v[52:67], v[124:127], a[48:51], v[52:67]
    ds_read_b64_tr_b16 v[148:149], v166 offset:3136
    ds_read_b64_tr_b16 v[150:151], v166 offset:4672
    s_waitcnt lgkmcnt(10)
    v_mfma_f32_32x32x16_bf16 v[68:83], v[128:131], a[48:51], v[68:83]
    ds_read_b64_tr_b16 v[152:153], v166 offset:3168
    ds_read_b64_tr_b16 v[154:155], v166 offset:4704
    s_waitcnt lgkmcnt(10)
    v_mfma_f32_32x32x16_bf16 v[84:99], v[132:135], a[48:51], v[84:99]
    ds_read_b64_tr_b16 v[156:157], v166 offset:3200
    ds_read_b64_tr_b16 v[158:159], v166 offset:4736
    s_waitcnt lgkmcnt(10)
    v_mfma_f32_32x32x16_bf16 v[100:115], v[136:139], a[48:51], v[100:115]
    ds_read_b64_tr_b16 v[160:161], v166 offset:3232
    ds_read_b64_tr_b16 v[162:163], v166 offset:4768
    s_waitcnt lgkmcnt(10)
    v_mfma_f32_32x32x16_bf16 v[20:35], v[140:143], a[52:55], v[20:35]
    ds_read_b64_tr_b16 v[116:117], v166 offset:6144
    ds_read_b64_tr_b16 v[118:119], v166 offset:7680
    s_waitcnt lgkmcnt(10)
    v_mfma_f32_32x32x16_bf16 v[36:51], v[144:147], a[52:55], v[36:51]
    ds_read_b64_tr_b16 v[120:121], v166 offset:6176
    ds_read_b64_tr_b16 v[122:123], v166 offset:7712
    s_waitcnt lgkmcnt(10)
    v_mfma_f32_32x32x16_bf16 v[52:67], v[148:151], a[52:55], v[52:67]
    ds_read_b64_tr_b16 v[124:125], v166 offset:6208
    ds_read_b64_tr_b16 v[126:127], v166 offset:7744
    s_waitcnt lgkmcnt(10)
    v_mfma_f32_32x32x16_bf16 v[68:83], v[152:155], a[52:55], v[68:83]
    ds_read_b64_tr_b16 v[128:129], v166 offset:6240
    ds_read_b64_tr_b16 v[130:131], v166 offset:7776
    s_waitcnt lgkmcnt(10)
    v_mfma_f32_32x32x16_bf16 v[84:99], v[156:159], a[52:55], v[84:99]
    ds_read_b64_tr_b16 v[132:133], v166 offset:6272
    ds_read_b64_tr_b16 v[134:135], v166 offset:7808
    s_waitcnt lgkmcnt(10)
    v_mfma_f32_32x32x16_bf16 v[100:115], v[160:163], a[52:55], v[100:115]
    ds_read_b64_tr_b16 v[136:137], v166 offset:6304
    ds_read_b64_tr_b16 v[138:139], v166 offset:7840
    s_waitcnt lgkmcnt(10)
    v_mfma_f32_32x32x16_bf16 v[20:35], v[116:119], a[56:59], v[20:35]
    ds_read_b64_tr_b16 v[140:141], v166 offset:9216
    ds_read_b64_tr_b16 v[142:143], v166 offset:10752
    s_waitcnt lgkmcnt(10)
    v_mfma_f32_32x32x16_bf16 v[36:51], v[120:123], a[56:59], v[36:51]
    ds_read_b64_tr_b16 v[144:145], v166 offset:9248
    ds_read_b64_tr_b16 v[146:147], v166 offset:10784
    s_waitcnt lgkmcnt(10)
    v_mfma_f32_32x32x16_bf16 v[52:67], v[124:127], a[56:59], v[52:67]
    ds_read_b64_tr_b16 v[148:149], v166 offset:9280
    ds_read_b64_tr_b16 v[150:151], v166 offset:10816
    s_waitcnt lgkmcnt(10)
    v_mfma_f32_32x32x16_bf16 v[68:83], v[128:131], a[56:59], v[68:83]
    ds_read_b64_tr_b16 v[152:153], v166 offset:9312
    ds_read_b64_tr_b16 v[154:155], v166 offset:10848
    s_waitcnt lgkmcnt(10)
    v_mfma_f32_32x32x16_bf16 v[84:99], v[132:135], a[56:59], v[84:99]
    ds_read_b64_tr_b16 v[156:157], v166 offset:9344
    ds_read_b64_tr_b16 v[158:159], v166 offset:10880
    s_waitcnt lgkmcnt(10)
    v_mfma_f32_32x32x16_bf16 v[100:115], v[136:139], a[56:59], v[100:115]
    ds_read_b64_tr_b16 v[160:161], v166 offset:9376
    ds_read_b64_tr_b16 v[162:163], v166 offset:10912
    s_waitcnt lgkmcnt(10)
    v_mfma_f32_32x32x16_bf16 v[20:35], v[140:143], a[60:63], v[20:35]
    s_add_u32 s48, s48, 24640
    s_cmp_ge_u32 s48, 98560
    s_cselect_b32 s48, 0, s48
    v_add_u32 v165, s48, v164
    s_waitcnt vmcnt(4)
    s_barrier
    ds_read_b64_tr_b16 v[116:117], v165 offset:0
    ds_read_b64_tr_b16 v[118:119], v165 offset:1536
    s_waitcnt lgkmcnt(10)
    v_mfma_f32_32x32x16_bf16 v[36:51], v[144:147], a[60:63], v[36:51]
    ds_read_b64_tr_b16 v[120:121], v165 offset:32
    ds_read_b64_tr_b16 v[122:123], v165 offset:1568
    s_waitcnt lgkmcnt(10)
    v_mfma_f32_32x32x16_bf16 v[52:67], v[148:151], a[60:63], v[52:67]
    ds_read_b64_tr_b16 v[124:125], v165 offset:64
    ds_read_b64_tr_b16 v[126:127], v165 offset:1600
    s_waitcnt lgkmcnt(10)
    v_mfma_f32_32x32x16_bf16 v[68:83], v[152:155], a[60:63], v[68:83]
    ds_read_b64_tr_b16 v[128:129], v165 offset:96
    ds_read_b64_tr_b16 v[130:131], v165 offset:1632
    s_waitcnt lgkmcnt(10)
    v_mfma_f32_32x32x16_bf16 v[84:99], v[156:159], a[60:63], v[84:99]
    ds_read_b64_tr_b16 v[132:133], v165 offset:128
    ds_read_b64_tr_b16 v[134:135], v165 offset:1664
    s_waitcnt lgkmcnt(10)
    v_mfma_f32_32x32x16_bf16 v[100:115], v[160:163], a[60:63], v[100:115]
    ds_read_b64_tr_b16 v[136:137], v165 offset:160
    ds_read_b64_tr_b16 v[138:139], v165 offset:1696
    s_waitcnt lgkmcnt(10)
    v_mfma_f32_32x32x16_bf16 v[20:35], v[116:119], a[0:3], v[20:35]
    ds_read_b64_tr_b16 v[140:141], v165 offset:3072
    ds_read_b64_tr_b16 v[142:143], v165 offset:4608
    s_waitcnt lgkmcnt(10)
    v_mfma_f32_32x32x16_bf16 v[36:51], v[120:123], a[0:3], v[36:51]
    ds_read_b64_tr_b16 v[144:145], v165 offset:3104
    ds_read_b64_tr_b16 v[146:147], v165 offset:4640
    s_waitcnt lgkmcnt(10)
    v_mfma_f32_32x32x16_bf16 v[52:67], v[124:127], a[0:3], v[52:67]
    ds_read_b64_tr_b16 v[148:149], v165 offset:3136
    ds_read_b64_tr_b16 v[150:151], v165 offset:4672
    s_waitcnt lgkmcnt(10)
    v_mfma_f32_32x32x16_bf16 v[68:83], v[128:131], a[0:3], v[68:83]
    ds_read_b64_tr_b16 v[152:153], v165 offset:3168
    ds_read_b64_tr_b16 v[154:155], v165 offset:4704
    s_waitcnt lgkmcnt(10)
    v_mfma_f32_32x32x16_bf16 v[84:99], v[132:135], a[0:3], v[84:99]
    ds_read_b64_tr_b16 v[156:157], v165 offset:3200
    ds_read_b64_tr_b16 v[158:159], v165 offset:4736
    s_waitcnt lgkmcnt(10)
    v_mfma_f32_32x32x16_bf16 v[100:115], v[136:139], a[0:3], v[100:115]
    ds_read_b64_tr_b16 v[160:161], v165 offset:3232
    ds_read_b64_tr_b16 v[162:163], v165 offset:4768
    s_waitcnt lgkmcnt(10)
    v_mfma_f32_32x32x16_bf16 v[20:35], v[140:143], a[4:7], v[20:35]
    ds_read_b64_tr_b16 v[116:117], v165 offset:6144
    ds_read_b64_tr_b16 v[118:119], v165 offset:7680
    s_waitcnt lgkmcnt(10)
    v_mfma_f32_32x32x16_bf16 v[36:51], v[144:147], a[4:7], v[36:51]
    ds_read_b64_tr_b16 v[120:121], v165 offset:6176
    ds_read_b64_tr_b16 v[122:123], v165 offset:7712
    s_waitcnt lgkmcnt(10)
    v_mfma_f32_32x32x16_bf16 v[52:67], v[148:151], a[4:7], v[52:67]
    ds_read_b64_tr_b16 v[124:125], v165 offset:6208
    ds_read_b64_tr_b16 v[126:127], v165 offset:7744
    s_waitcnt lgkmcnt(10)
    v_mfma_f32_32x32x16_bf16 v[68:83], v[152:155], a[4:7], v[68:83]
    ds_read_b64_tr_b16 v[128:129], v165 offset:6240
    ds_read_b64_tr_b16 v[130:131], v165 offset:7776
    s_waitcnt lgkmcnt(10)
    v_mfma_f32_32x32x16_bf16 v[84:99], v[156:159], a[4:7], v[84:99]
    ds_read_b64_tr_b16 v[132:133], v165 offset:6272
    ds_read_b64_tr_b16 v[134:135], v165 offset:7808
    s_waitcnt lgkmcnt(10)
    v_mfma_f32_32x32x16_bf16 v[100:115], v[160:163], a[4:7], v[100:115]
    ds_read_b64_tr_b16 v[136:137], v165 offset:6304
    ds_read_b64_tr_b16 v[138:139], v165 offset:7840
    s_waitcnt lgkmcnt(10)
    v_mfma_f32_32x32x16_bf16 v[20:35], v[116:119], a[8:11], v[20:35]
    ds_read_b64_tr_b16 v[140:141], v165 offset:9216
    ds_read_b64_tr_b16 v[142:143], v165 offset:10752
    s_waitcnt lgkmcnt(10)
    v_mfma_f32_32x32x16_bf16 v[36:51], v[120:123], a[8:11], v[36:51]
    ds_read_b64_tr_b16 v[144:145], v165 offset:9248
    ds_read_b64_tr_b16 v[146:147], v165 offset:10784
    s_waitcnt lgkmcnt(10)
    v_mfma_f32_32x32x16_bf16 v[52:67], v[124:127], a[8:11], v[52:67]
    ds_read_b64_tr_b16 v[148:149], v165 offset:9280
    ds_read_b64_tr_b16 v[150:151], v165 offset:10816
    s_waitcnt lgkmcnt(10)
    v_mfma_f32_32x32x16_bf16 v[68:83], v[128:131], a[8:11], v[68:83]
    ds_read_b64_tr_b16 v[152:153], v165 offset:9312
    ds_read_b64_tr_b16 v[154:155], v165 offset:10848
    s_waitcnt lgkmcnt(10)
    v_mfma_f32_32x32x16_bf16 v[84:99], v[132:135], a[8:11], v[84:99]
    ds_read_b64_tr_b16 v[156:157], v165 offset:9344
    ds_read_b64_tr_b16 v[158:159], v165 offset:10880
    s_waitcnt lgkmcnt(10)
    v_mfma_f32_32x32x16_bf16 v[100:115], v[136:139], a[8:11], v[100:115]
    ds_read_b64_tr_b16 v[160:161], v165 offset:9376
    ds_read_b64_tr_b16 v[162:163], v165 offset:10912
    s_waitcnt lgkmcnt(10)
    v_mfma_f32_32x32x16_bf16 v[20:35], v[140:143], a[12:15], v[20:35]
    s_add_u32 s48, s48, 24640
    s_cmp_ge_u32 s48, 98560
    s_cselect_b32 s48, 0, s48
    v_add_u32 v166, s48, v164
    s_waitcnt vmcnt(0)
    s_barrier
    ds_read_b64_tr_b16 v[116:117], v166 offset:0
    ds_read_b64_tr_b16 v[118:119], v166 offset:1536
    s_waitcnt lgkmcnt(10)
    v_mfma_f32_32x32x16_bf16 v[36:51], v[144:147], a[12:15], v[36:51]
    ds_read_b64_tr_b16 v[120:121], v166 offset:32
    ds_read_b64_tr_b16 v[122:123], v166 offset:1568
    s_waitcnt lgkmcnt(10)
    v_mfma_f32_32x32x16_bf16 v[52:67], v[148:151], a[12:15], v[52:67]
    ds_read_b64_tr_b16 v[124:125], v166 offset:64
    ds_read_b64_tr_b16 v[126:127], v166 offset:1600
    s_waitcnt lgkmcnt(10)
    v_mfma_f32_32x32x16_bf16 v[68:83], v[152:155], a[12:15], v[68:83]
    ds_read_b64_tr_b16 v[128:129], v166 offset:96
    ds_read_b64_tr_b16 v[130:131], v166 offset:1632
    s_waitcnt lgkmcnt(10)
    v_mfma_f32_32x32x16_bf16 v[84:99], v[156:159], a[12:15], v[84:99]
    ds_read_b64_tr_b16 v[132:133], v166 offset:128
    ds_read_b64_tr_b16 v[134:135], v166 offset:1664
    s_waitcnt lgkmcnt(10)
    v_mfma_f32_32x32x16_bf16 v[100:115], v[160:163], a[12:15], v[100:115]
    ds_read_b64_tr_b16 v[136:137], v166 offset:160
    ds_read_b64_tr_b16 v[138:139], v166 offset:1696
    s_waitcnt lgkmcnt(10)
    v_mfma_f32_32x32x16_bf16 v[20:35], v[116:119], a[16:19], v[20:35]
    ds_read_b64_tr_b16 v[140:141], v166 offset:3072
    ds_read_b64_tr_b16 v[142:143], v166 offset:4608
    s_waitcnt lgkmcnt(10)
    v_mfma_f32_32x32x16_bf16 v[36:51], v[120:123], a[16:19], v[36:51]
    ds_read_b64_tr_b16 v[144:145], v166 offset:3104
    ds_read_b64_tr_b16 v[146:147], v166 offset:4640
    s_waitcnt lgkmcnt(10)
    v_mfma_f32_32x32x16_bf16 v[52:67], v[124:127], a[16:19], v[52:67]
    ds_read_b64_tr_b16 v[148:149], v166 offset:3136
    ds_read_b64_tr_b16 v[150:151], v166 offset:4672
    s_waitcnt lgkmcnt(10)
    v_mfma_f32_32x32x16_bf16 v[68:83], v[128:131], a[16:19], v[68:83]
    ds_read_b64_tr_b16 v[152:153], v166 offset:3168
    ds_read_b64_tr_b16 v[154:155], v166 offset:4704
    s_waitcnt lgkmcnt(10)
    v_mfma_f32_32x32x16_bf16 v[84:99], v[132:135], a[16:19], v[84:99]
    ds_read_b64_tr_b16 v[156:157], v166 offset:3200
    ds_read_b64_tr_b16 v[158:159], v166 offset:4736
    s_waitcnt lgkmcnt(10)
    v_mfma_f32_32x32x16_bf16 v[100:115], v[136:139], a[16:19], v[100:115]
    ds_read_b64_tr_b16 v[160:161], v166 offset:3232
    ds_read_b64_tr_b16 v[162:163], v166 offset:4768
    s_waitcnt lgkmcnt(10)
    v_mfma_f32_32x32x16_bf16 v[20:35], v[140:143], a[20:23], v[20:35]
    ds_read_b64_tr_b16 v[116:117], v166 offset:6144
    ds_read_b64_tr_b16 v[118:119], v166 offset:7680
    s_waitcnt lgkmcnt(10)
    v_mfma_f32_32x32x16_bf16 v[36:51], v[144:147], a[20:23], v[36:51]
    ds_read_b64_tr_b16 v[120:121], v166 offset:6176
    ds_read_b64_tr_b16 v[122:123], v166 offset:7712
    s_waitcnt lgkmcnt(10)
    v_mfma_f32_32x32x16_bf16 v[52:67], v[148:151], a[20:23], v[52:67]
    ds_read_b64_tr_b16 v[124:125], v166 offset:6208
    ds_read_b64_tr_b16 v[126:127], v166 offset:7744
    s_waitcnt lgkmcnt(10)
    v_mfma_f32_32x32x16_bf16 v[68:83], v[152:155], a[20:23], v[68:83]
    ds_read_b64_tr_b16 v[128:129], v166 offset:6240
    ds_read_b64_tr_b16 v[130:131], v166 offset:7776
    s_waitcnt lgkmcnt(10)
    v_mfma_f32_32x32x16_bf16 v[84:99], v[156:159], a[20:23], v[84:99]
    ds_read_b64_tr_b16 v[132:133], v166 offset:6272
    ds_read_b64_tr_b16 v[134:135], v166 offset:7808
    s_waitcnt lgkmcnt(10)
    v_mfma_f32_32x32x16_bf16 v[100:115], v[160:163], a[20:23], v[100:115]
    ds_read_b64_tr_b16 v[136:137], v166 offset:6304
    ds_read_b64_tr_b16 v[138:139], v166 offset:7840
    s_waitcnt lgkmcnt(10)
    v_mfma_f32_32x32x16_bf16 v[20:35], v[116:119], a[24:27], v[20:35]
    ds_read_b64_tr_b16 v[140:141], v166 offset:9216
    ds_read_b64_tr_b16 v[142:143], v166 offset:10752
    s_waitcnt lgkmcnt(10)
    v_mfma_f32_32x32x16_bf16 v[36:51], v[120:123], a[24:27], v[36:51]
    ds_read_b64_tr_b16 v[144:145], v166 offset:9248
    ds_read_b64_tr_b16 v[146:147], v166 offset:10784
    s_waitcnt lgkmcnt(10)
    v_mfma_f32_32x32x16_bf16 v[52:67], v[124:127], a[24:27], v[52:67]
    ds_read_b64_tr_b16 v[148:149], v166 offset:9280
    ds_read_b64_tr_b16 v[150:151], v166 offset:10816
    s_waitcnt lgkmcnt(10)
    v_mfma_f32_32x32x16_bf16 v[68:83], v[128:131], a[24:27], v[68:83]
    ds_read_b64_tr_b16 v[152:153], v166 offset:9312
    ds_read_b64_tr_b16 v[154:155], v166 offset:10848
    s_waitcnt lgkmcnt(10)
    v_mfma_f32_32x32x16_bf16 v[84:99], v[132:135], a[24:27], v[84:99]
    ds_read_b64_tr_b16 v[156:157], v166 offset:9344
    ds_read_b64_tr_b16 v[158:159], v166 offset:10880
    s_waitcnt lgkmcnt(10)
    v_mfma_f32_32x32x16_bf16 v[100:115], v[136:139], a[24:27], v[100:115]
    ds_read_b64_tr_b16 v[160:161], v166 offset:9376
    ds_read_b64_tr_b16 v[162:163], v166 offset:10912
    s_waitcnt lgkmcnt(10)
    v_mfma_f32_32x32x16_bf16 v[20:35], v[140:143], a[28:31], v[20:35]
    s_waitcnt lgkmcnt(8)
    v_mfma_f32_32x32x16_bf16 v[36:51], v[144:147], a[28:31], v[36:51]
    s_waitcnt lgkmcnt(6)
    v_mfma_f32_32x32x16_bf16 v[52:67], v[148:151], a[28:31], v[52:67]
    s_waitcnt lgkmcnt(4)
    v_mfma_f32_32x32x16_bf16 v[68:83], v[152:155], a[28:31], v[68:83]
    s_waitcnt lgkmcnt(2)
    v_mfma_f32_32x32x16_bf16 v[84:99], v[156:159], a[28:31], v[84:99]
    s_waitcnt lgkmcnt(0)
    v_mfma_f32_32x32x16_bf16 v[100:115], v[160:163], a[28:31], v[100:115]
    s_waitcnt vmcnt(0) lgkmcnt(0)
    s_nop 11
    v_lshlrev_b32 v120, 4, v3
    v_add_u32 v120, 148736, v120
    s_barrier
    ds_read_b128 v[124:127], v120 offset:0
    ds_read_b128 v[132:135], v120 offset:384
    ds_read_b128 v[128:131], v120 offset:32
    ds_read_b128 v[136:139], v120 offset:416
    v_add_f32 v8, v8, v10
    v_add_f32 v9, v9, v11
    v_add_f32 v8, v8, v12
    v_add_f32 v9, v9, v13
    v_add_f32 v8, v8, v14
    v_add_f32 v9, v9, v15
    v_add_f32 v8, v8, v16
    v_add_f32 v9, v9, v17
    v_mov_b32 v18, v8
    v_mov_b32 v19, v8
    s_nop 1
    v_permlane32_swap_b32 v18, v19
    s_nop 1
    v_add_f32 v8, v18, v19
    v_mov_b32 v18, v9
    v_mov_b32 v19, v9
    s_nop 1
    v_permlane32_swap_b32 v18, v19
    s_nop 1
    v_add_f32 v9, v18, v19
    v_mul_f32 v116, 0xbacccccd, v8
    v_mul_f32 v18, 0x3acccccd, v9
    v_fma_f32 v18, -v116, v116, v18
    v_max_f32 v18, 0, v18
    v_add_f32 v18, 0x3727c5ac, v18
    v_rsq_f32 v118, v18
    s_nop 0
    v_mov_b32 v117, v116
    v_mov_b32 v119, v118
    s_mul_i32 s50, s56, 98304
    s_mul_i32 s51, s44, 6144
    s_add_u32 s50, s50, s51
    s_add_u32 s50, s50, 8306688
    s_add_u32 s24, s86, s50
    s_addc_u32 s25, s87, 0
    s_and_b32 s25, s25, 0xffff
    s_mov_b32 s26, 6144
    s_mov_b32 s27, 0x00020000
    s_mov_b32 s52, 2048
    v_mov_b32 v10, 0xc0135761
    v_mov_b32 v12, 0xbdd2d3e8
    v_mov_b32 v14, 1.0
    v_mov_b32 v11, 0xc0135761
    v_mov_b32 v13, 0xbdd2d3e8
    v_mov_b32 v15, 1.0
    s_waitcnt lgkmcnt(0)
    ds_read_b128 v[140:143], v120 offset:64
    ds_read_b128 v[148:151], v120 offset:448
    ds_read_b128 v[144:147], v120 offset:96
    ds_read_b128 v[152:155], v120 offset:480
    v_pk_fma_f32 v[124:125], v[116:117], v[124:125], v[20:21]
    v_pk_fma_f32 v[126:127], v[116:117], v[126:127], v[22:23]
    v_pk_fma_f32 v[128:129], v[116:117], v[128:129], v[24:25]
    v_pk_fma_f32 v[130:131], v[116:117], v[130:131], v[26:27]
    v_pk_fma_f32 v[132:133], v[116:117], v[132:133], v[28:29]
    v_pk_fma_f32 v[134:135], v[116:117], v[134:135], v[30:31]
    v_pk_fma_f32 v[136:137], v[116:117], v[136:137], v[32:33]
    v_pk_fma_f32 v[138:139], v[116:117], v[138:139], v[34:35]
    v_pk_mul_f32 v[124:125], v[118:119], v[124:125]
    v_pk_mul_f32 v[126:127], v[118:119], v[126:127]
    v_pk_mul_f32 v[128:129], v[118:119], v[128:129]
    v_pk_mul_f32 v[130:131], v[118:119], v[130:131]
    v_pk_mul_f32 v[156:157], v[124:125], v[124:125]
    v_pk_mul_f32 v[158:159], v[126:127], v[126:127]
    v_pk_mul_f32 v[160:161], v[128:129], v[128:129]
    v_pk_mul_f32 v[162:163], v[130:131], v[130:131]
    v_pk_fma_f32 v[156:157], v[156:157], v[12:13], v[10:11]
    v_pk_fma_f32 v[158:159], v[158:159], v[12:13], v[10:11]
    v_pk_fma_f32 v[160:161], v[160:161], v[12:13], v[10:11]
    v_pk_fma_f32 v[162:163], v[162:163], v[12:13], v[10:11]
    v_pk_mul_f32 v[156:157], v[156:157], v[124:125]
    v_pk_mul_f32 v[158:159], v[158:159], v[126:127]
    v_pk_mul_f32 v[160:161], v[160:161], v[128:129]
    v_pk_mul_f32 v[162:163], v[162:163], v[130:131]
    v_exp_f32 v156, v156
    v_exp_f32 v157, v157
    v_pk_mul_f32 v[132:133], v[118:119], v[132:133]
    v_exp_f32 v158, v158
    v_exp_f32 v159, v159
    v_pk_mul_f32 v[134:135], v[118:119], v[134:135]
    v_exp_f32 v160, v160
    v_exp_f32 v161, v161
    v_pk_mul_f32 v[136:137], v[118:119], v[136:137]
    v_exp_f32 v162, v162
    v_exp_f32 v163, v163
    v_pk_mul_f32 v[138:139], v[118:119], v[138:139]
    v_pk_add_f32 v[156:157], v[156:157], v[14:15]
    v_pk_add_f32 v[158:159], v[158:159], v[14:15]
    v_pk_add_f32 v[160:161], v[160:161], v[14:15]
    v_pk_add_f32 v[162:163], v[162:163], v[14:15]
    v_rcp_f32 v156, v156
    v_rcp_f32 v157, v157
    v_pk_mul_f32 v[124:125], v[124:125], v[132:133]
    v_rcp_f32 v158, v158
    v_rcp_f32 v159, v159
    v_pk_mul_f32 v[126:127], v[126:127], v[134:135]
    v_rcp_f32 v160, v160
    v_rcp_f32 v161, v161
    v_pk_mul_f32 v[128:129], v[128:129], v[136:137]
    v_rcp_f32 v162, v162
    v_rcp_f32 v163, v163
    v_pk_mul_f32 v[130:131], v[130:131], v[138:139]
    v_pk_mul_f32 v[156:157], v[156:157], v[124:125]
    v_pk_mul_f32 v[158:159], v[158:159], v[126:127]
    v_pk_mul_f32 v[160:161], v[160:161], v[128:129]
    v_pk_mul_f32 v[162:163], v[162:163], v[130:131]
    v_cvt_pk_bf16_f32 v164, v156, v157
    v_cvt_pk_bf16_f32 v165, v158, v159
    v_cvt_pk_bf16_f32 v166, v160, v161
    v_cvt_pk_bf16_f32 v167, v162, v163
    buffer_store_dwordx4 v[164:167], v4, s[24:27], 0 offen offset:0 sc1
    s_waitcnt lgkmcnt(0)
    ds_read_b128 v[124:127], v120 offset:128
    ds_read_b128 v[132:135], v120 offset:512
    ds_read_b128 v[128:131], v120 offset:160
    ds_read_b128 v[136:139], v120 offset:544
    v_pk_fma_f32 v[140:141], v[116:117], v[140:141], v[36:37]
    v_pk_fma_f32 v[142:143], v[116:117], v[142:143], v[38:39]
    v_pk_fma_f32 v[144:145], v[116:117], v[144:145], v[40:41]
    v_pk_fma_f32 v[146:147], v[116:117], v[146:147], v[42:43]
    v_pk_fma_f32 v[148:149], v[116:117], v[148:149], v[44:45]
    v_pk_fma_f32 v[150:151], v[116:117], v[150:151], v[46:47]
    v_pk_fma_f32 v[152:153], v[116:117], v[152:153], v[48:49]
    v_pk_fma_f32 v[154:155], v[116:117], v[154:155], v[50:51]
    v_pk_mul_f32 v[140:141], v[118:119], v[140:141]
    v_pk_mul_f32 v[142:143], v[118:119], v[142:143]
    v_pk_mul_f32 v[144:145], v[118:119], v[144:145]
    v_pk_mul_f32 v[146:147], v[118:119], v[146:147]
    v_pk_mul_f32 v[156:157], v[140:141], v[140:141]
    v_pk_mul_f32 v[158:159], v[142:143], v[142:143]
    v_pk_mul_f32 v[160:161], v[144:145], v[144:145]
    v_pk_mul_f32 v[162:163], v[146:147], v[146:147]
    v_pk_fma_f32 v[156:157], v[156:157], v[12:13], v[10:11]
    v_pk_fma_f32 v[158:159], v[158:159], v[12:13], v[10:11]
    v_pk_fma_f32 v[160:161], v[160:161], v[12:13], v[10:11]
    v_pk_fma_f32 v[162:163], v[162:163], v[12:13], v[10:11]
    v_pk_mul_f32 v[156:157], v[156:157], v[140:141]
    v_pk_mul_f32 v[158:159], v[158:159], v[142:143]
    v_pk_mul_f32 v[160:161], v[160:161], v[144:145]
    v_pk_mul_f32 v[162:163], v[162:163], v[146:147]
    v_exp_f32 v156, v156
    v_exp_f32 v157, v157
    v_pk_mul_f32 v[148:149], v[118:119], v[148:149]
    v_exp_f32 v158, v158
    v_exp_f32 v159, v159
    v_pk_mul_f32 v[150:151], v[118:119], v[150:151]
    v_exp_f32 v160, v160
    v_exp_f32 v161, v161
    v_pk_mul_f32 v[152:153], v[118:119], v[152:153]
    v_exp_f32 v162, v162
    v_exp_f32 v163, v163
    v_pk_mul_f32 v[154:155], v[118:119], v[154:155]
    v_pk_add_f32 v[156:157], v[156:157], v[14:15]
    v_pk_add_f32 v[158:159], v[158:159], v[14:15]
    v_pk_add_f32 v[160:161], v[160:161], v[14:15]
    v_pk_add_f32 v[162:163], v[162:163], v[14:15]
    v_rcp_f32 v156, v156
    v_rcp_f32 v157, v157
    v_pk_mul_f32 v[140:141], v[140:141], v[148:149]
    v_rcp_f32 v158, v158
    v_rcp_f32 v159, v159
    v_pk_mul_f32 v[142:143], v[142:143], v[150:151]
    v_rcp_f32 v160, v160
    v_rcp_f32 v161, v161
    v_pk_mul_f32 v[144:145], v[144:145], v[152:153]
    v_rcp_f32 v162, v162
    v_rcp_f32 v163, v163
    v_pk_mul_f32 v[146:147], v[146:147], v[154:155]
    v_pk_mul_f32 v[156:157], v[156:157], v[140:141]
    v_pk_mul_f32 v[158:159], v[158:159], v[142:143]
    v_pk_mul_f32 v[160:161], v[160:161], v[144:145]
    v_pk_mul_f32 v[162:163], v[162:163], v[146:147]
    v_cvt_pk_bf16_f32 v168, v156, v157
    v_cvt_pk_bf16_f32 v169, v158, v159
    v_cvt_pk_bf16_f32 v170, v160, v161
    v_cvt_pk_bf16_f32 v171, v162, v163
    buffer_store_dwordx4 v[168:171], v4, s[24:27], 0 offen offset:1024 sc1
    s_waitcnt lgkmcnt(0)
    ds_read_b128 v[140:143], v120 offset:192
    ds_read_b128 v[148:151], v120 offset:576
    ds_read_b128 v[144:147], v120 offset:224
    ds_read_b128 v[152:155], v120 offset:608
    v_pk_fma_f32 v[124:125], v[116:117], v[124:125], v[52:53]
    v_pk_fma_f32 v[126:127], v[116:117], v[126:127], v[54:55]
    v_pk_fma_f32 v[128:129], v[116:117], v[128:129], v[56:57]
    v_pk_fma_f32 v[130:131], v[116:117], v[130:131], v[58:59]
    v_pk_fma_f32 v[132:133], v[116:117], v[132:133], v[60:61]
    v_pk_fma_f32 v[134:135], v[116:117], v[134:135], v[62:63]
    v_pk_fma_f32 v[136:137], v[116:117], v[136:137], v[64:65]
    v_pk_fma_f32 v[138:139], v[116:117], v[138:139], v[66:67]
    v_pk_mul_f32 v[124:125], v[118:119], v[124:125]
    v_pk_mul_f32 v[126:127], v[118:119], v[126:127]
    v_pk_mul_f32 v[128:129], v[118:119], v[128:129]
    v_pk_mul_f32 v[130:131], v[118:119], v[130:131]
    v_pk_mul_f32 v[156:157], v[124:125], v[124:125]
    v_pk_mul_f32 v[158:159], v[126:127], v[126:127]
    v_pk_mul_f32 v[160:161], v[128:129], v[128:129]
    v_pk_mul_f32 v[162:163], v[130:131], v[130:131]
    v_pk_fma_f32 v[156:157], v[156:157], v[12:13], v[10:11]
    v_pk_fma_f32 v[158:159], v[158:159], v[12:13], v[10:11]
    v_pk_fma_f32 v[160:161], v[160:161], v[12:13], v[10:11]
    v_pk_fma_f32 v[162:163], v[162:163], v[12:13], v[10:11]
    v_pk_mul_f32 v[156:157], v[156:157], v[124:125]
    v_pk_mul_f32 v[158:159], v[158:159], v[126:127]
    v_pk_mul_f32 v[160:161], v[160:161], v[128:129]
    v_pk_mul_f32 v[162:163], v[162:163], v[130:131]
    v_exp_f32 v156, v156
    v_exp_f32 v157, v157
    v_pk_mul_f32 v[132:133], v[118:119], v[132:133]
    v_exp_f32 v158, v158
    v_exp_f32 v159, v159
    v_pk_mul_f32 v[134:135], v[118:119], v[134:135]
    v_exp_f32 v160, v160
    v_exp_f32 v161, v161
    v_pk_mul_f32 v[136:137], v[118:119], v[136:137]
    v_exp_f32 v162, v162
    v_exp_f32 v163, v163
    v_pk_mul_f32 v[138:139], v[118:119], v[138:139]
    v_pk_add_f32 v[156:157], v[156:157], v[14:15]
    v_pk_add_f32 v[158:159], v[158:159], v[14:15]
    v_pk_add_f32 v[160:161], v[160:161], v[14:15]
    v_pk_add_f32 v[162:163], v[162:163], v[14:15]
    v_rcp_f32 v156, v156
    v_rcp_f32 v157, v157
    v_pk_mul_f32 v[124:125], v[124:125], v[132:133]
    v_rcp_f32 v158, v158
    v_rcp_f32 v159, v159
    v_pk_mul_f32 v[126:127], v[126:127], v[134:135]
    v_rcp_f32 v160, v160
    v_rcp_f32 v161, v161
    v_pk_mul_f32 v[128:129], v[128:129], v[136:137]
    v_rcp_f32 v162, v162
    v_rcp_f32 v163, v163
    v_pk_mul_f32 v[130:131], v[130:131], v[138:139]
    v_pk_mul_f32 v[156:157], v[156:157], v[124:125]
    v_pk_mul_f32 v[158:159], v[158:159], v[126:127]
    v_pk_mul_f32 v[160:161], v[160:161], v[128:129]
    v_pk_mul_f32 v[162:163], v[162:163], v[130:131]
    v_cvt_pk_bf16_f32 v164, v156, v157
    v_cvt_pk_bf16_f32 v165, v158, v159
    v_cvt_pk_bf16_f32 v166, v160, v161
    v_cvt_pk_bf16_f32 v167, v162, v163
    buffer_store_dwordx4 v[164:167], v4, s[24:27], 0 offen offset:2048 sc1
    s_waitcnt lgkmcnt(0)
    ds_read_b128 v[124:127], v120 offset:256
    ds_read_b128 v[132:135], v120 offset:640
    ds_read_b128 v[128:131], v120 offset:288
    ds_read_b128 v[136:139], v120 offset:672
    v_pk_fma_f32 v[140:141], v[116:117], v[140:141], v[68:69]
    v_pk_fma_f32 v[142:143], v[116:117], v[142:143], v[70:71]
    v_pk_fma_f32 v[144:145], v[116:117], v[144:145], v[72:73]
    v_pk_fma_f32 v[146:147], v[116:117], v[146:147], v[74:75]
    v_pk_fma_f32 v[148:149], v[116:117], v[148:149], v[76:77]
    v_pk_fma_f32 v[150:151], v[116:117], v[150:151], v[78:79]
    v_pk_fma_f32 v[152:153], v[116:117], v[152:153], v[80:81]
    v_pk_fma_f32 v[154:155], v[116:117], v[154:155], v[82:83]
    v_pk_mul_f32 v[140:141], v[118:119], v[140:141]
    v_pk_mul_f32 v[142:143], v[118:119], v[142:143]
    v_pk_mul_f32 v[144:145], v[118:119], v[144:145]
    v_pk_mul_f32 v[146:147], v[118:119], v[146:147]
    v_pk_mul_f32 v[156:157], v[140:141], v[140:141]
    v_pk_mul_f32 v[158:159], v[142:143], v[142:143]
    v_pk_mul_f32 v[160:161], v[144:145], v[144:145]
    v_pk_mul_f32 v[162:163], v[146:147], v[146:147]
    v_pk_fma_f32 v[156:157], v[156:157], v[12:13], v[10:11]
    v_pk_fma_f32 v[158:159], v[158:159], v[12:13], v[10:11]
    v_pk_fma_f32 v[160:161], v[160:161], v[12:13], v[10:11]
    v_pk_fma_f32 v[162:163], v[162:163], v[12:13], v[10:11]
    v_pk_mul_f32 v[156:157], v[156:157], v[140:141]
    v_pk_mul_f32 v[158:159], v[158:159], v[142:143]
    v_pk_mul_f32 v[160:161], v[160:161], v[144:145]
    v_pk_mul_f32 v[162:163], v[162:163], v[146:147]
    v_exp_f32 v156, v156
    v_exp_f32 v157, v157
    v_pk_mul_f32 v[148:149], v[118:119], v[148:149]
    v_exp_f32 v158, v158
    v_exp_f32 v159, v159
    v_pk_mul_f32 v[150:151], v[118:119], v[150:151]
    v_exp_f32 v160, v160
    v_exp_f32 v161, v161
    v_pk_mul_f32 v[152:153], v[118:119], v[152:153]
    v_exp_f32 v162, v162
    v_exp_f32 v163, v163
    v_pk_mul_f32 v[154:155], v[118:119], v[154:155]
    v_pk_add_f32 v[156:157], v[156:157], v[14:15]
    v_pk_add_f32 v[158:159], v[158:159], v[14:15]
    v_pk_add_f32 v[160:161], v[160:161], v[14:15]
    v_pk_add_f32 v[162:163], v[162:163], v[14:15]
    v_rcp_f32 v156, v156
    v_rcp_f32 v157, v157
    v_pk_mul_f32 v[140:141], v[140:141], v[148:149]
    v_rcp_f32 v158, v158
    v_rcp_f32 v159, v159
    v_pk_mul_f32 v[142:143], v[142:143], v[150:151]
    v_rcp_f32 v160, v160
    v_rcp_f32 v161, v161
    v_pk_mul_f32 v[144:145], v[144:145], v[152:153]
    v_rcp_f32 v162, v162
    v_rcp_f32 v163, v163
    v_pk_mul_f32 v[146:147], v[146:147], v[154:155]
    v_pk_mul_f32 v[156:157], v[156:157], v[140:141]
    v_pk_mul_f32 v[158:159], v[158:159], v[142:143]
    v_pk_mul_f32 v[160:161], v[160:161], v[144:145]
    v_pk_mul_f32 v[162:163], v[162:163], v[146:147]
    v_cvt_pk_bf16_f32 v168, v156, v157
    v_cvt_pk_bf16_f32 v169, v158, v159
    v_cvt_pk_bf16_f32 v170, v160, v161
    v_cvt_pk_bf16_f32 v171, v162, v163
    buffer_store_dwordx4 v[168:171], v4, s[24:27], 0 offen offset:3072 sc1
    s_waitcnt lgkmcnt(0)
    ds_read_b128 v[140:143], v120 offset:320
    ds_read_b128 v[148:151], v120 offset:704
    ds_read_b128 v[144:147], v120 offset:352
    ds_read_b128 v[152:155], v120 offset:736
    v_pk_fma_f32 v[124:125], v[116:117], v[124:125], v[84:85]
    v_pk_fma_f32 v[126:127], v[116:117], v[126:127], v[86:87]
    v_pk_fma_f32 v[128:129], v[116:117], v[128:129], v[88:89]
    v_pk_fma_f32 v[130:131], v[116:117], v[130:131], v[90:91]
    v_pk_fma_f32 v[132:133], v[116:117], v[132:133], v[92:93]
    v_pk_fma_f32 v[134:135], v[116:117], v[134:135], v[94:95]
    v_pk_fma_f32 v[136:137], v[116:117], v[136:137], v[96:97]
    v_pk_fma_f32 v[138:139], v[116:117], v[138:139], v[98:99]
    v_pk_mul_f32 v[124:125], v[118:119], v[124:125]
    v_pk_mul_f32 v[126:127], v[118:119], v[126:127]
    v_pk_mul_f32 v[128:129], v[118:119], v[128:129]
    v_pk_mul_f32 v[130:131], v[118:119], v[130:131]
    v_pk_mul_f32 v[156:157], v[124:125], v[124:125]
    v_pk_mul_f32 v[158:159], v[126:127], v[126:127]
    v_pk_mul_f32 v[160:161], v[128:129], v[128:129]
    v_pk_mul_f32 v[162:163], v[130:131], v[130:131]
    v_pk_fma_f32 v[156:157], v[156:157], v[12:13], v[10:11]
    v_pk_fma_f32 v[158:159], v[158:159], v[12:13], v[10:11]
    v_pk_fma_f32 v[160:161], v[160:161], v[12:13], v[10:11]
    v_pk_fma_f32 v[162:163], v[162:163], v[12:13], v[10:11]
    v_pk_mul_f32 v[156:157], v[156:157], v[124:125]
    v_pk_mul_f32 v[158:159], v[158:159], v[126:127]
    v_pk_mul_f32 v[160:161], v[160:161], v[128:129]
    v_pk_mul_f32 v[162:163], v[162:163], v[130:131]
    v_exp_f32 v156, v156
    v_exp_f32 v157, v157
    v_pk_mul_f32 v[132:133], v[118:119], v[132:133]
    v_exp_f32 v158, v158
    v_exp_f32 v159, v159
    v_pk_mul_f32 v[134:135], v[118:119], v[134:135]
    v_exp_f32 v160, v160
    v_exp_f32 v161, v161
    v_pk_mul_f32 v[136:137], v[118:119], v[136:137]
    v_exp_f32 v162, v162
    v_exp_f32 v163, v163
    v_pk_mul_f32 v[138:139], v[118:119], v[138:139]
    v_pk_add_f32 v[156:157], v[156:157], v[14:15]
    v_pk_add_f32 v[158:159], v[158:159], v[14:15]
    v_pk_add_f32 v[160:161], v[160:161], v[14:15]
    v_pk_add_f32 v[162:163], v[162:163], v[14:15]
    v_rcp_f32 v156, v156
    v_rcp_f32 v157, v157
    v_pk_mul_f32 v[124:125], v[124:125], v[132:133]
    v_rcp_f32 v158, v158
    v_rcp_f32 v159, v159
    v_pk_mul_f32 v[126:127], v[126:127], v[134:135]
    v_rcp_f32 v160, v160
    v_rcp_f32 v161, v161
    v_pk_mul_f32 v[128:129], v[128:129], v[136:137]
    v_rcp_f32 v162, v162
    v_rcp_f32 v163, v163
    v_pk_mul_f32 v[130:131], v[130:131], v[138:139]
    v_pk_mul_f32 v[156:157], v[156:157], v[124:125]
    v_pk_mul_f32 v[158:159], v[158:159], v[126:127]
    v_pk_mul_f32 v[160:161], v[160:161], v[128:129]
    v_pk_mul_f32 v[162:163], v[162:163], v[130:131]
    v_cvt_pk_bf16_f32 v164, v156, v157
    v_cvt_pk_bf16_f32 v165, v158, v159
    v_cvt_pk_bf16_f32 v166, v160, v161
    v_cvt_pk_bf16_f32 v167, v162, v163
    buffer_store_dwordx4 v[164:167], v4, s[24:27], s52 offen offset:2048 sc1
    s_waitcnt lgkmcnt(0)
    v_pk_fma_f32 v[140:141], v[116:117], v[140:141], v[100:101]
    v_pk_fma_f32 v[142:143], v[116:117], v[142:143], v[102:103]
    v_pk_fma_f32 v[144:145], v[116:117], v[144:145], v[104:105]
    v_pk_fma_f32 v[146:147], v[116:117], v[146:147], v[106:107]
    v_pk_fma_f32 v[148:149], v[116:117], v[148:149], v[108:109]
    v_pk_fma_f32 v[150:151], v[116:117], v[150:151], v[110:111]
    v_pk_fma_f32 v[152:153], v[116:117], v[152:153], v[112:113]
    v_pk_fma_f32 v[154:155], v[116:117], v[154:155], v[114:115]
    v_pk_mul_f32 v[140:141], v[118:119], v[140:141]
    v_pk_mul_f32 v[142:143], v[118:119], v[142:143]
    v_pk_mul_f32 v[144:145], v[118:119], v[144:145]
    v_pk_mul_f32 v[146:147], v[118:119], v[146:147]
    v_pk_mul_f32 v[156:157], v[140:141], v[140:141]
    v_pk_mul_f32 v[158:159], v[142:143], v[142:143]
    v_pk_mul_f32 v[160:161], v[144:145], v[144:145]
    v_pk_mul_f32 v[162:163], v[146:147], v[146:147]
    v_pk_fma_f32 v[156:157], v[156:157], v[12:13], v[10:11]
    v_pk_fma_f32 v[158:159], v[158:159], v[12:13], v[10:11]
    v_pk_fma_f32 v[160:161], v[160:161], v[12:13], v[10:11]
    v_pk_fma_f32 v[162:163], v[162:163], v[12:13], v[10:11]
    v_pk_mul_f32 v[156:157], v[156:157], v[140:141]
    v_pk_mul_f32 v[158:159], v[158:159], v[142:143]
    v_pk_mul_f32 v[160:161], v[160:161], v[144:145]
    v_pk_mul_f32 v[162:163], v[162:163], v[146:147]
    v_exp_f32 v156, v156
    v_exp_f32 v157, v157
    v_pk_mul_f32 v[148:149], v[118:119], v[148:149]
    v_exp_f32 v158, v158
    v_exp_f32 v159, v159
    v_pk_mul_f32 v[150:151], v[118:119], v[150:151]
    v_exp_f32 v160, v160
    v_exp_f32 v161, v161
    v_pk_mul_f32 v[152:153], v[118:119], v[152:153]
    v_exp_f32 v162, v162
    v_exp_f32 v163, v163
    v_pk_mul_f32 v[154:155], v[118:119], v[154:155]
    v_pk_add_f32 v[156:157], v[156:157], v[14:15]
    v_pk_add_f32 v[158:159], v[158:159], v[14:15]
    v_pk_add_f32 v[160:161], v[160:161], v[14:15]
    v_pk_add_f32 v[162:163], v[162:163], v[14:15]
    v_rcp_f32 v156, v156
    v_rcp_f32 v157, v157
    v_pk_mul_f32 v[140:141], v[140:141], v[148:149]
    v_rcp_f32 v158, v158
    v_rcp_f32 v159, v159
    v_pk_mul_f32 v[142:143], v[142:143], v[150:151]
    v_rcp_f32 v160, v160
    v_rcp_f32 v161, v161
    v_pk_mul_f32 v[144:145], v[144:145], v[152:153]
    v_rcp_f32 v162, v162
    v_rcp_f32 v163, v163
    v_pk_mul_f32 v[146:147], v[146:147], v[154:155]
    v_pk_mul_f32 v[156:157], v[156:157], v[140:141]
    v_pk_mul_f32 v[158:159], v[158:159], v[142:143]
    v_pk_mul_f32 v[160:161], v[160:161], v[144:145]
    v_pk_mul_f32 v[162:163], v[162:163], v[146:147]
    v_cvt_pk_bf16_f32 v168, v156, v157
    v_cvt_pk_bf16_f32 v169, v158, v159
    v_cvt_pk_bf16_f32 v170, v160, v161
    v_cvt_pk_bf16_f32 v171, v162, v163
    buffer_store_dwordx4 v[168:171], v4, s[24:27], s52 offen offset:3072 sc1
    s_lshl_b32 s50, s56, 8
    s_add_u32 s50, s50, 34816
    s_waitcnt vmcnt(0)
    v_mov_b32 v18, 1
    s_mov_b64 exec, 1
    buffer_atomic_add v18, off, s[4:7], s50 sc1
    s_mov_b64 exec, -1
    s_cmp_eq_u32 s40, 3
    s_cbranch_scc1 F_exit
F_phase_c:
    v_and_b32 v1, 63, v0
    s_and_b32 s3, s2, 7
    s_lshr_b32 s44, s2, 3
    s_mul_i32 s50, s44, 205
    s_lshr_b32 s50, s50, 11
    s_mul_i32 s51, s50, 10
    s_lshl_b32 s43, s50, 3
    s_add_u32 s43, s43, s3
    s_lshl_b32 s61, s44, 1
    s_add_u32 s61, s61, s3
    s_sub_u32 s61, s61, 46
    s_sub_u32 s52, s2, 220
    s_cmp_ge_u32 s2, 240
    s_cselect_b32 s61, s52, s61
    s_sub_u32 s44, s44, s51
    s_cmp_ge_u32 s43, 22
    s_cbranch_scc1 F_exit
    s_lshl_b32 s55, s44, 7
    s_mul_i32 s56, s43, 3
    s_add_u32 s56, s56, s40
    s_waitcnt lgkmcnt(0)
    s_mov_b32 s16, s80
    s_and_b32 s17, s81, 0xffff
    s_mov_b32 s18, 1966080
    s_mov_b32 s19, 0x00020000
    s_mul_i32 s50, s56, 98304
    s_add_u32 s50, s50, 8306688
    s_add_u32 s20, s86, s50
    s_addc_u32 s21, s87, 0
    s_and_b32 s21, s21, 0xffff
    s_mov_b32 s22, 98304
    s_mov_b32 s23, 0x00020000
    s_cmp_ge_u32 s56, 64
    s_cselect_b32 s22, 0, s22
    v_lshrrev_b32 v2, 5, v1
    v_lshlrev_b32 v3, 4, v1
    s_lshl_b32 s51, s44, 12
    s_mul_i32 s50, s56, 40960
    s_add_u32 s50, s50, s51
    s_add_u32 s50, s50, 5505024
    s_add_u32 s28, s86, s50
    s_addc_u32 s29, s87, 0
    s_and_b32 s29, s29, 0xffff
    s_mov_b32 s30, 4096
    s_mov_b32 s31, 0x00020000
    s_cmp_ge_u32 s56, 64
    s_cselect_b32 s30, 0, s30
    s_cmp_lt_u32 s40, 3
    s_cbranch_scc1 L_compute_78
    s_mov_b32 s53, 25856
    v_mov_b32 v90, v1
    v_lshrrev_b32 v91, 3, v90
    v_and_b32 v92, 7, v90
    v_bfe_u32 v93, v91, 1, 1
    v_lshlrev_b32 v93, 2, v93
    v_xor_b32 v92, v92, v93
    v_mul_u32_u24 v91, 1280, v91
    v_lshl_add_u32 v91, v92, 4, v91
    v_add_u32 v68, s55, v91
    v_add_u32 v69, 10240, v68
    v_add_u32 v70, 10240, v69
    v_add_u32 v71, 10240, v70
    v_add_u32 v72, 10240, v71
    v_add_u32 v73, 10240, v72
    v_add_u32 v74, 10240, v73
    v_add_u32 v75, 10240, v74
    s_mov_b32 s45, 0
    s_add_u32 s47, s53, 73728
    s_add_u32 s51, s53, 122880
    s_mov_b32 s49, 6
L_ldn_79:
    s_mov_b32 m0, s47
    s_nop 0
    buffer_load_dwordx4 v68, s[16:19], s45 offen lds
    s_add_u32 m0, s47, 1024
    s_nop 0
    buffer_load_dwordx4 v69, s[16:19], s45 offen lds
    s_add_u32 m0, s47, 2048
    s_nop 0
    buffer_load_dwordx4 v70, s[16:19], s45 offen lds
    s_add_u32 m0, s47, 3072
    s_nop 0
    buffer_load_dwordx4 v71, s[16:19], s45 offen lds
    s_add_u32 m0, s47, 4096
    s_nop 0
    buffer_load_dwordx4 v72, s[16:19], s45 offen lds
    s_add_u32 m0, s47, 5120
    s_nop 0
    buffer_load_dwordx4 v73, s[16:19], s45 offen lds
    s_add_u32 m0, s47, 6144
    s_nop 0
    buffer_load_dwordx4 v74, s[16:19], s45 offen lds
    s_add_u32 m0, s47, 7168
    s_nop 0
    buffer_load_dwordx4 v75, s[16:19], s45 offen lds
    s_add_u32 s45, s45, 81920
    s_add_u32 s47, s47, 8192
    s_cmp_ge_u32 s47, s51
    s_cselect_b32 s47, s53, s47
    s_sub_u32 s49, s49, 1
    s_cmp_lg_u32 s49, 0
    s_cbranch_scc1 L_ldn_79
    s_barrier
    s_mov_b32 s49, 8
L_ldn_80:
    s_mov_b32 m0, s47
    s_nop 0
    buffer_load_dwordx4 v68, s[16:19], s45 offen lds
    s_add_u32 m0, s47, 1024
    s_nop 0
    buffer_load_dwordx4 v69, s[16:19], s45 offen lds
    s_add_u32 m0, s47, 2048
    s_nop 0
    buffer_load_dwordx4 v70, s[16:19], s45 offen lds
    s_add_u32 m0, s47, 3072
    s_nop 0
    buffer_load_dwordx4 v71, s[16:19], s45 offen lds
    s_add_u32 m0, s47, 4096
    s_nop 0
    buffer_load_dwordx4 v72, s[16:19], s45 offen lds
    s_add_u32 m0, s47, 5120
    s_nop 0
    buffer_load_dwordx4 v73, s[16:19], s45 offen lds
    s_add_u32 m0, s47, 6144
    s_nop 0
    buffer_load_dwordx4 v74, s[16:19], s45 offen lds
    s_add_u32 m0, s47, 7168
    s_nop 0
    buffer_load_dwordx4 v75, s[16:19], s45 offen lds
    s_add_u32 s45, s45, 81920
    s_add_u32 s47, s47, 8192
    s_cmp_ge_u32 s47, s51
    s_cselect_b32 s47, s53, s47
    s_sub_u32 s49, s49, 1
    s_cmp_lg_u32 s49, 0
    s_cbranch_scc1 L_ldn_80
    s_waitcnt vmcnt(63)
    s_barrier
    s_mov_b32 s46, 10
L_ldloop_81:
    s_waitcnt vmcnt(63)
    s_barrier
    s_mov_b32 m0, s47
    s_nop 0
    buffer_load_dwordx4 v68, s[16:19], s45 offen lds
    s_add_u32 m0, s47, 1024
    s_nop 0
    buffer_load_dwordx4 v69, s[16:19], s45 offen lds
    s_add_u32 m0, s47, 2048
    s_nop 0
    buffer_load_dwordx4 v70, s[16:19], s45 offen lds
    s_add_u32 m0, s47, 3072
    s_nop 0
    buffer_load_dwordx4 v71, s[16:19], s45 offen lds
    s_add_u32 m0, s47, 4096
    s_nop 0
    buffer_load_dwordx4 v72, s[16:19], s45 offen lds
    s_add_u32 m0, s47, 5120
    s_nop 0
    buffer_load_dwordx4 v73, s[16:19], s45 offen lds
    s_add_u32 m0, s47, 6144
    s_nop 0
    buffer_load_dwordx4 v74, s[16:19], s45 offen lds
    s_add_u32 m0, s47, 7168
    s_nop 0
    buffer_load_dwordx4 v75, s[16:19], s45 offen lds
    s_add_u32 s45, s45, 81920
    s_add_u32 s47, s47, 8192
    s_cmp_ge_u32 s47, s51
    s_cselect_b32 s47, s53, s47
    s_sub_u32 s46, s46, 1
    s_cmp_lg_u32 s46, 0
    s_cbranch_scc1 L_ldloop_81
    s_waitcnt vmcnt(63)
    s_barrier
    s_waitcnt vmcnt(63)
    s_barrier
    s_waitcnt vmcnt(63)
    s_barrier
    s_waitcnt vmcnt(63)
    s_barrier
    s_waitcnt vmcnt(63)
    s_barrier
    s_waitcnt vmcnt(56)
    s_barrier
    s_waitcnt vmcnt(48)
    s_barrier
    s_waitcnt vmcnt(40)
    s_barrier
    s_waitcnt vmcnt(32)
    s_barrier
    s_waitcnt vmcnt(24)
    s_barrier
    s_waitcnt vmcnt(16)
    s_barrier
    s_waitcnt vmcnt(8)
    s_barrier
    s_waitcnt vmcnt(0)
    s_barrier
    s_endpgm
L_compute_78:
    v_lshrrev_b32 v90, 5, v1
    v_mul_u32_u24 v84, 512, v90
    v_bfe_u32 v90, v1, 4, 1
    v_mul_u32_u24 v90, 32, v90
    v_add_u32 v84, v84, v90
    v_bfe_u32 v90, v1, 2, 2
    v_mul_u32_u24 v91, 128, v90
    v_add_u32 v84, v84, v91
    v_and_b32 v91, 3, v1
    v_lshl_add_u32 v84, v91, 3, v84
    v_add_u32 v84, 25856, v84
    v_lshrrev_b32 v90, 1, v90
    v_lshl_add_u32 v84, v90, 6, v84
    v_xor_b32 v85, 64, v84
    v_lshrrev_b32 v105, 5, v1
    v_lshlrev_b32 v105, 2, v105
    v_and_b32 v104, 31, v1
    v_sub_u32 v104, v104, v105
    v_mov_b32 v107, 0x3f80
    v_subrev_u32 v105, 0, v104
    v_cmp_gt_u32 vcc, 2, v105
    v_lshlrev_b32 v106, 4, v105
    v_lshlrev_b32 v106, v106, v107
    v_cndmask_b32 v96, 0, v106, vcc
    v_subrev_u32 v105, 2, v104
    v_cmp_gt_u32 vcc, 2, v105
    v_lshlrev_b32 v106, 4, v105
    v_lshlrev_b32 v106, v106, v107
    v_cndmask_b32 v97, 0, v106, vcc
    v_subrev_u32 v105, 8, v104
    v_cmp_gt_u32 vcc, 2, v105
    v_lshlrev_b32 v106, 4, v105
    v_lshlrev_b32 v106, v106, v107
    v_cndmask_b32 v98, 0, v106, vcc
    v_subrev_u32 v105, 10, v104
    v_cmp_gt_u32 vcc, 2, v105
    v_lshlrev_b32 v106, 4, v105
    v_lshlrev_b32 v106, v106, v107
    v_cndmask_b32 v99, 0, v106, vcc
    v_subrev_u32 v105, 16, v104
    v_cmp_gt_u32 vcc, 2, v105
    v_lshlrev_b32 v106, 4, v105
    v_lshlrev_b32 v106, v106, v107
    v_cndmask_b32 v100, 0, v106, vcc
    v_subrev_u32 v105, 18, v104
    v_cmp_gt_u32 vcc, 2, v105
    v_lshlrev_b32 v106, 4, v105
    v_lshlrev_b32 v106, v106, v107
    v_cndmask_b32 v101, 0, v106, vcc
    v_subrev_u32 v105, 24, v104
    v_cmp_gt_u32 vcc, 2, v105
    v_lshlrev_b32 v106, 4, v105
    v_lshlrev_b32 v106, v106, v107
    v_cndmask_b32 v102, 0, v106, vcc
    v_subrev_u32 v105, 26, v104
    v_cmp_gt_u32 vcc, 2, v105
    v_lshlrev_b32 v106, 4, v105
    v_lshlrev_b32 v106, v106, v107
    v_cndmask_b32 v103, 0, v106, vcc
    s_mul_i32 s50, s40, 4608
    v_and_b32 v20, 31, v1
    v_mul_u32_u24 v20, 144, v20
    v_lshl_add_u32 v20, v2, 3, v20
    v_add_u32 v20, s50, v20
    v_lshrrev_b32 v21, 3, v1
    v_and_b32 v90, 7, v1
    v_mul_u32_u24 v22, 144, v21
    v_lshl_add_u32 v22, v90, 4, v22
    v_add_u32 v22, s50, v22
    v_mul_u32_u24 v21, 1280, v21
    v_lshl_add_u32 v21, v90, 4, v21
    s_mov_b32 s24, s82
    s_and_b32 s25, s83, 0xffff
    s_mov_b32 s26, 2621440
    s_mov_b32 s27, 0x00020000
    s_mul_i32 s57, s56, 40960
    s_add_u32 s57, s57, s55
    v_add_u32 v86, 73728, v84
    v_add_u32 v87, 73728, v85
    s_mov_b32 s48, 73728
    buffer_load_dwordx4 v[4:7], v3, s[28:31], 0 offen offset:0 sc1
    buffer_load_dwordx4 v[8:11], v3, s[28:31], 0 offen offset:1024 sc1
    buffer_load_dwordx4 v[12:15], v3, s[28:31], 0 offen offset:2048 sc1
    buffer_load_dwordx4 v[16:19], v3, s[28:31], 0 offen offset:3072 sc1
    s_cmp_ge_u32 s56, 64
    s_cbranch_scc1 L_nodep_82
    s_lshl_b32 s50, s56, 8
    s_add_u32 s50, s50, 34816
    s_mov_b32 s9, 0
L_poll_83:
    buffer_load_dword v23, off, s[4:7], s50 sc1
    s_waitcnt vmcnt(0)
    v_readfirstlane_b32 s10, v23
    s_cmp_ge_u32 s10, 16
    s_cbranch_scc1 L_polled_84
    s_add_u32 s9, s9, 1
    s_sleep 2
    s_cmp_lt_u32 s9, 50000
    s_cbranch_scc1 L_poll_83
L_polled_84:
L_nodep_82:
    s_mov_b32 s62, 0
    buffer_load_dwordx4 a[0:3], v3, s[20:23], s62 offen offset:0 sc1
    buffer_load_dwordx4 a[4:7], v3, s[20:23], s62 offen offset:1024 sc1
    buffer_load_dwordx4 a[8:11], v3, s[20:23], s62 offen offset:2048 sc1
    buffer_load_dwordx4 a[12:15], v3, s[20:23], s62 offen offset:3072 sc1
    s_mov_b32 s62, 4096
    buffer_load_dwordx4 a[16:19], v3, s[20:23], s62 offen offset:0 sc1
    buffer_load_dwordx4 a[20:23], v3, s[20:23], s62 offen offset:1024 sc1
    buffer_load_dwordx4 a[24:27], v3, s[20:23], s62 offen offset:2048 sc1
    buffer_load_dwordx4 a[28:31], v3, s[20:23], s62 offen offset:3072 sc1
    s_mov_b32 s62, 8192
    buffer_load_dwordx4 a[32:35], v3, s[20:23], s62 offen offset:0 sc1
    buffer_load_dwordx4 a[36:39], v3, s[20:23], s62 offen offset:1024 sc1
    buffer_load_dwordx4 a[40:43], v3, s[20:23], s62 offen offset:2048 sc1
    buffer_load_dwordx4 a[44:47], v3, s[20:23], s62 offen offset:3072 sc1
    s_waitcnt vmcnt(8)
    s_barrier
    ds_read_b64_tr_b16 v[68:69], v86 offset:0
    ds_read_b64_tr_b16 v[70:71], v86 offset:1024
    ds_read_b64_tr_b16 v[72:73], v87 offset:0
    ds_read_b64_tr_b16 v[74:75], v87 offset:1024
    v_mfma_f32_32x32x16_bf16 v[24:39], v[96:99], v[4:7], 0
    v_mfma_f32_32x32x16_bf16 v[40:55], v[96:99], v[12:15], 0
    v_mfma_f32_32x32x16_bf16 v[24:39], v[100:103], v[8:11], v[24:39]
    v_mfma_f32_32x32x16_bf16 v[40:55], v[100:103], v[16:19], v[40:55]
    s_waitcnt lgkmcnt(2)
    v_mfma_f32_32x32x16_bf16 v[24:39], v[68:71], a[0:3], v[24:39]
    ds_read_b64_tr_b16 v[76:77], v86 offset:2048
    ds_read_b64_tr_b16 v[78:79], v86 offset:3072
    s_waitcnt lgkmcnt(2)
    v_mfma_f32_32x32x16_bf16 v[40:55], v[72:75], a[0:3], v[40:55]
    ds_read_b64_tr_b16 v[80:81], v87 offset:2048
    ds_read_b64_tr_b16 v[82:83], v87 offset:3072
    s_mov_b32 s62, 12288
    buffer_load_dwordx4 a[48:51], v3, s[20:23], s62 offen offset:0 sc1
    buffer_load_dwordx4 a[52:55], v3, s[20:23], s62 offen offset:1024 sc1
    s_waitcnt lgkmcnt(2)
    v_mfma_f32_32x32x16_bf16 v[24:39], v[76:79], a[4:7], v[24:39]
    ds_read_b64_tr_b16 v[68:69], v86 offset:4096
    ds_read_b64_tr_b16 v[70:71], v86 offset:5120
    s_waitcnt lgkmcnt(2)
    v_mfma_f32_32x32x16_bf16 v[40:55], v[80:83], a[4:7], v[40:55]
    ds_read_b64_tr_b16 v[72:73], v87 offset:4096
    ds_read_b64_tr_b16 v[74:75], v87 offset:5120
    buffer_load_dwordx4 a[56:59], v3, s[20:23], s62 offen offset:2048 sc1
    buffer_load_dwordx4 a[60:63], v3, s[20:23], s62 offen offset:3072 sc1
    s_waitcnt lgkmcnt(2)
    v_mfma_f32_32x32x16_bf16 v[24:39], v[68:71], a[8:11], v[24:39]
    ds_read_b64_tr_b16 v[76:77], v86 offset:6144
    ds_read_b64_tr_b16 v[78:79], v86 offset:7168
    s_waitcnt lgkmcnt(2)
    v_mfma_f32_32x32x16_bf16 v[40:55], v[72:75], a[8:11], v[40:55]
    ds_read_b64_tr_b16 v[80:81], v87 offset:6144
    ds_read_b64_tr_b16 v[82:83], v87 offset:7168
    s_mov_b32 s62, 16384
    buffer_load_dwordx4 a[64:67], v3, s[20:23], s62 offen offset:0 sc1
    buffer_load_dwordx4 a[68:71], v3, s[20:23], s62 offen offset:1024 sc1
    s_waitcnt lgkmcnt(2)
    v_mfma_f32_32x32x16_bf16 v[24:39], v[76:79], a[12:15], v[24:39]
    s_add_u32 s48, s48, 8192
    s_cmp_ge_u32 s48, 122880
    s_cselect_b32 s48, 0, s48
    v_add_u32 v88, s48, v84
    v_add_u32 v89, s48, v85
    s_waitcnt vmcnt(10)
    s_barrier
    ds_read_b64_tr_b16 v[68:69], v88 offset:0
    ds_read_b64_tr_b16 v[70:71], v88 offset:1024
    s_waitcnt lgkmcnt(2)
    v_mfma_f32_32x32x16_bf16 v[40:55], v[80:83], a[12:15], v[40:55]
    ds_read_b64_tr_b16 v[72:73], v89 offset:0
    ds_read_b64_tr_b16 v[74:75], v89 offset:1024
    buffer_load_dwordx4 a[72:75], v3, s[20:23], s62 offen offset:2048 sc1
    buffer_load_dwordx4 a[76:79], v3, s[20:23], s62 offen offset:3072 sc1
    s_waitcnt lgkmcnt(2)
    v_mfma_f32_32x32x16_bf16 v[24:39], v[68:71], a[16:19], v[24:39]
    ds_read_b64_tr_b16 v[76:77], v88 offset:2048
    ds_read_b64_tr_b16 v[78:79], v88 offset:3072
    s_waitcnt lgkmcnt(2)
    v_mfma_f32_32x32x16_bf16 v[40:55], v[72:75], a[16:19], v[40:55]
    ds_read_b64_tr_b16 v[80:81], v89 offset:2048
    ds_read_b64_tr_b16 v[82:83], v89 offset:3072
    s_mov_b32 s62, 20480
    buffer_load_dwordx4 a[80:83], v3, s[20:23], s62 offen offset:0 sc1
    buffer_load_dwordx4 v[56:59], v3, s[20:23], s62 offen offset:1024 sc1
    s_waitcnt lgkmcnt(2)
    v_mfma_f32_32x32x16_bf16 v[24:39], v[76:79], a[20:23], v[24:39]
    ds_read_b64_tr_b16 v[68:69], v88 offset:4096
    ds_read_b64_tr_b16 v[70:71], v88 offset:5120
    s_waitcnt lgkmcnt(2)
    v_mfma_f32_32x32x16_bf16 v[40:55], v[80:83], a[20:23], v[40:55]
    ds_read_b64_tr_b16 v[72:73], v89 offset:4096
    ds_read_b64_tr_b16 v[74:75], v89 offset:5120
    buffer_load_dwordx4 v[60:63], v3, s[20:23], s62 offen offset:2048 sc1
    buffer_load_dwordx4 v[64:67], v3, s[20:23], s62 offen offset:3072 sc1
    s_waitcnt lgkmcnt(2)
    v_mfma_f32_32x32x16_bf16 v[24:39], v[68:71], a[24:27], v[24:39]
    ds_read_b64_tr_b16 v[76:77], v88 offset:6144
    ds_read_b64_tr_b16 v[78:79], v88 offset:7168
    s_waitcnt lgkmcnt(2)
    v_mfma_f32_32x32x16_bf16 v[40:55], v[72:75], a[24:27], v[40:55]
    ds_read_b64_tr_b16 v[80:81], v89 offset:6144
    ds_read_b64_tr_b16 v[82:83], v89 offset:7168
    s_mov_b32 s62, 24576
    buffer_load_dwordx4 a[0:3], v3, s[20:23], s62 offen offset:0 sc1
    buffer_load_dwordx4 a[4:7], v3, s[20:23], s62 offen offset:1024 sc1
    s_waitcnt lgkmcnt(2)
    v_mfma_f32_32x32x16_bf16 v[24:39], v[76:79], a[28:31], v[24:39]
    s_add_u32 s48, s48, 8192
    s_cmp_ge_u32 s48, 122880
    s_cselect_b32 s48, 0, s48
    v_add_u32 v86, s48, v84
    v_add_u32 v87, s48, v85
    s_waitcnt vmcnt(14)
    s_barrier
    ds_read_b64_tr_b16 v[68:69], v86 offset:0
    ds_read_b64_tr_b16 v[70:71], v86 offset:1024
    s_waitcnt lgkmcnt(2)
    v_mfma_f32_32x32x16_bf16 v[40:55], v[80:83], a[28:31], v[40:55]
    ds_read_b64_tr_b16 v[72:73], v87 offset:0
    ds_read_b64_tr_b16 v[74:75], v87 offset:1024
    buffer_load_dwordx4 a[8:11], v3, s[20:23], s62 offen offset:2048 sc1
    buffer_load_dwordx4 a[12:15], v3, s[20:23], s62 offen offset:3072 sc1
    s_waitcnt lgkmcnt(2)
    v_mfma_f32_32x32x16_bf16 v[24:39], v[68:71], a[32:35], v[24:39]
    ds_read_b64_tr_b16 v[76:77], v86 offset:2048
    ds_read_b64_tr_b16 v[78:79], v86 offset:3072
    s_waitcnt lgkmcnt(2)
    v_mfma_f32_32x32x16_bf16 v[40:55], v[72:75], a[32:35], v[40:55]
    ds_read_b64_tr_b16 v[80:81], v87 offset:2048
    ds_read_b64_tr_b16 v[82:83], v87 offset:3072
    s_mov_b32 s62, 28672
    buffer_load_dwordx4 a[16:19], v3, s[20:23], s62 offen offset:0 sc1
    buffer_load_dwordx4 a[20:23], v3, s[20:23], s62 offen offset:1024 sc1
    s_waitcnt lgkmcnt(2)
    v_mfma_f32_32x32x16_bf16 v[24:39], v[76:79], a[36:39], v[24:39]
    ds_read_b64_tr_b16 v[68:69], v86 offset:4096
    ds_read_b64_tr_b16 v[70:71], v86 offset:5120
    s_waitcnt lgkmcnt(2)
    v_mfma_f32_32x32x16_bf16 v[40:55], v[80:83], a[36:39], v[40:55]
    ds_read_b64_tr_b16 v[72:73], v87 offset:4096
    ds_read_b64_tr_b16 v[74:75], v87 offset:5120
    buffer_load_dwordx4 a[24:27], v3, s[20:23], s62 offen offset:2048 sc1
    buffer_load_dwordx4 a[28:31], v3, s[20:23], s62 offen offset:3072 sc1
    s_waitcnt lgkmcnt(2)
    v_mfma_f32_32x32x16_bf16 v[24:39], v[68:71], a[40:43], v[24:39]
    ds_read_b64_tr_b16 v[76:77], v86 offset:6144
    ds_read_b64_tr_b16 v[78:79], v86 offset:7168
    s_waitcnt lgkmcnt(2)
    v_mfma_f32_32x32x16_bf16 v[40:55], v[72:75], a[40:43], v[40:55]
    ds_read_b64_tr_b16 v[80:81], v87 offset:6144
    ds_read_b64_tr_b16 v[82:83], v87 offset:7168
    s_mov_b32 s62, 32768
    buffer_load_dwordx4 a[32:35], v3, s[20:23], s62 offen offset:0 sc1
    buffer_load_dwordx4 a[36:39], v3, s[20:23], s62 offen offset:1024 sc1
    s_waitcnt lgkmcnt(2)
    v_mfma_f32_32x32x16_bf16 v[24:39], v[76:79], a[44:47], v[24:39]
    s_add_u32 s48, s48, 8192
    s_cmp_ge_u32 s48, 122880
    s_cselect_b32 s48, 0, s48
    v_add_u32 v88, s48, v84
    v_add_u32 v89, s48, v85
    s_waitcnt vmcnt(18)
    s_barrier
    ds_read_b64_tr_b16 v[68:69], v88 offset:0
    ds_read_b64_tr_b16 v[70:71], v88 offset:1024
    s_waitcnt lgkmcnt(2)
    v_mfma_f32_32x32x16_bf16 v[40:55], v[80:83], a[44:47], v[40:55]
    ds_read_b64_tr_b16 v[72:73], v89 offset:0
    ds_read_b64_tr_b16 v[74:75], v89 offset:1024
    buffer_load_dwordx4 a[40:43], v3, s[20:23], s62 offen offset:2048 sc1
    buffer_load_dwordx4 a[44:47], v3, s[20:23], s62 offen offset:3072 sc1
    s_waitcnt lgkmcnt(2)
    v_mfma_f32_32x32x16_bf16 v[24:39], v[68:71], a[48:51], v[24:39]
    ds_read_b64_tr_b16 v[76:77], v88 offset:2048
    ds_read_b64_tr_b16 v[78:79], v88 offset:3072
    s_waitcnt lgkmcnt(2)
    v_mfma_f32_32x32x16_bf16 v[40:55], v[72:75], a[48:51], v[40:55]
    ds_read_b64_tr_b16 v[80:81], v89 offset:2048
    ds_read_b64_tr_b16 v[82:83], v89 offset:3072
    s_mov_b32 s62, 36864
    buffer_load_dwordx4 a[48:51], v3, s[20:23], s62 offen offset:0 sc1
    s_waitcnt lgkmcnt(2)
    v_mfma_f32_32x32x16_bf16 v[24:39], v[76:79], a[52:55], v[24:39]
    ds_read_b64_tr_b16 v[68:69], v88 offset:4096
    ds_read_b64_tr_b16 v[70:71], v88 offset:5120
    s_waitcnt lgkmcnt(2)
    v_mfma_f32_32x32x16_bf16 v[40:55], v[80:83], a[52:55], v[40:55]
    ds_read_b64_tr_b16 v[72:73], v89 offset:4096
    ds_read_b64_tr_b16 v[74:75], v89 offset:5120
    buffer_load_dwordx4 a[52:55], v3, s[20:23], s62 offen offset:1024 sc1
    s_waitcnt lgkmcnt(2)
    v_mfma_f32_32x32x16_bf16 v[24:39], v[68:71], a[56:59], v[24:39]
    ds_read_b64_tr_b16 v[76:77], v88 offset:6144
    ds_read_b64_tr_b16 v[78:79], v88 offset:7168
    s_waitcnt lgkmcnt(2)
    v_mfma_f32_32x32x16_bf16 v[40:55], v[72:75], a[56:59], v[40:55]
    ds_read_b64_tr_b16 v[80:81], v89 offset:6144
    ds_read_b64_tr_b16 v[82:83], v89 offset:7168
    buffer_load_dwordx4 a[56:59], v3, s[20:23], s62 offen offset:2048 sc1
    s_waitcnt lgkmcnt(2)
    v_mfma_f32_32x32x16_bf16 v[24:39], v[76:79], a[60:63], v[24:39]
    s_add_u32 s48, s48, 8192
    s_cmp_ge_u32 s48, 122880
    s_cselect_b32 s48, 0, s48
    v_add_u32 v86, s48, v84
    v_add_u32 v87, s48, v85
    s_waitcnt vmcnt(19)
    s_barrier
    ds_read_b64_tr_b16 v[68:69], v86 offset:0
    ds_read_b64_tr_b16 v[70:71], v86 offset:1024
    s_waitcnt lgkmcnt(2)
    v_mfma_f32_32x32x16_bf16 v[40:55], v[80:83], a[60:63], v[40:55]
    ds_read_b64_tr_b16 v[72:73], v87 offset:0
    ds_read_b64_tr_b16 v[74:75], v87 offset:1024
    buffer_load_dwordx4 a[60:63], v3, s[20:23], s62 offen offset:3072 sc1
    s_waitcnt lgkmcnt(2)
    v_mfma_f32_32x32x16_bf16 v[24:39], v[68:71], a[64:67], v[24:39]
    ds_read_b64_tr_b16 v[76:77], v86 offset:2048
    ds_read_b64_tr_b16 v[78:79], v86 offset:3072
    s_waitcnt lgkmcnt(2)
    v_mfma_f32_32x32x16_bf16 v[40:55], v[72:75], a[64:67], v[40:55]
    ds_read_b64_tr_b16 v[80:81], v87 offset:2048
    ds_read_b64_tr_b16 v[82:83], v87 offset:3072
    s_mov_b32 s62, 40960
    buffer_load_dwordx4 a[64:67], v3, s[20:23], s62 offen offset:0 sc1
    s_waitcnt lgkmcnt(2)
    v_mfma_f32_32x32x16_bf16 v[24:39], v[76:79], a[68:71], v[24:39]
    ds_read_b64_tr_b16 v[68:69], v86 offset:4096
    ds_read_b64_tr_b16 v[70:71], v86 offset:5120
    s_waitcnt lgkmcnt(2)
    v_mfma_f32_32x32x16_bf16 v[40:55], v[80:83], a[68:71], v[40:55]
    ds_read_b64_tr_b16 v[72:73], v87 offset:4096
    ds_read_b64_tr_b16 v[74:75], v87 offset:5120
    buffer_load_dwordx4 a[68:71], v3, s[20:23], s62 offen offset:1024 sc1
    s_waitcnt lgkmcnt(2)
    v_mfma_f32_32x32x16_bf16 v[24:39], v[68:71], a[72:75], v[24:39]
    ds_read_b64_tr_b16 v[76:77], v86 offset:6144
    ds_read_b64_tr_b16 v[78:79], v86 offset:7168
    s_waitcnt lgkmcnt(2)
    v_mfma_f32_32x32x16_bf16 v[40:55], v[72:75], a[72:75], v[40:55]
    ds_read_b64_tr_b16 v[80:81], v87 offset:6144
    ds_read_b64_tr_b16 v[82:83], v87 offset:7168
    buffer_load_dwordx4 a[72:75], v3, s[20:23], s62 offen offset:2048 sc1
    s_waitcnt lgkmcnt(2)
    v_mfma_f32_32x32x16_bf16 v[24:39], v[76:79], a[76:79], v[24:39]
    s_add_u32 s48, s48, 8192
    s_cmp_ge_u32 s48, 122880
    s_cselect_b32 s48, 0, s48
    v_add_u32 v88, s48, v84
    v_add_u32 v89, s48, v85
    s_waitcnt vmcnt(19)
    s_barrier
    ds_read_b64_tr_b16 v[68:69], v88 offset:0
    ds_read_b64_tr_b16 v[70:71], v88 offset:1024
    s_waitcnt lgkmcnt(2)
    v_mfma_f32_32x32x16_bf16 v[40:55], v[80:83], a[76:79], v[40:55]
    ds_read_b64_tr_b16 v[72:73], v89 offset:0
    ds_read_b64_tr_b16 v[74:75], v89 offset:1024
    buffer_load_dwordx4 a[76:79], v3, s[20:23], s62 offen offset:3072 sc1
    s_waitcnt lgkmcnt(2)
    v_mfma_f32_32x32x16_bf16 v[24:39], v[68:71], a[80:83], v[24:39]
    ds_read_b64_tr_b16 v[76:77], v88 offset:2048
    ds_read_b64_tr_b16 v[78:79], v88 offset:3072
    s_waitcnt lgkmcnt(2)
    v_mfma_f32_32x32x16_bf16 v[40:55], v[72:75], a[80:83], v[40:55]
    ds_read_b64_tr_b16 v[80:81], v89 offset:2048
    ds_read_b64_tr_b16 v[82:83], v89 offset:3072
    s_mov_b32 s62, 45056
    buffer_load_dwordx4 a[80:83], v3, s[20:23], s62 offen offset:0 sc1
    s_waitcnt lgkmcnt(2)
    v_mfma_f32_32x32x16_bf16 v[24:39], v[76:79], v[56:59], v[24:39]
    ds_read_b64_tr_b16 v[68:69], v88 offset:4096
    ds_read_b64_tr_b16 v[70:71], v88 offset:5120
    s_waitcnt lgkmcnt(2)
    v_mfma_f32_32x32x16_bf16 v[40:55], v[80:83], v[56:59], v[40:55]
    ds_read_b64_tr_b16 v[72:73], v89 offset:4096
    ds_read_b64_tr_b16 v[74:75], v89 offset:5120
    buffer_load_dwordx4 v[56:59], v3, s[20:23], s62 offen offset:1024 sc1
    s_waitcnt lgkmcnt(2)
    v_mfma_f32_32x32x16_bf16 v[24:39], v[68:71], v[60:63], v[24:39]
    ds_read_b64_tr_b16 v[76:77], v88 offset:6144
    ds_read_b64_tr_b16 v[78:79], v88 offset:7168
    s_waitcnt lgkmcnt(2)
    v_mfma_f32_32x32x16_bf16 v[40:55], v[72:75], v[60:63], v[40:55]
    ds_read_b64_tr_b16 v[80:81], v89 offset:6144
    ds_read_b64_tr_b16 v[82:83], v89 offset:7168
    buffer_load_dwordx4 v[60:63], v3, s[20:23], s62 offen offset:2048 sc1
    s_waitcnt lgkmcnt(2)
    v_mfma_f32_32x32x16_bf16 v[24:39], v[76:79], v[64:67], v[24:39]
    s_add_u32 s48, s48, 8192
    s_cmp_ge_u32 s48, 122880
    s_cselect_b32 s48, 0, s48
    v_add_u32 v86, s48, v84
    v_add_u32 v87, s48, v85
    s_waitcnt vmcnt(19)
    s_barrier
    ds_read_b64_tr_b16 v[68:69], v86 offset:0
    ds_read_b64_tr_b16 v[70:71], v86 offset:1024
    s_waitcnt lgkmcnt(2)
    v_mfma_f32_32x32x16_bf16 v[40:55], v[80:83], v[64:67], v[40:55]
    ds_read_b64_tr_b16 v[72:73], v87 offset:0
    ds_read_b64_tr_b16 v[74:75], v87 offset:1024
    buffer_load_dwordx4 v[64:67], v3, s[20:23], s62 offen offset:3072 sc1
    s_mov_b32 s46, 49152
    s_mov_b32 s49, 2
L_kloop_85:
    s_waitcnt lgkmcnt(2)
    v_mfma_f32_32x32x16_bf16 v[24:39], v[68:71], a[0:3], v[24:39]
    ds_read_b64_tr_b16 v[76:77], v86 offset:2048
    ds_read_b64_tr_b16 v[78:79], v86 offset:3072
    s_waitcnt lgkmcnt(2)
    v_mfma_f32_32x32x16_bf16 v[40:55], v[72:75], a[0:3], v[40:55]
    ds_read_b64_tr_b16 v[80:81], v87 offset:2048
    ds_read_b64_tr_b16 v[82:83], v87 offset:3072
    buffer_load_dwordx4 a[0:3], v3, s[20:23], s46 offen offset:0 sc1
    s_waitcnt lgkmcnt(2)
    v_mfma_f32_32x32x16_bf16 v[24:39], v[76:79], a[4:7], v[24:39]
    ds_read_b64_tr_b16 v[68:69], v86 offset:4096
    ds_read_b64_tr_b16 v[70:71], v86 offset:5120
    s_waitcnt lgkmcnt(2)
    v_mfma_f32_32x32x16_bf16 v[40:55], v[80:83], a[4:7], v[40:55]
    ds_read_b64_tr_b16 v[72:73], v87 offset:4096
    ds_read_b64_tr_b16 v[74:75], v87 offset:5120
    buffer_load_dwordx4 a[4:7], v3, s[20:23], s46 offen offset:1024 sc1
    s_waitcnt lgkmcnt(2)
    v_mfma_f32_32x32x16_bf16 v[24:39], v[68:71], a[8:11], v[24:39]
    ds_read_b64_tr_b16 v[76:77], v86 offset:6144
    ds_read_b64_tr_b16 v[78:79], v86 offset:7168
    s_waitcnt lgkmcnt(2)
    v_mfma_f32_32x32x16_bf16 v[40:55], v[72:75], a[8:11], v[40:55]
    ds_read_b64_tr_b16 v[80:81], v87 offset:6144
    ds_read_b64_tr_b16 v[82:83], v87 offset:7168
    buffer_load_dwordx4 a[8:11], v3, s[20:23], s46 offen offset:2048 sc1
    s_waitcnt lgkmcnt(2)
    v_mfma_f32_32x32x16_bf16 v[24:39], v[76:79], a[12:15], v[24:39]
    s_add_u32 s48, s48, 8192
    s_cmp_ge_u32 s48, 122880
    s_cselect_b32 s48, 0, s48
    v_add_u32 v88, s48, v84
    v_add_u32 v89, s48, v85
    s_waitcnt vmcnt(19)
    s_barrier
    ds_read_b64_tr_b16 v[68:69], v88 offset:0
    ds_read_b64_tr_b16 v[70:71], v88 offset:1024
    s_waitcnt lgkmcnt(2)
    v_mfma_f32_32x32x16_bf16 v[40:55], v[80:83], a[12:15], v[40:55]
    ds_read_b64_tr_b16 v[72:73], v89 offset:0
    ds_read_b64_tr_b16 v[74:75], v89 offset:1024
    buffer_load_dwordx4 a[12:15], v3, s[20:23], s46 offen offset:3072 sc1
    s_add_u32 s46, s46, 4096
    s_waitcnt lgkmcnt(2)
    v_mfma_f32_32x32x16_bf16 v[24:39], v[68:71], a[16:19], v[24:39]
    ds_read_b64_tr_b16 v[76:77], v88 offset:2048
    ds_read_b64_tr_b16 v[78:79], v88 offset:3072
    s_waitcnt lgkmcnt(2)
    v_mfma_f32_32x32x16_bf16 v[40:55], v[72:75], a[16:19], v[40:55]
    ds_read_b64_tr_b16 v[80:81], v89 offset:2048
    ds_read_b64_tr_b16 v[82:83], v89 offset:3072
    buffer_load_dwordx4 a[16:19], v3, s[20:23], s46 offen offset:0 sc1
    s_waitcnt lgkmcnt(2)
    v_mfma_f32_32x32x16_bf16 v[24:39], v[76:79], a[20:23], v[24:39]
    ds_read_b64_tr_b16 v[68:69], v88 offset:4096
    ds_read_b64_tr_b16 v[70:71], v88 offset:5120
    s_waitcnt lgkmcnt(2)
    v_mfma_f32_32x32x16_bf16 v[40:55], v[80:83], a[20:23], v[40:55]
    ds_read_b64_tr_b16 v[72:73], v89 offset:4096
    ds_read_b64_tr_b16 v[74:75], v89 offset:5120
    buffer_load_dwordx4 a[20:23], v3, s[20:23], s46 offen offset:1024 sc1
    s_waitcnt lgkmcnt(2)
    v_mfma_f32_32x32x16_bf16 v[24:39], v[68:71], a[24:27], v[24:39]
    ds_read_b64_tr_b16 v[76:77], v88 offset:6144
    ds_read_b64_tr_b16 v[78:79], v88 offset:7168
    s_waitcnt lgkmcnt(2)
    v_mfma_f32_32x32x16_bf16 v[40:55], v[72:75], a[24:27], v[40:55]
    ds_read_b64_tr_b16 v[80:81], v89 offset:6144
    ds_read_b64_tr_b16 v[82:83], v89 offset:7168
    buffer_load_dwordx4 a[24:27], v3, s[20:23], s46 offen offset:2048 sc1
    s_waitcnt lgkmcnt(2)
    v_mfma_f32_32x32x16_bf16 v[24:39], v[76:79], a[28:31], v[24:39]
    s_add_u32 s48, s48, 8192
    s_cmp_ge_u32 s48, 122880
    s_cselect_b32 s48, 0, s48
    v_add_u32 v86, s48, v84
    v_add_u32 v87, s48, v85
    s_waitcnt vmcnt(19)
    s_barrier
    ds_read_b64_tr_b16 v[68:69], v86 offset:0
    ds_read_b64_tr_b16 v[70:71], v86 offset:1024
    s_waitcnt lgkmcnt(2)
    v_mfma_f32_32x32x16_bf16 v[40:55], v[80:83], a[28:31], v[40:55]
    ds_read_b64_tr_b16 v[72:73], v87 offset:0
    ds_read_b64_tr_b16 v[74:75], v87 offset:1024
    buffer_load_dwordx4 a[28:31], v3, s[20:23], s46 offen offset:3072 sc1
    s_add_u32 s46, s46, 4096
    s_waitcnt lgkmcnt(2)
    v_mfma_f32_32x32x16_bf16 v[24:39], v[68:71], a[32:35], v[24:39]
    ds_read_b64_tr_b16 v[76:77], v86 offset:2048
    ds_read_b64_tr_b16 v[78:79], v86 offset:3072
    s_waitcnt lgkmcnt(2)
    v_mfma_f32_32x32x16_bf16 v[40:55], v[72:75], a[32:35], v[40:55]
    ds_read_b64_tr_b16 v[80:81], v87 offset:2048
    ds_read_b64_tr_b16 v[82:83], v87 offset:3072
    buffer_load_dwordx4 a[32:35], v3, s[20:23], s46 offen offset:0 sc1
    s_waitcnt lgkmcnt(2)
    v_mfma_f32_32x32x16_bf16 v[24:39], v[76:79], a[36:39], v[24:39]
    ds_read_b64_tr_b16 v[68:69], v86 offset:4096
    ds_read_b64_tr_b16 v[70:71], v86 offset:5120
    s_waitcnt lgkmcnt(2)
    v_mfma_f32_32x32x16_bf16 v[40:55], v[80:83], a[36:39], v[40:55]
    ds_read_b64_tr_b16 v[72:73], v87 offset:4096
    ds_read_b64_tr_b16 v[74:75], v87 offset:5120
    buffer_load_dwordx4 a[36:39], v3, s[20:23], s46 offen offset:1024 sc1
    s_waitcnt lgkmcnt(2)
    v_mfma_f32_32x32x16_bf16 v[24:39], v[68:71], a[40:43], v[24:39]
    ds_read_b64_tr_b16 v[76:77], v86 offset:6144
    ds_read_b64_tr_b16 v[78:79], v86 offset:7168
    s_waitcnt lgkmcnt(2)
    v_mfma_f32_32x32x16_bf16 v[40:55], v[72:75], a[40:43], v[40:55]
    ds_read_b64_tr_b16 v[80:81], v87 offset:6144
    ds_read_b64_tr_b16 v[82:83], v87 offset:7168
    buffer_load_dwordx4 a[40:43], v3, s[20:23], s46 offen offset:2048 sc1
    s_waitcnt lgkmcnt(2)
    v_mfma_f32_32x32x16_bf16 v[24:39], v[76:79], a[44:47], v[24:39]
    s_add_u32 s48, s48, 8192
    s_cmp_ge_u32 s48, 122880
    s_cselect_b32 s48, 0, s48
    v_add_u32 v88, s48, v84
    v_add_u32 v89, s48, v85
    s_waitcnt vmcnt(19)
    s_barrier
    ds_read_b64_tr_b16 v[68:69], v88 offset:0
    ds_read_b64_tr_b16 v[70:71], v88 offset:1024
    s_waitcnt lgkmcnt(2)
    v_mfma_f32_32x32x16_bf16 v[40:55], v[80:83], a[44:47], v[40:55]
    ds_read_b64_tr_b16 v[72:73], v89 offset:0
    ds_read_b64_tr_b16 v[74:75], v89 offset:1024
    buffer_load_dwordx4 a[44:47], v3, s[20:23], s46 offen offset:3072 sc1
    s_add_u32 s46, s46, 4096
    s_waitcnt lgkmcnt(2)
    v_mfma_f32_32x32x16_bf16 v[24:39], v[68:71], a[48:51], v[24:39]
    ds_read_b64_tr_b16 v[76:77], v88 offset:2048
    ds_read_b64_tr_b16 v[78:79], v88 offset:3072
    s_waitcnt lgkmcnt(2)
    v_mfma_f32_32x32x16_bf16 v[40:55], v[72:75], a[48:51], v[40:55]
    ds_read_b64_tr_b16 v[80:81], v89 offset:2048
    ds_read_b64_tr_b16 v[82:83], v89 offset:3072
    buffer_load_dwordx4 a[48:51], v3, s[20:23], s46 offen offset:0 sc1
    s_waitcnt lgkmcnt(2)
    v_mfma_f32_32x32x16_bf16 v[24:39], v[76:79], a[52:55], v[24:39]
    ds_read_b64_tr_b16 v[68:69], v88 offset:4096
    ds_read_b64_tr_b16 v[70:71], v88 offset:5120
    s_waitcnt lgkmcnt(2)
    v_mfma_f32_32x32x16_bf16 v[40:55], v[80:83], a[52:55], v[40:55]
    ds_read_b64_tr_b16 v[72:73], v89 offset:4096
    ds_read_b64_tr_b16 v[74:75], v89 offset:5120
    buffer_load_dwordx4 a[52:55], v3, s[20:23], s46 offen offset:1024 sc1
    s_waitcnt lgkmcnt(2)
    v_mfma_f32_32x32x16_bf16 v[24:39], v[68:71], a[56:59], v[24:39]
    ds_read_b64_tr_b16 v[76:77], v88 offset:6144
    ds_read_b64_tr_b16 v[78:79], v88 offset:7168
    s_waitcnt lgkmcnt(2)
    v_mfma_f32_32x32x16_bf16 v[40:55], v[72:75], a[56:59], v[40:55]
    ds_read_b64_tr_b16 v[80:81], v89 offset:6144
    ds_read_b64_tr_b16 v[82:83], v89 offset:7168
    buffer_load_dwordx4 a[56:59], v3, s[20:23], s46 offen offset:2048 sc1
    s_waitcnt lgkmcnt(2)
    v_mfma_f32_32x32x16_bf16 v[24:39], v[76:79], a[60:63], v[24:39]
    s_add_u32 s48, s48, 8192
    s_cmp_ge_u32 s48, 122880
    s_cselect_b32 s48, 0, s48
    v_add_u32 v86, s48, v84
    v_add_u32 v87, s48, v85
    s_waitcnt vmcnt(19)
    s_barrier
    ds_read_b64_tr_b16 v[68:69], v86 offset:0
    ds_read_b64_tr_b16 v[70:71], v86 offset:1024
    s_waitcnt lgkmcnt(2)
    v_mfma_f32_32x32x16_bf16 v[40:55], v[80:83], a[60:63], v[40:55]
    ds_read_b64_tr_b16 v[72:73], v87 offset:0
    ds_read_b64_tr_b16 v[74:75], v87 offset:1024
    buffer_load_dwordx4 a[60:63], v3, s[20:23], s46 offen offset:3072 sc1
    s_add_u32 s46, s46, 4096
    s_waitcnt lgkmcnt(2)
    v_mfma_f32_32x32x16_bf16 v[24:39], v[68:71], a[64:67], v[24:39]
    ds_read_b64_tr_b16 v[76:77], v86 offset:2048
    ds_read_b64_tr_b16 v[78:79], v86 offset:3072
    s_waitcnt lgkmcnt(2)
    v_mfma_f32_32x32x16_bf16 v[40:55], v[72:75], a[64:67], v[40:55]
    ds_read_b64_tr_b16 v[80:81], v87 offset:2048
    ds_read_b64_tr_b16 v[82:83], v87 offset:3072
    buffer_load_dwordx4 a[64:67], v3, s[20:23], s46 offen offset:0 sc1
    s_waitcnt lgkmcnt(2)
    v_mfma_f32_32x32x16_bf16 v[24:39], v[76:79], a[68:71], v[24:39]
    ds_read_b64_tr_b16 v[68:69], v86 offset:4096
    ds_read_b64_tr_b16 v[70:71], v86 offset:5120
    s_waitcnt lgkmcnt(2)
    v_mfma_f32_32x32x16_bf16 v[40:55], v[80:83], a[68:71], v[40:55]
    ds_read_b64_tr_b16 v[72:73], v87 offset:4096
    ds_read_b64_tr_b16 v[74:75], v87 offset:5120
    buffer_load_dwordx4 a[68:71], v3, s[20:23], s46 offen offset:1024 sc1
    s_waitcnt lgkmcnt(2)
    v_mfma_f32_32x32x16_bf16 v[24:39], v[68:71], a[72:75], v[24:39]
    ds_read_b64_tr_b16 v[76:77], v86 offset:6144
    ds_read_b64_tr_b16 v[78:79], v86 offset:7168
    s_waitcnt lgkmcnt(2)
    v_mfma_f32_32x32x16_bf16 v[40:55], v[72:75], a[72:75], v[40:55]
    ds_read_b64_tr_b16 v[80:81], v87 offset:6144
    ds_read_b64_tr_b16 v[82:83], v87 offset:7168
    buffer_load_dwordx4 a[72:75], v3, s[20:23], s46 offen offset:2048 sc1
    s_waitcnt lgkmcnt(2)
    v_mfma_f32_32x32x16_bf16 v[24:39], v[76:79], a[76:79], v[24:39]
    s_add_u32 s48, s48, 8192
    s_cmp_ge_u32 s48, 122880
    s_cselect_b32 s48, 0, s48
    v_add_u32 v88, s48, v84
    v_add_u32 v89, s48, v85
    s_waitcnt vmcnt(19)
    s_barrier
    ds_read_b64_tr_b16 v[68:69], v88 offset:0
    ds_read_b64_tr_b16 v[70:71], v88 offset:1024
    s_waitcnt lgkmcnt(2)
    v_mfma_f32_32x32x16_bf16 v[40:55], v[80:83], a[76:79], v[40:55]
    ds_read_b64_tr_b16 v[72:73], v89 offset:0
    ds_read_b64_tr_b16 v[74:75], v89 offset:1024
    buffer_load_dwordx4 a[76:79], v3, s[20:23], s46 offen offset:3072 sc1
    s_add_u32 s46, s46, 4096
    s_waitcnt lgkmcnt(2)
    v_mfma_f32_32x32x16_bf16 v[24:39], v[68:71], a[80:83], v[24:39]
    ds_read_b64_tr_b16 v[76:77], v88 offset:2048
    ds_read_b64_tr_b16 v[78:79], v88 offset:3072
    s_waitcnt lgkmcnt(2)
    v_mfma_f32_32x32x16_bf16 v[40:55], v[72:75], a[80:83], v[40:55]
    ds_read_b64_tr_b16 v[80:81], v89 offset:2048
    ds_read_b64_tr_b16 v[82:83], v89 offset:3072
    buffer_load_dwordx4 a[80:83], v3, s[20:23], s46 offen offset:0 sc1
    s_waitcnt lgkmcnt(2)
    v_mfma_f32_32x32x16_bf16 v[24:39], v[76:79], v[56:59], v[24:39]
    ds_read_b64_tr_b16 v[68:69], v88 offset:4096
    ds_read_b64_tr_b16 v[70:71], v88 offset:5120
    s_waitcnt lgkmcnt(2)
    v_mfma_f32_32x32x16_bf16 v[40:55], v[80:83], v[56:59], v[40:55]
    ds_read_b64_tr_b16 v[72:73], v89 offset:4096
    ds_read_b64_tr_b16 v[74:75], v89 offset:5120
    buffer_load_dwordx4 v[56:59], v3, s[20:23], s46 offen offset:1024 sc1
    s_waitcnt lgkmcnt(2)
    v_mfma_f32_32x32x16_bf16 v[24:39], v[68:71], v[60:63], v[24:39]
    ds_read_b64_tr_b16 v[76:77], v88 offset:6144
    ds_read_b64_tr_b16 v[78:79], v88 offset:7168
    s_waitcnt lgkmcnt(2)
    v_mfma_f32_32x32x16_bf16 v[40:55], v[72:75], v[60:63], v[40:55]
    ds_read_b64_tr_b16 v[80:81], v89 offset:6144
    ds_read_b64_tr_b16 v[82:83], v89 offset:7168
    buffer_load_dwordx4 v[60:63], v3, s[20:23], s46 offen offset:2048 sc1
    s_waitcnt lgkmcnt(2)
    v_mfma_f32_32x32x16_bf16 v[24:39], v[76:79], v[64:67], v[24:39]
    s_add_u32 s48, s48, 8192
    s_cmp_ge_u32 s48, 122880
    s_cselect_b32 s48, 0, s48
    v_add_u32 v86, s48, v84
    v_add_u32 v87, s48, v85
    s_waitcnt vmcnt(19)
    s_barrier
    ds_read_b64_tr_b16 v[68:69], v86 offset:0
    ds_read_b64_tr_b16 v[70:71], v86 offset:1024
    s_waitcnt lgkmcnt(2)
    v_mfma_f32_32x32x16_bf16 v[40:55], v[80:83], v[64:67], v[40:55]
    ds_read_b64_tr_b16 v[72:73], v87 offset:0
    ds_read_b64_tr_b16 v[74:75], v87 offset:1024
    buffer_load_dwordx4 v[64:67], v3, s[20:23], s46 offen offset:3072 sc1
    s_add_u32 s46, s46, 4096
    s_sub_u32 s49, s49, 1
    s_cmp_lg_u32 s49, 0
    s_cbranch_scc1 L_kloop_85
    s_waitcnt lgkmcnt(2)
    v_mfma_f32_32x32x16_bf16 v[24:39], v[68:71], a[0:3], v[24:39]
    ds_read_b64_tr_b16 v[76:77], v86 offset:2048
    ds_read_b64_tr_b16 v[78:79], v86 offset:3072
    s_waitcnt lgkmcnt(2)
    v_mfma_f32_32x32x16_bf16 v[40:55], v[72:75], a[0:3], v[40:55]
    ds_read_b64_tr_b16 v[80:81], v87 offset:2048
    ds_read_b64_tr_b16 v[82:83], v87 offset:3072
    s_waitcnt lgkmcnt(2)
    v_mfma_f32_32x32x16_bf16 v[24:39], v[76:79], a[4:7], v[24:39]
    ds_read_b64_tr_b16 v[68:69], v86 offset:4096
    ds_read_b64_tr_b16 v[70:71], v86 offset:5120
    s_waitcnt lgkmcnt(2)
    v_mfma_f32_32x32x16_bf16 v[40:55], v[80:83], a[4:7], v[40:55]
    ds_read_b64_tr_b16 v[72:73], v87 offset:4096
    ds_read_b64_tr_b16 v[74:75], v87 offset:5120
    s_waitcnt lgkmcnt(2)
    v_mfma_f32_32x32x16_bf16 v[24:39], v[68:71], a[8:11], v[24:39]
    ds_read_b64_tr_b16 v[76:77], v86 offset:6144
    ds_read_b64_tr_b16 v[78:79], v86 offset:7168
    s_waitcnt lgkmcnt(2)
    v_mfma_f32_32x32x16_bf16 v[40:55], v[72:75], a[8:11], v[40:55]
    ds_read_b64_tr_b16 v[80:81], v87 offset:6144
    ds_read_b64_tr_b16 v[82:83], v87 offset:7168
    s_waitcnt lgkmcnt(2)
    v_mfma_f32_32x32x16_bf16 v[24:39], v[76:79], a[12:15], v[24:39]
    s_add_u32 s48, s48, 8192
    s_cmp_ge_u32 s48, 122880
    s_cselect_b32 s48, 0, s48
    v_add_u32 v88, s48, v84
    v_add_u32 v89, s48, v85
    s_waitcnt vmcnt(16)
    s_barrier
    ds_read_b64_tr_b16 v[68:69], v88 offset:0
    ds_read_b64_tr_b16 v[70:71], v88 offset:1024
    s_waitcnt lgkmcnt(2)
    v_mfma_f32_32x32x16_bf16 v[40:55], v[80:83], a[12:15], v[40:55]
    ds_read_b64_tr_b16 v[72:73], v89 offset:0
    ds_read_b64_tr_b16 v[74:75], v89 offset:1024
    s_waitcnt lgkmcnt(2)
    v_mfma_f32_32x32x16_bf16 v[24:39], v[68:71], a[16:19], v[24:39]
    ds_read_b64_tr_b16 v[76:77], v88 offset:2048
    ds_read_b64_tr_b16 v[78:79], v88 offset:3072
    s_waitcnt lgkmcnt(2)
    v_mfma_f32_32x32x16_bf16 v[40:55], v[72:75], a[16:19], v[40:55]
    ds_read_b64_tr_b16 v[80:81], v89 offset:2048
    ds_read_b64_tr_b16 v[82:83], v89 offset:3072
    s_waitcnt lgkmcnt(2)
    v_mfma_f32_32x32x16_bf16 v[24:39], v[76:79], a[20:23], v[24:39]
    ds_read_b64_tr_b16 v[68:69], v88 offset:4096
    ds_read_b64_tr_b16 v[70:71], v88 offset:5120
    s_waitcnt lgkmcnt(2)
    v_mfma_f32_32x32x16_bf16 v[40:55], v[80:83], a[20:23], v[40:55]
    ds_read_b64_tr_b16 v[72:73], v89 offset:4096
    ds_read_b64_tr_b16 v[74:75], v89 offset:5120
    s_waitcnt lgkmcnt(2)
    v_mfma_f32_32x32x16_bf16 v[24:39], v[68:71], a[24:27], v[24:39]
    ds_read_b64_tr_b16 v[76:77], v88 offset:6144
    ds_read_b64_tr_b16 v[78:79], v88 offset:7168
    s_waitcnt lgkmcnt(2)
    v_mfma_f32_32x32x16_bf16 v[40:55], v[72:75], a[24:27], v[40:55]
    ds_read_b64_tr_b16 v[80:81], v89 offset:6144
    ds_read_b64_tr_b16 v[82:83], v89 offset:7168
    s_waitcnt lgkmcnt(2)
    v_mfma_f32_32x32x16_bf16 v[24:39], v[76:79], a[28:31], v[24:39]
    s_add_u32 s48, s48, 8192
    s_cmp_ge_u32 s48, 122880
    s_cselect_b32 s48, 0, s48
    v_add_u32 v86, s48, v84
    v_add_u32 v87, s48, v85
    s_waitcnt vmcnt(12)
    s_barrier
    ds_read_b64_tr_b16 v[68:69], v86 offset:0
    ds_read_b64_tr_b16 v[70:71], v86 offset:1024
    s_waitcnt lgkmcnt(2)
    v_mfma_f32_32x32x16_bf16 v[40:55], v[80:83], a[28:31], v[40:55]
    ds_read_b64_tr_b16 v[72:73], v87 offset:0
    ds_read_b64_tr_b16 v[74:75], v87 offset:1024
    s_waitcnt lgkmcnt(2)
    v_mfma_f32_32x32x16_bf16 v[24:39], v[68:71], a[32:35], v[24:39]
    ds_read_b64_tr_b16 v[76:77], v86 offset:2048
    ds_read_b64_tr_b16 v[78:79], v86 offset:3072
    s_waitcnt lgkmcnt(2)
    v_mfma_f32_32x32x16_bf16 v[40:55], v[72:75], a[32:35], v[40:55]
    ds_read_b64_tr_b16 v[80:81], v87 offset:2048
    ds_read_b64_tr_b16 v[82:83], v87 offset:3072
    s_waitcnt lgkmcnt(2)
    v_mfma_f32_32x32x16_bf16 v[24:39], v[76:79], a[36:39], v[24:39]
    ds_read_b64_tr_b16 v[68:69], v86 offset:4096
    ds_read_b64_tr_b16 v[70:71], v86 offset:5120
    s_waitcnt lgkmcnt(2)
    v_mfma_f32_32x32x16_bf16 v[40:55], v[80:83], a[36:39], v[40:55]
    ds_read_b64_tr_b16 v[72:73], v87 offset:4096
    ds_read_b64_tr_b16 v[74:75], v87 offset:5120
    s_waitcnt lgkmcnt(2)
    v_mfma_f32_32x32x16_bf16 v[24:39], v[68:71], a[40:43], v[24:39]
    ds_read_b64_tr_b16 v[76:77], v86 offset:6144
    ds_read_b64_tr_b16 v[78:79], v86 offset:7168
    s_waitcnt lgkmcnt(2)
    v_mfma_f32_32x32x16_bf16 v[40:55], v[72:75], a[40:43], v[40:55]
    ds_read_b64_tr_b16 v[80:81], v87 offset:6144
    ds_read_b64_tr_b16 v[82:83], v87 offset:7168
    s_waitcnt lgkmcnt(2)
    v_mfma_f32_32x32x16_bf16 v[24:39], v[76:79], a[44:47], v[24:39]
    s_add_u32 s48, s48, 8192
    s_cmp_ge_u32 s48, 122880
    s_cselect_b32 s48, 0, s48
    v_add_u32 v88, s48, v84
    v_add_u32 v89, s48, v85
    s_waitcnt vmcnt(8)
    s_barrier
    ds_read_b64_tr_b16 v[68:69], v88 offset:0
    ds_read_b64_tr_b16 v[70:71], v88 offset:1024
    s_waitcnt lgkmcnt(2)
    v_mfma_f32_32x32x16_bf16 v[40:55], v[80:83], a[44:47], v[40:55]
    ds_read_b64_tr_b16 v[72:73], v89 offset:0
    ds_read_b64_tr_b16 v[74:75], v89 offset:1024
    s_waitcnt lgkmcnt(2)
    v_mfma_f32_32x32x16_bf16 v[24:39], v[68:71], a[48:51], v[24:39]
    ds_read_b64_tr_b16 v[76:77], v88 offset:2048
    ds_read_b64_tr_b16 v[78:79], v88 offset:3072
    s_waitcnt lgkmcnt(2)
    v_mfma_f32_32x32x16_bf16 v[40:55], v[72:75], a[48:51], v[40:55]
    ds_read_b64_tr_b16 v[80:81], v89 offset:2048
    ds_read_b64_tr_b16 v[82:83], v89 offset:3072
    s_waitcnt lgkmcnt(2)
    v_mfma_f32_32x32x16_bf16 v[24:39], v[76:79], a[52:55], v[24:39]
    ds_read_b64_tr_b16 v[68:69], v88 offset:4096
    ds_read_b64_tr_b16 v[70:71], v88 offset:5120
    s_waitcnt lgkmcnt(2)
    v_mfma_f32_32x32x16_bf16 v[40:55], v[80:83], a[52:55], v[40:55]
    ds_read_b64_tr_b16 v[72:73], v89 offset:4096
    ds_read_b64_tr_b16 v[74:75], v89 offset:5120
    s_waitcnt lgkmcnt(2)
    v_mfma_f32_32x32x16_bf16 v[24:39], v[68:71], a[56:59], v[24:39]
    ds_read_b64_tr_b16 v[76:77], v88 offset:6144
    ds_read_b64_tr_b16 v[78:79], v88 offset:7168
    s_waitcnt lgkmcnt(2)
    v_mfma_f32_32x32x16_bf16 v[40:55], v[72:75], a[56:59], v[40:55]
    ds_read_b64_tr_b16 v[80:81], v89 offset:6144
    ds_read_b64_tr_b16 v[82:83], v89 offset:7168
    s_waitcnt lgkmcnt(2)
    v_mfma_f32_32x32x16_bf16 v[24:39], v[76:79], a[60:63], v[24:39]
    s_add_u32 s48, s48, 8192
    s_cmp_ge_u32 s48, 122880
    s_cselect_b32 s48, 0, s48
    v_add_u32 v86, s48, v84
    v_add_u32 v87, s48, v85
    s_waitcnt vmcnt(4)
    s_barrier
    ds_read_b64_tr_b16 v[68:69], v86 offset:0
    ds_read_b64_tr_b16 v[70:71], v86 offset:1024
    s_waitcnt lgkmcnt(2)
    v_mfma_f32_32x32x16_bf16 v[40:55], v[80:83], a[60:63], v[40:55]
    ds_read_b64_tr_b16 v[72:73], v87 offset:0
    ds_read_b64_tr_b16 v[74:75], v87 offset:1024
    s_waitcnt lgkmcnt(2)
    v_mfma_f32_32x32x16_bf16 v[24:39], v[68:71], a[64:67], v[24:39]
    ds_read_b64_tr_b16 v[76:77], v86 offset:2048
    ds_read_b64_tr_b16 v[78:79], v86 offset:3072
    s_waitcnt lgkmcnt(2)
    v_mfma_f32_32x32x16_bf16 v[40:55], v[72:75], a[64:67], v[40:55]
    ds_read_b64_tr_b16 v[80:81], v87 offset:2048
    ds_read_b64_tr_b16 v[82:83], v87 offset:3072
    s_waitcnt lgkmcnt(2)
    v_mfma_f32_32x32x16_bf16 v[24:39], v[76:79], a[68:71], v[24:39]
    ds_read_b64_tr_b16 v[68:69], v86 offset:4096
    ds_read_b64_tr_b16 v[70:71], v86 offset:5120
    s_waitcnt lgkmcnt(2)
    v_mfma_f32_32x32x16_bf16 v[40:55], v[80:83], a[68:71], v[40:55]
    ds_read_b64_tr_b16 v[72:73], v87 offset:4096
    ds_read_b64_tr_b16 v[74:75], v87 offset:5120
    s_waitcnt lgkmcnt(2)
    v_mfma_f32_32x32x16_bf16 v[24:39], v[68:71], a[72:75], v[24:39]
    ds_read_b64_tr_b16 v[76:77], v86 offset:6144
    ds_read_b64_tr_b16 v[78:79], v86 offset:7168
    s_waitcnt lgkmcnt(2)
    v_mfma_f32_32x32x16_bf16 v[40:55], v[72:75], a[72:75], v[40:55]
    ds_read_b64_tr_b16 v[80:81], v87 offset:6144
    ds_read_b64_tr_b16 v[82:83], v87 offset:7168
    s_waitcnt lgkmcnt(2)
    v_mfma_f32_32x32x16_bf16 v[24:39], v[76:79], a[76:79], v[24:39]
    s_add_u32 s48, s48, 8192
    s_cmp_ge_u32 s48, 122880
    s_cselect_b32 s48, 0, s48
    v_add_u32 v88, s48, v84
    v_add_u32 v89, s48, v85
    s_waitcnt vmcnt(0)
    s_barrier
    ds_read_b64_tr_b16 v[68:69], v88 offset:0
    ds_read_b64_tr_b16 v[70:71], v88 offset:1024
    s_waitcnt lgkmcnt(2)
    v_mfma_f32_32x32x16_bf16 v[40:55], v[80:83], a[76:79], v[40:55]
    ds_read_b64_tr_b16 v[72:73], v89 offset:0
    ds_read_b64_tr_b16 v[74:75], v89 offset:1024
    s_waitcnt lgkmcnt(2)
    v_mfma_f32_32x32x16_bf16 v[24:39], v[68:71], a[80:83], v[24:39]
    ds_read_b64_tr_b16 v[76:77], v88 offset:2048
    ds_read_b64_tr_b16 v[78:79], v88 offset:3072
    s_waitcnt lgkmcnt(2)
    v_mfma_f32_32x32x16_bf16 v[40:55], v[72:75], a[80:83], v[40:55]
    ds_read_b64_tr_b16 v[80:81], v89 offset:2048
    ds_read_b64_tr_b16 v[82:83], v89 offset:3072
    s_waitcnt lgkmcnt(2)
    v_mfma_f32_32x32x16_bf16 v[24:39], v[76:79], v[56:59], v[24:39]
    ds_read_b64_tr_b16 v[68:69], v88 offset:4096
    ds_read_b64_tr_b16 v[70:71], v88 offset:5120
    s_waitcnt lgkmcnt(2)
    v_mfma_f32_32x32x16_bf16 v[40:55], v[80:83], v[56:59], v[40:55]
    ds_read_b64_tr_b16 v[72:73], v89 offset:4096
    ds_read_b64_tr_b16 v[74:75], v89 offset:5120
    s_waitcnt lgkmcnt(2)
    v_mfma_f32_32x32x16_bf16 v[24:39], v[68:71], v[60:63], v[24:39]
    ds_read_b64_tr_b16 v[76:77], v88 offset:6144
    ds_read_b64_tr_b16 v[78:79], v88 offset:7168
    s_waitcnt lgkmcnt(2)
    v_mfma_f32_32x32x16_bf16 v[40:55], v[72:75], v[60:63], v[40:55]
    ds_read_b64_tr_b16 v[80:81], v89 offset:6144
    ds_read_b64_tr_b16 v[82:83], v89 offset:7168
    s_waitcnt lgkmcnt(2)
    v_mfma_f32_32x32x16_bf16 v[24:39], v[76:79], v[64:67], v[24:39]
    s_waitcnt lgkmcnt(0)
    v_mfma_f32_32x32x16_bf16 v[40:55], v[80:83], v[64:67], v[40:55]
    s_waitcnt vmcnt(0) lgkmcnt(0)
    s_nop 11
    v_cvt_pk_bf16_f32 v108, v24, v25
    v_cvt_pk_bf16_f32 v109, v26, v27
    ds_write_b64 v20, v[108:109] offset:0
    v_cvt_pk_bf16_f32 v110, v28, v29
    v_cvt_pk_bf16_f32 v111, v30, v31
    ds_write_b64 v20, v[110:111] offset:16
    v_cvt_pk_bf16_f32 v112, v32, v33
    v_cvt_pk_bf16_f32 v113, v34, v35
    ds_write_b64 v20, v[112:113] offset:32
    v_cvt_pk_bf16_f32 v114, v36, v37
    v_cvt_pk_bf16_f32 v115, v38, v39
    ds_write_b64 v20, v[114:115] offset:48
    v_cvt_pk_bf16_f32 v116, v40, v41
    v_cvt_pk_bf16_f32 v117, v42, v43
    ds_write_b64 v20, v[116:117] offset:64
    v_cvt_pk_bf16_f32 v118, v44, v45
    v_cvt_pk_bf16_f32 v119, v46, v47
    ds_write_b64 v20, v[118:119] offset:80
    v_cvt_pk_bf16_f32 v120, v48, v49
    v_cvt_pk_bf16_f32 v121, v50, v51
    ds_write_b64 v20, v[120:121] offset:96
    v_cvt_pk_bf16_f32 v122, v52, v53
    v_cvt_pk_bf16_f32 v123, v54, v55
    ds_write_b64 v20, v[122:123] offset:112
    s_waitcnt lgkmcnt(0)
    ds_read_b128 v[4:7], v22 offset:0
    ds_read_b128 v[8:11], v22 offset:1152
    ds_read_b128 v[12:15], v22 offset:2304
    ds_read_b128 v[16:19], v22 offset:3456
    s_waitcnt lgkmcnt(3)
    buffer_store_dwordx4 v[4:7], v21, s[24:27], s57 offen nt
    s_add_u32 s57, s57, 10240
    s_waitcnt lgkmcnt(2)
    buffer_store_dwordx4 v[8:11], v21, s[24:27], s57 offen nt
    s_add_u32 s57, s57, 10240
    s_waitcnt lgkmcnt(1)
    buffer_store_dwordx4 v[12:15], v21, s[24:27], s57 offen nt
    s_add_u32 s57, s57, 10240
    s_waitcnt lgkmcnt(0)
    buffer_store_dwordx4 v[16:19], v21, s[24:27], s57 offen nt
F_exit:
F_end:
    s_endpgm
K2_fb:
    v_cmp_eq_u32 s[58:59], 1, v2
    s_nop 1
    v_cndmask_b32 v22, v22, 0, s[58:59]
    v_cndmask_b32 v23, v23, 0, s[58:59]
    v_mov_b32 v128, 0xff800000
    s_mov_b32 s47, 0
K2_mx:
    buffer_load_dwordx4 v[96:99], v4, s[16:19], s47 offen
    buffer_load_dwordx2 v[104:105], v5, s[16:19], s47 offen offset:1024
    s_waitcnt vmcnt(0)
    v_mfma_f32_32x32x16_bf16 v[24:39], v[96:99], v[16:19], 0
    v_mfma_f32_32x32x8_bf16 v[24:39], v[104:105], v[22:23], v[24:39]
    s_nop 15
    v_max3_f32 v8, v24, v25, v26
    v_max3_f32 v8, v8, v27, v28
    v_max3_f32 v8, v8, v29, v30
    v_max3_f32 v8, v8, v31, v32
    v_max3_f32 v8, v8, v33, v34
    v_max3_f32 v8, v8, v35, v36
    v_max3_f32 v8, v8, v37, v38
    v_max_f32 v8, v8, v39
    v_max_f32 v128, v128, v8
    s_add_u32 s47, s47, 4096
    s_cmp_lt_u32 s47, 262144
    s_cbranch_scc1 K2_mx
    v_mov_b32 v9, v128
    s_nop 1
    v_permlane32_swap_b32 v128, v9
    s_nop 1
    v_min_f32 v128, -v128, -v9
    v_and_b32 v6, 0xffff0000, v128
    v_sub_f32 v7, v128, v6
    v_and_b32 v8, 0xffff0000, v7
    v_perm_b32 v6, v7, v128, s15
    v_sub_f32 v7, v7, v8
    v_lshrrev_b32 v7, 16, v7
    v_cndmask_b32 v22, v22, v6, s[58:59]
    v_cndmask_b32 v23, v23, v7, s[58:59]
    v_mov_b32 v80, 0
    v_mov_b32 v81, 0
    v_mov_b32 v82, 0
    v_mov_b32 v83, 0
    v_mov_b32 v84, 0
    v_mov_b32 v85, 0
    v_mov_b32 v86, 0
    v_mov_b32 v87, 0
    v_mov_b32 v88, 0
    v_mov_b32 v89, 0
    v_mov_b32 v90, 0
    v_mov_b32 v91, 0
    v_mov_b32 v92, 0
    v_mov_b32 v93, 0
    v_mov_b32 v94, 0
    v_mov_b32 v95, 0
    s_mov_b32 s47, 0
K2_p2:
    buffer_load_dwordx4 v[96:99], v4, s[16:19], s47 offen
    buffer_load_dwordx2 v[104:105], v5, s[16:19], s47 offen offset:1024
    buffer_load_dwordx4 v[108:111], v4, s[16:19], s47 offen offset:2048
    buffer_load_dwordx4 v[116:119], v4, s[16:19], s47 offen offset:3072
    s_waitcnt vmcnt(0)
    v_mfma_f32_32x32x16_bf16 v[24:39], v[96:99], v[16:19], 0
    v_mfma_f32_32x32x8_bf16 v[24:39], v[104:105], v[22:23], v[24:39]
    s_nop 15
    v_exp_f32 v24, v24
    v_exp_f32 v25, v25
    v_exp_f32 v26, v26
    v_exp_f32 v27, v27
    v_exp_f32 v28, v28
    v_exp_f32 v29, v29
    v_exp_f32 v30, v30
    v_exp_f32 v31, v31
    v_exp_f32 v32, v32
    v_exp_f32 v33, v33
    v_exp_f32 v34, v34
    v_exp_f32 v35, v35
    v_exp_f32 v36, v36
    v_exp_f32 v37, v37
    v_exp_f32 v38, v38
    v_exp_f32 v39, v39
    s_nop 0
    v_cvt_pk_bf16_f32 v56, v24, v25
    v_cvt_pk_bf16_f32 v57, v26, v27
    v_cvt_pk_bf16_f32 v58, v28, v29
    v_cvt_pk_bf16_f32 v59, v30, v31
    v_cvt_pk_bf16_f32 v60, v32, v33
    v_cvt_pk_bf16_f32 v61, v34, v35
    v_cvt_pk_bf16_f32 v62, v36, v37
    v_cvt_pk_bf16_f32 v63, v38, v39
    s_nop 1
    v_mfma_f32_32x32x16_bf16 v[80:95], v[108:111], v[56:59], v[80:95]
    v_mfma_f32_32x32x16_bf16 v[80:95], v[116:119], v[60:63], v[80:95]
    s_nop 15
    s_add_u32 s47, s47, 4096
    s_cmp_lt_u32 s47, 262144
    s_cbranch_scc1 K2_p2
    v_mov_b32 v6, v88
    v_mov_b32 v131, v88
    s_nop 1
    v_permlane32_swap_b32 v6, v131
    s_nop 1
    v_rcp_f32 v104, v131
    v_rcp_f32 v105, v131
    s_waitcnt lgkmcnt(0)
    v_pk_mul_f32 v[88:89], v[88:89], v[104:105]
    v_pk_mul_f32 v[90:91], v[90:91], v[104:105]
    v_cvt_pk_bf16_f32 v60, v88, v89
    v_cvt_pk_bf16_f32 v61, v90, v91
    ds_write_b64 v142, v[60:61] offset:1024
    v_pk_mul_f32 v[80:81], v[80:81], v[104:105]
    v_pk_mul_f32 v[82:83], v[82:83], v[104:105]
    v_cvt_pk_bf16_f32 v56, v80, v81
    v_cvt_pk_bf16_f32 v57, v82, v83
    ds_write_b64 v140, v[56:57] offset:0
    v_pk_mul_f32 v[84:85], v[84:85], v[104:105]
    v_pk_mul_f32 v[86:87], v[86:87], v[104:105]
    v_cvt_pk_bf16_f32 v58, v84, v85
    v_cvt_pk_bf16_f32 v59, v86, v87
    ds_write_b64 v140, v[58:59] offset:512
    v_add_u32 v7, 148736, v143
    s_branch K2_ok
.section .rodata,"a"
.p2align 6
.amdhsa_kernel k1_qkv_kernel
  .amdhsa_next_free_vgpr 164
  .amdhsa_next_free_sgpr 102
  .amdhsa_accum_offset 164
  .amdhsa_group_segment_fixed_size 0
  .amdhsa_kernarg_size 96
  .amdhsa_user_sgpr_count 2
  .amdhsa_user_sgpr_kernarg_segment_ptr 1
  .amdhsa_system_sgpr_workgroup_id_x 1
.end_amdhsa_kernel
.p2align 6
.amdhsa_kernel k2_tail_kernel
  .amdhsa_next_free_vgpr 256
  .amdhsa_next_free_sgpr 102
  .amdhsa_accum_offset 172
  .amdhsa_group_segment_fixed_size 0
  .amdhsa_kernarg_size 96
  .amdhsa_user_sgpr_count 2
  .amdhsa_user_sgpr_kernarg_segment_ptr 1
  .amdhsa_system_sgpr_workgroup_id_x 1
.end_amdhsa_kernel
```
